```python
import torch

def _softmax(x, axis=-1):
    return torch.softmax(x, dim=axis)
def _gelu(x):
    return torch.nn.functional.gelu(x, approximate="tanh")
def _silu(x):
    return torch.nn.functional.silu(x)
def _sigmoid(x):
    return torch.sigmoid(x)
def _layernorm(x, axis=-1, eps=1e-5):
    m = x.mean(dim=axis, keepdim=True)
    v = x.var(dim=axis, keepdim=True, unbiased=False)
    return (x - m) / torch.sqrt(v + eps)
def _scatter_add(tgt, idx, src, axis=0):
    return tgt.clone().index_add_(axis, idx, src)
def _segment_sum(src, seg, n):
    out = torch.zeros((n,) + src.shape[1:], dtype=src.dtype)
    return out.index_add_(0, seg, src)
def _pad(x, pw):
    flat = tuple(v for pair in reversed(pw) for v in pair)
    return torch.nn.functional.pad(x, flat)

kernel_name = 'sequential_preLN__mha_block__mixer_s_mlp__prompt'

def setup_inputs():

    _w = (lambda a: (lambda t: t.to(torch.bfloat16) if t.is_floating_point() else t)(torch.as_tensor(a)))
    def _A_setup():
        B, S, D, H = 1, 2048, 576, 32
        return {
            "x": _w((lambda *s: torch.randn(*s, dtype=torch.bfloat16) * 0.05)(B, S, D)),
            "wqkv": _w((lambda *s: torch.randn(*s, dtype=torch.bfloat16) * 0.05)(D, 3 * D)),
            "wo": _w((lambda *s: torch.randn(*s, dtype=torch.bfloat16) * 0.05)(D, D)),
        }
    _A_in = _A_setup()

    def _B_setup():
        B, S, D, F = 1, 2048, 576, 4608
        return {
            "x":  _w((lambda *s: torch.randn(*s, dtype=torch.bfloat16) * 0.05)(B, S, D)),
            "w1": _w((lambda *s: torch.randn(*s, dtype=torch.bfloat16) * 3.2)(D, D) * (D ** -0.5)),
            "w2": _w((lambda *s: torch.randn(*s, dtype=torch.bfloat16) * 3.2)(D, D) * (D ** -0.5)),
            "w3": _w((lambda *s: torch.randn(*s, dtype=torch.bfloat16) * 3.2)(D, F) * (D ** -0.5)),
            "w4": _w((lambda *s: torch.randn(*s, dtype=torch.bfloat16) * 3.2)(F, D) * (F ** -0.5)),
        }
    _B_in = _B_setup()

    return {
        "A_x": _A_in["x"],
        "A_wqkv": _A_in["wqkv"],
        "A_wo": _A_in["wo"],
        "B_x": _B_in["x"],
        "B_w1": _B_in["w1"],
        "B_w2": _B_in["w2"],
        "B_w3": _B_in["w3"],
        "B_w4": _B_in["w4"],
    }

def reference(A_x, A_wqkv, A_wo, B_x, B_w1, B_w2, B_w3, B_w4):
    def _A_ref(x, wqkv, wo):
        B, S, D = x.shape
        H = 32
        Dh = D // H
        qkv = (lambda x, *d: x.permute(*d))((x @ wqkv).reshape(B, S, 3, H, Dh), 2, 0, 3, 1, 4)
        q, k, v = qkv[0], qkv[1], qkv[2]
        scores = torch.einsum("bhqd,bhkd->bhqk", q, k) * (Dh ** -0.5)
        p = _softmax(scores, axis=-1)
        o = torch.einsum("bhqk,bhkd->bhqd", p, v)
        return (lambda x, *d: x.permute(*d))(o, 0, 2, 1, 3).reshape(B, S, D) @ wo

    def _B_ref(x, w1, w2, w3, w4):
        B, S, D = x.shape
        h = _gelu(_layernorm(x, axis=-1) @ w1)
        c = D // 4
        g0 = _pad(h[:, :, 0*c:1*c], ((0, 0), (1, 0), (0, 0)))[:, :S, :]
        g1 = _pad(h[:, :, 1*c:2*c], ((0, 0), (0, 1), (0, 0)))[:, 1:, :]
        g2 = _pad(h[:, :, 2*c:3*c], ((0, 0), (2, 0), (0, 0)))[:, :S, :]
        g3 = _pad(h[:, :, 3*c:   ], ((0, 0), (0, 2), (0, 0)))[:, 2:, :]
        hs = torch.concatenate([g0, g1, g2, g3], axis=-1) @ w2
        x1 = x + hs
        h2 = _gelu(_layernorm(x1, axis=-1) @ w3) @ w4
        return x1 + h2

    x = A_x
    h = x + _A_ref(_layernorm(x, axis=-1), A_wqkv, A_wo)
    h2 = h + _B_ref(_layernorm(h, axis=-1), B_w1, B_w2, B_w3, B_w4)
    return h2
```

```asm
; @launch kernel=k_ln1_kernel grid=(64,1,1) block=(256,1,1) lds=0
; @launch kernel=k_qkv_kernel grid=(288,1,1) block=(256,1,1) lds=69632
; @launch kernel=k_attn_kernel grid=(512,1,1) block=(256,1,1) lds=18432
; @launch kernel=k_wo_kernel grid=(288,1,1) block=(256,1,1) lds=40960
; @launch kernel=k_ln2_kernel grid=(64,1,1) block=(256,1,1) lds=0
; @launch kernel=k_w1_kernel grid=(288,1,1) block=(256,1,1) lds=40960
; @launch kernel=k_w2_kernel grid=(288,1,1) block=(256,1,1) lds=40960
; @launch kernel=k_ln3_kernel grid=(64,1,1) block=(256,1,1) lds=0
; @launch kernel=k_w3_kernel grid=(768,1,1) block=(256,1,1) lds=69632
; @launch kernel=k_w4_kernel grid=(384,1,1) block=(256,1,1) lds=69632
; @launch kernel=sequential_preLN__mha_block__mixer_s_mlp__prompt_kernel grid=(576,1,1) block=(256,1,1) lds=0
.amdgcn_target "amdgcn-amd-amdhsa--gfx950"
.text
.globl k_ln1_kernel
.p2align 8
.type k_ln1_kernel,@function
k_ln1_kernel:
    s_cmp_ge_u32 s2, 64
    s_cbranch_scc1 k_ln1_kernel_end
    s_load_dwordx2 s[4:5], s[0:1], 0
    s_load_dwordx2 s[6:7], s[0:1], 80
    s_waitcnt lgkmcnt(0)
    s_mov_b32 s8, s4
    s_mov_b32 s9, s5
    s_mov_b32 s10, 2359296
    s_mov_b32 s11, 0x00020000
    s_add_u32 s12, s6, 56623104
    s_addc_u32 s13, s7, 0
    s_mov_b32 s14, 2359296
    s_mov_b32 s15, 0x00020000
    s_lshl_b32 s20, s2, 5
    v_lshrrev_b32 v5, 3, v0
    v_add_u32 v5, s20, v5
    v_mul_u32_u24 v5, 1152, v5
    v_and_b32 v4, 7, v0
    v_lshlrev_b32 v4, 4, v4
    v_add_u32 v5, v5, v4
    buffer_load_dwordx4 v[8:11], v5, s[8:11], 0 offen offset:0
    buffer_load_dwordx4 v[12:15], v5, s[8:11], 0 offen offset:128
    buffer_load_dwordx4 v[16:19], v5, s[8:11], 0 offen offset:256
    buffer_load_dwordx4 v[20:23], v5, s[8:11], 0 offen offset:384
    buffer_load_dwordx4 v[24:27], v5, s[8:11], 0 offen offset:512
    buffer_load_dwordx4 v[28:31], v5, s[8:11], 0 offen offset:640
    buffer_load_dwordx4 v[32:35], v5, s[8:11], 0 offen offset:768
    buffer_load_dwordx4 v[36:39], v5, s[8:11], 0 offen offset:896
    buffer_load_dwordx4 v[40:43], v5, s[8:11], 0 offen offset:1024
    v_mov_b32 v6, 0x3f803f80
    s_waitcnt vmcnt(0)
    v_mov_b32 v1, 0
    v_lshlrev_b32 v3, 16, v8
    v_and_b32 v4, 0xffff0000, v8
    v_add_f32 v1, v1, v3
    v_add_f32 v1, v1, v4
    v_lshlrev_b32 v3, 16, v9
    v_and_b32 v4, 0xffff0000, v9
    v_add_f32 v1, v1, v3
    v_add_f32 v1, v1, v4
    v_lshlrev_b32 v3, 16, v10
    v_and_b32 v4, 0xffff0000, v10
    v_add_f32 v1, v1, v3
    v_add_f32 v1, v1, v4
    v_lshlrev_b32 v3, 16, v11
    v_and_b32 v4, 0xffff0000, v11
    v_add_f32 v1, v1, v3
    v_add_f32 v1, v1, v4
    v_lshlrev_b32 v3, 16, v12
    v_and_b32 v4, 0xffff0000, v12
    v_add_f32 v1, v1, v3
    v_add_f32 v1, v1, v4
    v_lshlrev_b32 v3, 16, v13
    v_and_b32 v4, 0xffff0000, v13
    v_add_f32 v1, v1, v3
    v_add_f32 v1, v1, v4
    v_lshlrev_b32 v3, 16, v14
    v_and_b32 v4, 0xffff0000, v14
    v_add_f32 v1, v1, v3
    v_add_f32 v1, v1, v4
    v_lshlrev_b32 v3, 16, v15
    v_and_b32 v4, 0xffff0000, v15
    v_add_f32 v1, v1, v3
    v_add_f32 v1, v1, v4
    v_lshlrev_b32 v3, 16, v16
    v_and_b32 v4, 0xffff0000, v16
    v_add_f32 v1, v1, v3
    v_add_f32 v1, v1, v4
    v_lshlrev_b32 v3, 16, v17
    v_and_b32 v4, 0xffff0000, v17
    v_add_f32 v1, v1, v3
    v_add_f32 v1, v1, v4
    v_lshlrev_b32 v3, 16, v18
    v_and_b32 v4, 0xffff0000, v18
    v_add_f32 v1, v1, v3
    v_add_f32 v1, v1, v4
    v_lshlrev_b32 v3, 16, v19
    v_and_b32 v4, 0xffff0000, v19
    v_add_f32 v1, v1, v3
    v_add_f32 v1, v1, v4
    v_lshlrev_b32 v3, 16, v20
    v_and_b32 v4, 0xffff0000, v20
    v_add_f32 v1, v1, v3
    v_add_f32 v1, v1, v4
    v_lshlrev_b32 v3, 16, v21
    v_and_b32 v4, 0xffff0000, v21
    v_add_f32 v1, v1, v3
    v_add_f32 v1, v1, v4
    v_lshlrev_b32 v3, 16, v22
    v_and_b32 v4, 0xffff0000, v22
    v_add_f32 v1, v1, v3
    v_add_f32 v1, v1, v4
    v_lshlrev_b32 v3, 16, v23
    v_and_b32 v4, 0xffff0000, v23
    v_add_f32 v1, v1, v3
    v_add_f32 v1, v1, v4
    v_lshlrev_b32 v3, 16, v24
    v_and_b32 v4, 0xffff0000, v24
    v_add_f32 v1, v1, v3
    v_add_f32 v1, v1, v4
    v_lshlrev_b32 v3, 16, v25
    v_and_b32 v4, 0xffff0000, v25
    v_add_f32 v1, v1, v3
    v_add_f32 v1, v1, v4
    v_lshlrev_b32 v3, 16, v26
    v_and_b32 v4, 0xffff0000, v26
    v_add_f32 v1, v1, v3
    v_add_f32 v1, v1, v4
    v_lshlrev_b32 v3, 16, v27
    v_and_b32 v4, 0xffff0000, v27
    v_add_f32 v1, v1, v3
    v_add_f32 v1, v1, v4
    v_lshlrev_b32 v3, 16, v28
    v_and_b32 v4, 0xffff0000, v28
    v_add_f32 v1, v1, v3
    v_add_f32 v1, v1, v4
    v_lshlrev_b32 v3, 16, v29
    v_and_b32 v4, 0xffff0000, v29
    v_add_f32 v1, v1, v3
    v_add_f32 v1, v1, v4
    v_lshlrev_b32 v3, 16, v30
    v_and_b32 v4, 0xffff0000, v30
    v_add_f32 v1, v1, v3
    v_add_f32 v1, v1, v4
    v_lshlrev_b32 v3, 16, v31
    v_and_b32 v4, 0xffff0000, v31
    v_add_f32 v1, v1, v3
    v_add_f32 v1, v1, v4
    v_lshlrev_b32 v3, 16, v32
    v_and_b32 v4, 0xffff0000, v32
    v_add_f32 v1, v1, v3
    v_add_f32 v1, v1, v4
    v_lshlrev_b32 v3, 16, v33
    v_and_b32 v4, 0xffff0000, v33
    v_add_f32 v1, v1, v3
    v_add_f32 v1, v1, v4
    v_lshlrev_b32 v3, 16, v34
    v_and_b32 v4, 0xffff0000, v34
    v_add_f32 v1, v1, v3
    v_add_f32 v1, v1, v4
    v_lshlrev_b32 v3, 16, v35
    v_and_b32 v4, 0xffff0000, v35
    v_add_f32 v1, v1, v3
    v_add_f32 v1, v1, v4
    v_lshlrev_b32 v3, 16, v36
    v_and_b32 v4, 0xffff0000, v36
    v_add_f32 v1, v1, v3
    v_add_f32 v1, v1, v4
    v_lshlrev_b32 v3, 16, v37
    v_and_b32 v4, 0xffff0000, v37
    v_add_f32 v1, v1, v3
    v_add_f32 v1, v1, v4
    v_lshlrev_b32 v3, 16, v38
    v_and_b32 v4, 0xffff0000, v38
    v_add_f32 v1, v1, v3
    v_add_f32 v1, v1, v4
    v_lshlrev_b32 v3, 16, v39
    v_and_b32 v4, 0xffff0000, v39
    v_add_f32 v1, v1, v3
    v_add_f32 v1, v1, v4
    v_lshlrev_b32 v3, 16, v40
    v_and_b32 v4, 0xffff0000, v40
    v_add_f32 v1, v1, v3
    v_add_f32 v1, v1, v4
    v_lshlrev_b32 v3, 16, v41
    v_and_b32 v4, 0xffff0000, v41
    v_add_f32 v1, v1, v3
    v_add_f32 v1, v1, v4
    v_lshlrev_b32 v3, 16, v42
    v_and_b32 v4, 0xffff0000, v42
    v_add_f32 v1, v1, v3
    v_add_f32 v1, v1, v4
    v_lshlrev_b32 v3, 16, v43
    v_and_b32 v4, 0xffff0000, v43
    v_add_f32 v1, v1, v3
    v_add_f32 v1, v1, v4
    s_nop 1
    v_add_f32_dpp v1, v1, v1 quad_perm:[1,0,3,2] row_mask:0xf bank_mask:0xf
    s_nop 1
    v_add_f32_dpp v1, v1, v1 quad_perm:[2,3,0,1] row_mask:0xf bank_mask:0xf
    s_nop 1
    v_add_f32_dpp v1, v1, v1 row_half_mirror row_mask:0xf bank_mask:0xf
    v_mul_f32 v1, 0x3ae38e39, v1
    v_mov_b32 v2, 0
    v_lshlrev_b32 v3, 16, v8
    v_and_b32 v4, 0xffff0000, v8
    v_sub_f32 v3, v3, v1
    v_sub_f32 v4, v4, v1
    v_fmac_f32 v2, v3, v3
    v_fmac_f32 v2, v4, v4
    v_lshlrev_b32 v3, 16, v9
    v_and_b32 v4, 0xffff0000, v9
    v_sub_f32 v3, v3, v1
    v_sub_f32 v4, v4, v1
    v_fmac_f32 v2, v3, v3
    v_fmac_f32 v2, v4, v4
    v_lshlrev_b32 v3, 16, v10
    v_and_b32 v4, 0xffff0000, v10
    v_sub_f32 v3, v3, v1
    v_sub_f32 v4, v4, v1
    v_fmac_f32 v2, v3, v3
    v_fmac_f32 v2, v4, v4
    v_lshlrev_b32 v3, 16, v11
    v_and_b32 v4, 0xffff0000, v11
    v_sub_f32 v3, v3, v1
    v_sub_f32 v4, v4, v1
    v_fmac_f32 v2, v3, v3
    v_fmac_f32 v2, v4, v4
    v_lshlrev_b32 v3, 16, v12
    v_and_b32 v4, 0xffff0000, v12
    v_sub_f32 v3, v3, v1
    v_sub_f32 v4, v4, v1
    v_fmac_f32 v2, v3, v3
    v_fmac_f32 v2, v4, v4
    v_lshlrev_b32 v3, 16, v13
    v_and_b32 v4, 0xffff0000, v13
    v_sub_f32 v3, v3, v1
    v_sub_f32 v4, v4, v1
    v_fmac_f32 v2, v3, v3
    v_fmac_f32 v2, v4, v4
    v_lshlrev_b32 v3, 16, v14
    v_and_b32 v4, 0xffff0000, v14
    v_sub_f32 v3, v3, v1
    v_sub_f32 v4, v4, v1
    v_fmac_f32 v2, v3, v3
    v_fmac_f32 v2, v4, v4
    v_lshlrev_b32 v3, 16, v15
    v_and_b32 v4, 0xffff0000, v15
    v_sub_f32 v3, v3, v1
    v_sub_f32 v4, v4, v1
    v_fmac_f32 v2, v3, v3
    v_fmac_f32 v2, v4, v4
    v_lshlrev_b32 v3, 16, v16
    v_and_b32 v4, 0xffff0000, v16
    v_sub_f32 v3, v3, v1
    v_sub_f32 v4, v4, v1
    v_fmac_f32 v2, v3, v3
    v_fmac_f32 v2, v4, v4
    v_lshlrev_b32 v3, 16, v17
    v_and_b32 v4, 0xffff0000, v17
    v_sub_f32 v3, v3, v1
    v_sub_f32 v4, v4, v1
    v_fmac_f32 v2, v3, v3
    v_fmac_f32 v2, v4, v4
    v_lshlrev_b32 v3, 16, v18
    v_and_b32 v4, 0xffff0000, v18
    v_sub_f32 v3, v3, v1
    v_sub_f32 v4, v4, v1
    v_fmac_f32 v2, v3, v3
    v_fmac_f32 v2, v4, v4
    v_lshlrev_b32 v3, 16, v19
    v_and_b32 v4, 0xffff0000, v19
    v_sub_f32 v3, v3, v1
    v_sub_f32 v4, v4, v1
    v_fmac_f32 v2, v3, v3
    v_fmac_f32 v2, v4, v4
    v_lshlrev_b32 v3, 16, v20
    v_and_b32 v4, 0xffff0000, v20
    v_sub_f32 v3, v3, v1
    v_sub_f32 v4, v4, v1
    v_fmac_f32 v2, v3, v3
    v_fmac_f32 v2, v4, v4
    v_lshlrev_b32 v3, 16, v21
    v_and_b32 v4, 0xffff0000, v21
    v_sub_f32 v3, v3, v1
    v_sub_f32 v4, v4, v1
    v_fmac_f32 v2, v3, v3
    v_fmac_f32 v2, v4, v4
    v_lshlrev_b32 v3, 16, v22
    v_and_b32 v4, 0xffff0000, v22
    v_sub_f32 v3, v3, v1
    v_sub_f32 v4, v4, v1
    v_fmac_f32 v2, v3, v3
    v_fmac_f32 v2, v4, v4
    v_lshlrev_b32 v3, 16, v23
    v_and_b32 v4, 0xffff0000, v23
    v_sub_f32 v3, v3, v1
    v_sub_f32 v4, v4, v1
    v_fmac_f32 v2, v3, v3
    v_fmac_f32 v2, v4, v4
    v_lshlrev_b32 v3, 16, v24
    v_and_b32 v4, 0xffff0000, v24
    v_sub_f32 v3, v3, v1
    v_sub_f32 v4, v4, v1
    v_fmac_f32 v2, v3, v3
    v_fmac_f32 v2, v4, v4
    v_lshlrev_b32 v3, 16, v25
    v_and_b32 v4, 0xffff0000, v25
    v_sub_f32 v3, v3, v1
    v_sub_f32 v4, v4, v1
    v_fmac_f32 v2, v3, v3
    v_fmac_f32 v2, v4, v4
    v_lshlrev_b32 v3, 16, v26
    v_and_b32 v4, 0xffff0000, v26
    v_sub_f32 v3, v3, v1
    v_sub_f32 v4, v4, v1
    v_fmac_f32 v2, v3, v3
    v_fmac_f32 v2, v4, v4
    v_lshlrev_b32 v3, 16, v27
    v_and_b32 v4, 0xffff0000, v27
    v_sub_f32 v3, v3, v1
    v_sub_f32 v4, v4, v1
    v_fmac_f32 v2, v3, v3
    v_fmac_f32 v2, v4, v4
    v_lshlrev_b32 v3, 16, v28
    v_and_b32 v4, 0xffff0000, v28
    v_sub_f32 v3, v3, v1
    v_sub_f32 v4, v4, v1
    v_fmac_f32 v2, v3, v3
    v_fmac_f32 v2, v4, v4
    v_lshlrev_b32 v3, 16, v29
    v_and_b32 v4, 0xffff0000, v29
    v_sub_f32 v3, v3, v1
    v_sub_f32 v4, v4, v1
    v_fmac_f32 v2, v3, v3
    v_fmac_f32 v2, v4, v4
    v_lshlrev_b32 v3, 16, v30
    v_and_b32 v4, 0xffff0000, v30
    v_sub_f32 v3, v3, v1
    v_sub_f32 v4, v4, v1
    v_fmac_f32 v2, v3, v3
    v_fmac_f32 v2, v4, v4
    v_lshlrev_b32 v3, 16, v31
    v_and_b32 v4, 0xffff0000, v31
    v_sub_f32 v3, v3, v1
    v_sub_f32 v4, v4, v1
    v_fmac_f32 v2, v3, v3
    v_fmac_f32 v2, v4, v4
    v_lshlrev_b32 v3, 16, v32
    v_and_b32 v4, 0xffff0000, v32
    v_sub_f32 v3, v3, v1
    v_sub_f32 v4, v4, v1
    v_fmac_f32 v2, v3, v3
    v_fmac_f32 v2, v4, v4
    v_lshlrev_b32 v3, 16, v33
    v_and_b32 v4, 0xffff0000, v33
    v_sub_f32 v3, v3, v1
    v_sub_f32 v4, v4, v1
    v_fmac_f32 v2, v3, v3
    v_fmac_f32 v2, v4, v4
    v_lshlrev_b32 v3, 16, v34
    v_and_b32 v4, 0xffff0000, v34
    v_sub_f32 v3, v3, v1
    v_sub_f32 v4, v4, v1
    v_fmac_f32 v2, v3, v3
    v_fmac_f32 v2, v4, v4
    v_lshlrev_b32 v3, 16, v35
    v_and_b32 v4, 0xffff0000, v35
    v_sub_f32 v3, v3, v1
    v_sub_f32 v4, v4, v1
    v_fmac_f32 v2, v3, v3
    v_fmac_f32 v2, v4, v4
    v_lshlrev_b32 v3, 16, v36
    v_and_b32 v4, 0xffff0000, v36
    v_sub_f32 v3, v3, v1
    v_sub_f32 v4, v4, v1
    v_fmac_f32 v2, v3, v3
    v_fmac_f32 v2, v4, v4
    v_lshlrev_b32 v3, 16, v37
    v_and_b32 v4, 0xffff0000, v37
    v_sub_f32 v3, v3, v1
    v_sub_f32 v4, v4, v1
    v_fmac_f32 v2, v3, v3
    v_fmac_f32 v2, v4, v4
    v_lshlrev_b32 v3, 16, v38
    v_and_b32 v4, 0xffff0000, v38
    v_sub_f32 v3, v3, v1
    v_sub_f32 v4, v4, v1
    v_fmac_f32 v2, v3, v3
    v_fmac_f32 v2, v4, v4
    v_lshlrev_b32 v3, 16, v39
    v_and_b32 v4, 0xffff0000, v39
    v_sub_f32 v3, v3, v1
    v_sub_f32 v4, v4, v1
    v_fmac_f32 v2, v3, v3
    v_fmac_f32 v2, v4, v4
    v_lshlrev_b32 v3, 16, v40
    v_and_b32 v4, 0xffff0000, v40
    v_sub_f32 v3, v3, v1
    v_sub_f32 v4, v4, v1
    v_fmac_f32 v2, v3, v3
    v_fmac_f32 v2, v4, v4
    v_lshlrev_b32 v3, 16, v41
    v_and_b32 v4, 0xffff0000, v41
    v_sub_f32 v3, v3, v1
    v_sub_f32 v4, v4, v1
    v_fmac_f32 v2, v3, v3
    v_fmac_f32 v2, v4, v4
    v_lshlrev_b32 v3, 16, v42
    v_and_b32 v4, 0xffff0000, v42
    v_sub_f32 v3, v3, v1
    v_sub_f32 v4, v4, v1
    v_fmac_f32 v2, v3, v3
    v_fmac_f32 v2, v4, v4
    v_lshlrev_b32 v3, 16, v43
    v_and_b32 v4, 0xffff0000, v43
    v_sub_f32 v3, v3, v1
    v_sub_f32 v4, v4, v1
    v_fmac_f32 v2, v3, v3
    v_fmac_f32 v2, v4, v4
    s_nop 1
    v_add_f32_dpp v2, v2, v2 quad_perm:[1,0,3,2] row_mask:0xf bank_mask:0xf
    s_nop 1
    v_add_f32_dpp v2, v2, v2 quad_perm:[2,3,0,1] row_mask:0xf bank_mask:0xf
    s_nop 1
    v_add_f32_dpp v2, v2, v2 row_half_mirror row_mask:0xf bank_mask:0xf
    v_mul_f32 v2, 0x3ae38e39, v2
    v_add_f32 v2, 0x3727c5ac, v2
    v_rsq_f32 v2, v2
    s_nop 1
    v_mul_f32 v1, v1, v2
    v_sub_f32 v1, 0, v1
    v_lshlrev_b32 v3, 16, v8
    v_and_b32 v4, 0xffff0000, v8
    v_fma_f32 v3, v3, v2, v1
    v_fma_f32 v4, v4, v2, v1
    v_cvt_pk_bf16_f32 v8, v3, v4
    v_lshlrev_b32 v3, 16, v9
    v_and_b32 v4, 0xffff0000, v9
    v_fma_f32 v3, v3, v2, v1
    v_fma_f32 v4, v4, v2, v1
    v_cvt_pk_bf16_f32 v9, v3, v4
    v_lshlrev_b32 v3, 16, v10
    v_and_b32 v4, 0xffff0000, v10
    v_fma_f32 v3, v3, v2, v1
    v_fma_f32 v4, v4, v2, v1
    v_cvt_pk_bf16_f32 v10, v3, v4
    v_lshlrev_b32 v3, 16, v11
    v_and_b32 v4, 0xffff0000, v11
    v_fma_f32 v3, v3, v2, v1
    v_fma_f32 v4, v4, v2, v1
    v_cvt_pk_bf16_f32 v11, v3, v4
    v_lshlrev_b32 v3, 16, v12
    v_and_b32 v4, 0xffff0000, v12
    v_fma_f32 v3, v3, v2, v1
    v_fma_f32 v4, v4, v2, v1
    v_cvt_pk_bf16_f32 v12, v3, v4
    v_lshlrev_b32 v3, 16, v13
    v_and_b32 v4, 0xffff0000, v13
    v_fma_f32 v3, v3, v2, v1
    v_fma_f32 v4, v4, v2, v1
    v_cvt_pk_bf16_f32 v13, v3, v4
    v_lshlrev_b32 v3, 16, v14
    v_and_b32 v4, 0xffff0000, v14
    v_fma_f32 v3, v3, v2, v1
    v_fma_f32 v4, v4, v2, v1
    v_cvt_pk_bf16_f32 v14, v3, v4
    v_lshlrev_b32 v3, 16, v15
    v_and_b32 v4, 0xffff0000, v15
    v_fma_f32 v3, v3, v2, v1
    v_fma_f32 v4, v4, v2, v1
    v_cvt_pk_bf16_f32 v15, v3, v4
    v_lshlrev_b32 v3, 16, v16
    v_and_b32 v4, 0xffff0000, v16
    v_fma_f32 v3, v3, v2, v1
    v_fma_f32 v4, v4, v2, v1
    v_cvt_pk_bf16_f32 v16, v3, v4
    v_lshlrev_b32 v3, 16, v17
    v_and_b32 v4, 0xffff0000, v17
    v_fma_f32 v3, v3, v2, v1
    v_fma_f32 v4, v4, v2, v1
    v_cvt_pk_bf16_f32 v17, v3, v4
    v_lshlrev_b32 v3, 16, v18
    v_and_b32 v4, 0xffff0000, v18
    v_fma_f32 v3, v3, v2, v1
    v_fma_f32 v4, v4, v2, v1
    v_cvt_pk_bf16_f32 v18, v3, v4
    v_lshlrev_b32 v3, 16, v19
    v_and_b32 v4, 0xffff0000, v19
    v_fma_f32 v3, v3, v2, v1
    v_fma_f32 v4, v4, v2, v1
    v_cvt_pk_bf16_f32 v19, v3, v4
    v_lshlrev_b32 v3, 16, v20
    v_and_b32 v4, 0xffff0000, v20
    v_fma_f32 v3, v3, v2, v1
    v_fma_f32 v4, v4, v2, v1
    v_cvt_pk_bf16_f32 v20, v3, v4
    v_lshlrev_b32 v3, 16, v21
    v_and_b32 v4, 0xffff0000, v21
    v_fma_f32 v3, v3, v2, v1
    v_fma_f32 v4, v4, v2, v1
    v_cvt_pk_bf16_f32 v21, v3, v4
    v_lshlrev_b32 v3, 16, v22
    v_and_b32 v4, 0xffff0000, v22
    v_fma_f32 v3, v3, v2, v1
    v_fma_f32 v4, v4, v2, v1
    v_cvt_pk_bf16_f32 v22, v3, v4
    v_lshlrev_b32 v3, 16, v23
    v_and_b32 v4, 0xffff0000, v23
    v_fma_f32 v3, v3, v2, v1
    v_fma_f32 v4, v4, v2, v1
    v_cvt_pk_bf16_f32 v23, v3, v4
    v_lshlrev_b32 v3, 16, v24
    v_and_b32 v4, 0xffff0000, v24
    v_fma_f32 v3, v3, v2, v1
    v_fma_f32 v4, v4, v2, v1
    v_cvt_pk_bf16_f32 v24, v3, v4
    v_lshlrev_b32 v3, 16, v25
    v_and_b32 v4, 0xffff0000, v25
    v_fma_f32 v3, v3, v2, v1
    v_fma_f32 v4, v4, v2, v1
    v_cvt_pk_bf16_f32 v25, v3, v4
    v_lshlrev_b32 v3, 16, v26
    v_and_b32 v4, 0xffff0000, v26
    v_fma_f32 v3, v3, v2, v1
    v_fma_f32 v4, v4, v2, v1
    v_cvt_pk_bf16_f32 v26, v3, v4
    v_lshlrev_b32 v3, 16, v27
    v_and_b32 v4, 0xffff0000, v27
    v_fma_f32 v3, v3, v2, v1
    v_fma_f32 v4, v4, v2, v1
    v_cvt_pk_bf16_f32 v27, v3, v4
    v_lshlrev_b32 v3, 16, v28
    v_and_b32 v4, 0xffff0000, v28
    v_fma_f32 v3, v3, v2, v1
    v_fma_f32 v4, v4, v2, v1
    v_cvt_pk_bf16_f32 v28, v3, v4
    v_lshlrev_b32 v3, 16, v29
    v_and_b32 v4, 0xffff0000, v29
    v_fma_f32 v3, v3, v2, v1
    v_fma_f32 v4, v4, v2, v1
    v_cvt_pk_bf16_f32 v29, v3, v4
    v_lshlrev_b32 v3, 16, v30
    v_and_b32 v4, 0xffff0000, v30
    v_fma_f32 v3, v3, v2, v1
    v_fma_f32 v4, v4, v2, v1
    v_cvt_pk_bf16_f32 v30, v3, v4
    v_lshlrev_b32 v3, 16, v31
    v_and_b32 v4, 0xffff0000, v31
    v_fma_f32 v3, v3, v2, v1
    v_fma_f32 v4, v4, v2, v1
    v_cvt_pk_bf16_f32 v31, v3, v4
    v_lshlrev_b32 v3, 16, v32
    v_and_b32 v4, 0xffff0000, v32
    v_fma_f32 v3, v3, v2, v1
    v_fma_f32 v4, v4, v2, v1
    v_cvt_pk_bf16_f32 v32, v3, v4
    v_lshlrev_b32 v3, 16, v33
    v_and_b32 v4, 0xffff0000, v33
    v_fma_f32 v3, v3, v2, v1
    v_fma_f32 v4, v4, v2, v1
    v_cvt_pk_bf16_f32 v33, v3, v4
    v_lshlrev_b32 v3, 16, v34
    v_and_b32 v4, 0xffff0000, v34
    v_fma_f32 v3, v3, v2, v1
    v_fma_f32 v4, v4, v2, v1
    v_cvt_pk_bf16_f32 v34, v3, v4
    v_lshlrev_b32 v3, 16, v35
    v_and_b32 v4, 0xffff0000, v35
    v_fma_f32 v3, v3, v2, v1
    v_fma_f32 v4, v4, v2, v1
    v_cvt_pk_bf16_f32 v35, v3, v4
    v_lshlrev_b32 v3, 16, v36
    v_and_b32 v4, 0xffff0000, v36
    v_fma_f32 v3, v3, v2, v1
    v_fma_f32 v4, v4, v2, v1
    v_cvt_pk_bf16_f32 v36, v3, v4
    v_lshlrev_b32 v3, 16, v37
    v_and_b32 v4, 0xffff0000, v37
    v_fma_f32 v3, v3, v2, v1
    v_fma_f32 v4, v4, v2, v1
    v_cvt_pk_bf16_f32 v37, v3, v4
    v_lshlrev_b32 v3, 16, v38
    v_and_b32 v4, 0xffff0000, v38
    v_fma_f32 v3, v3, v2, v1
    v_fma_f32 v4, v4, v2, v1
    v_cvt_pk_bf16_f32 v38, v3, v4
    v_lshlrev_b32 v3, 16, v39
    v_and_b32 v4, 0xffff0000, v39
    v_fma_f32 v3, v3, v2, v1
    v_fma_f32 v4, v4, v2, v1
    v_cvt_pk_bf16_f32 v39, v3, v4
    v_lshlrev_b32 v3, 16, v40
    v_and_b32 v4, 0xffff0000, v40
    v_fma_f32 v3, v3, v2, v1
    v_fma_f32 v4, v4, v2, v1
    v_cvt_pk_bf16_f32 v40, v3, v4
    v_lshlrev_b32 v3, 16, v41
    v_and_b32 v4, 0xffff0000, v41
    v_fma_f32 v3, v3, v2, v1
    v_fma_f32 v4, v4, v2, v1
    v_cvt_pk_bf16_f32 v41, v3, v4
    v_lshlrev_b32 v3, 16, v42
    v_and_b32 v4, 0xffff0000, v42
    v_fma_f32 v3, v3, v2, v1
    v_fma_f32 v4, v4, v2, v1
    v_cvt_pk_bf16_f32 v42, v3, v4
    v_lshlrev_b32 v3, 16, v43
    v_and_b32 v4, 0xffff0000, v43
    v_fma_f32 v3, v3, v2, v1
    v_fma_f32 v4, v4, v2, v1
    v_cvt_pk_bf16_f32 v43, v3, v4
    buffer_store_dwordx4 v[8:11], v5, s[12:15], 0 offen offset:0
    buffer_store_dwordx4 v[12:15], v5, s[12:15], 0 offen offset:128
    buffer_store_dwordx4 v[16:19], v5, s[12:15], 0 offen offset:256
    buffer_store_dwordx4 v[20:23], v5, s[12:15], 0 offen offset:384
    buffer_store_dwordx4 v[24:27], v5, s[12:15], 0 offen offset:512
    buffer_store_dwordx4 v[28:31], v5, s[12:15], 0 offen offset:640
    buffer_store_dwordx4 v[32:35], v5, s[12:15], 0 offen offset:768
    buffer_store_dwordx4 v[36:39], v5, s[12:15], 0 offen offset:896
    buffer_store_dwordx4 v[40:43], v5, s[12:15], 0 offen offset:1024
    s_waitcnt vmcnt(0)
k_ln1_kernel_end:
    s_endpgm
.section .rodata,"a"
.p2align 6
.amdhsa_kernel k_ln1_kernel
  .amdhsa_next_free_vgpr 48
  .amdhsa_next_free_sgpr 32
  .amdhsa_accum_offset 48
  .amdhsa_group_segment_fixed_size 0
  .amdhsa_kernarg_size 88
  .amdhsa_user_sgpr_count 2
  .amdhsa_user_sgpr_kernarg_segment_ptr 1
  .amdhsa_system_sgpr_workgroup_id_x 1
.end_amdhsa_kernel
.text
.globl k_qkv_kernel
.p2align 8
.type k_qkv_kernel,@function
k_qkv_kernel:
    s_cmp_ge_u32 s2, 288
    s_cbranch_scc1 k_qkv_kernel_end
    s_load_dwordx2 s[36:37], s[0:1], 80
    s_load_dwordx2 s[38:39], s[0:1], 8
    s_mov_b32 s3, 0
    s_mov_b32 s6, s2
    s_mul_i32 s4, s6, 57
    s_lshr_b32 s4, s4, 10
    s_mul_i32 s5, s4, 18
    s_sub_u32 s5, s6, s5
    s_waitcnt lgkmcnt(0)
    s_add_u32 s8, s36, 56623104
    s_addc_u32 s9, s37, 0
    s_mov_b32 s10, 2359296
    s_mov_b32 s11, 0x00020000
    s_mov_b32 s12, s38
    s_mov_b32 s13, s39
    s_mov_b32 s14, 1990656
    s_mov_b32 s15, 0x00020000
    s_mov_b32 s16, s36
    s_mov_b32 s17, s37
    s_mov_b32 s18, 7077888
    s_mov_b32 s19, 0x00020000
    s_mul_i32 s32, s4, 128
    s_mul_i32 s33, s5, 96
    s_mul_i32 s34, s3, 1152
    s_mul_i32 s35, s3, 1990656
    v_and_b32 v5, 63, v0
    v_lshrrev_b32 v1, 3, v0
    v_and_b32 v2, 7, v0
    v_lshlrev_b32 v2, 4, v2
    v_mul_u32_u24 v10, 160, v1
    v_add_u32 v10, v10, v2
    v_add_u32 v3, s32, v1
    v_mul_u32_u24 v3, 1152, v3
    v_add_u32 v6, v3, v2
    v_add_u32 v7, 36864, v6
    v_add_u32 v8, 73728, v6
    v_add_u32 v9, 110592, v6
    v_add_u32 v1, 0, v0
    v_mul_u32_u24 v2, 683, v1
    v_lshrrev_b32 v2, 13, v2
    v_mul_u32_u24 v3, 12, v2
    v_sub_u32 v3, v1, v3
    v_lshlrev_b32 v3, 4, v3
    v_mul_u32_u24 v14, 224, v2
    v_add_u32 v14, v14, v3
    v_mul_u32_u24 v11, 3456, v2
    v_add_u32 v11, v11, v3
    v_mov_b32 v4, s33
    v_lshlrev_b32 v4, 1, v4
    v_add_u32 v11, v11, v4
    v_add_u32 v1, 256, v0
    v_mul_u32_u24 v2, 683, v1
    v_lshrrev_b32 v2, 13, v2
    v_mul_u32_u24 v3, 12, v2
    v_sub_u32 v3, v1, v3
    v_lshlrev_b32 v3, 4, v3
    v_mul_u32_u24 v15, 224, v2
    v_add_u32 v15, v15, v3
    v_mul_u32_u24 v12, 3456, v2
    v_add_u32 v12, v12, v3
    v_mov_b32 v4, s33
    v_lshlrev_b32 v4, 1, v4
    v_add_u32 v12, v12, v4
    v_add_u32 v1, 512, v0
    v_mul_u32_u24 v2, 683, v1
    v_lshrrev_b32 v2, 13, v2
    v_mul_u32_u24 v3, 12, v2
    v_sub_u32 v3, v1, v3
    v_lshlrev_b32 v3, 4, v3
    v_mul_u32_u24 v16, 224, v2
    v_add_u32 v16, v16, v3
    v_mul_u32_u24 v13, 3456, v2
    v_add_u32 v13, v13, v3
    v_mov_b32 v4, s33
    v_lshlrev_b32 v4, 1, v4
    v_add_u32 v13, v13, v4
    v_lshrrev_b32 v1, 7, v0
    v_mul_u32_u24 v1, 64, v1
    v_and_b32 v2, 15, v0
    v_add_u32 v1, v1, v2
    v_mul_u32_u24 v17, 160, v1
    v_lshrrev_b32 v2, 4, v5
    v_lshlrev_b32 v3, 4, v2
    v_add_u32 v17, v17, v3
    v_add_u32 v1, s32, v1
    v_mul_u32_u24 v19, 3456, v1
    v_lshrrev_b32 v4, 6, v0
    v_and_b32 v4, 1, v4
    v_mul_u32_u24 v4, 48, v4
    v_lshlrev_b32 v3, 2, v2
    v_add_u32 v3, v3, v4
    v_add_u32 v3, s33, v3
    v_mul_u32_u24 v3, 2, v3
    v_add_u32 v19, v19, v3
    v_and_b32 v1, 15, v0
    v_lshrrev_b32 v1, 2, v1
    v_lshlrev_b32 v3, 3, v2
    v_add_u32 v1, v1, v3
    v_mul_u32_u24 v18, 224, v1
    v_and_b32 v1, 3, v0
    v_lshlrev_b32 v1, 3, v1
    v_add_u32 v18, v18, v1
    v_lshlrev_b32 v4, 1, v4
    v_add_u32 v18, v18, v4
    v_mov_b32 v104, 0
    v_mov_b32 v105, 0
    v_mov_b32 v106, 0
    v_mov_b32 v107, 0
    v_mov_b32 v108, 0
    v_mov_b32 v109, 0
    v_mov_b32 v110, 0
    v_mov_b32 v111, 0
    v_mov_b32 v112, 0
    v_mov_b32 v113, 0
    v_mov_b32 v114, 0
    v_mov_b32 v115, 0
    v_mov_b32 v116, 0
    v_mov_b32 v117, 0
    v_mov_b32 v118, 0
    v_mov_b32 v119, 0
    v_mov_b32 v120, 0
    v_mov_b32 v121, 0
    v_mov_b32 v122, 0
    v_mov_b32 v123, 0
    v_mov_b32 v124, 0
    v_mov_b32 v125, 0
    v_mov_b32 v126, 0
    v_mov_b32 v127, 0
    v_mov_b32 v128, 0
    v_mov_b32 v129, 0
    v_mov_b32 v130, 0
    v_mov_b32 v131, 0
    v_mov_b32 v132, 0
    v_mov_b32 v133, 0
    v_mov_b32 v134, 0
    v_mov_b32 v135, 0
    v_mov_b32 v136, 0
    v_mov_b32 v137, 0
    v_mov_b32 v138, 0
    v_mov_b32 v139, 0
    v_mov_b32 v140, 0
    v_mov_b32 v141, 0
    v_mov_b32 v142, 0
    v_mov_b32 v143, 0
    v_mov_b32 v144, 0
    v_mov_b32 v145, 0
    v_mov_b32 v146, 0
    v_mov_b32 v147, 0
    v_mov_b32 v148, 0
    v_mov_b32 v149, 0
    v_mov_b32 v150, 0
    v_mov_b32 v151, 0
    buffer_load_dwordx4 v[20:23], v6, s[8:11], s34 offen
    buffer_load_dwordx4 v[24:27], v7, s[8:11], s34 offen
    buffer_load_dwordx4 v[28:31], v8, s[8:11], s34 offen
    buffer_load_dwordx4 v[32:35], v9, s[8:11], s34 offen
    buffer_load_dwordx4 v[36:39], v11, s[12:15], s35 offen
    buffer_load_dwordx4 v[40:43], v12, s[12:15], s35 offen
    buffer_load_dwordx4 v[44:47], v13, s[12:15], s35 offen
    s_add_u32 s34, s34, 128
    s_add_u32 s35, s35, 221184
    s_waitcnt vmcnt(0)
    ds_write_b128 v10, v[20:23] offset:0
    ds_write_b128 v10, v[24:27] offset:5120
    ds_write_b128 v10, v[28:31] offset:10240
    ds_write_b128 v10, v[32:35] offset:15360
    ds_write_b128 v14, v[36:39] offset:20480
    ds_write_b128 v15, v[40:43] offset:20480
    ds_write_b128 v16, v[44:47] offset:20480
    v_add_u32 v10, 34816, v10
    v_add_u32 v14, 34816, v14
    v_add_u32 v15, 34816, v15
    v_add_u32 v16, 34816, v16
    buffer_load_dwordx4 v[20:23], v6, s[8:11], s34 offen
    buffer_load_dwordx4 v[24:27], v7, s[8:11], s34 offen
    buffer_load_dwordx4 v[28:31], v8, s[8:11], s34 offen
    buffer_load_dwordx4 v[32:35], v9, s[8:11], s34 offen
    buffer_load_dwordx4 v[36:39], v11, s[12:15], s35 offen
    buffer_load_dwordx4 v[40:43], v12, s[12:15], s35 offen
    buffer_load_dwordx4 v[44:47], v13, s[12:15], s35 offen
    s_add_u32 s34, s34, 128
    s_add_u32 s35, s35, 221184
    s_waitcnt lgkmcnt(0)
    s_barrier
    ds_read_b128 v[48:51], v17 offset:0
    ds_read_b128 v[52:55], v17 offset:2560
    ds_read_b128 v[56:59], v17 offset:5120
    ds_read_b128 v[60:63], v17 offset:7680
    ds_read_b64_tr_b16 v[80:81], v18 offset:20480
    ds_read_b64_tr_b16 v[82:83], v18 offset:21376
    ds_read_b64_tr_b16 v[84:85], v18 offset:20512
    ds_read_b64_tr_b16 v[86:87], v18 offset:21408
    ds_read_b64_tr_b16 v[88:89], v18 offset:20544
    ds_read_b64_tr_b16 v[90:91], v18 offset:21440
    s_waitcnt lgkmcnt(0)
    v_mfma_f32_16x16x32_bf16 v[104:107], v[80:83], v[48:51], v[104:107]
    ds_read_b128 v[64:67], v17 offset:64
    v_mfma_f32_16x16x32_bf16 v[108:111], v[84:87], v[48:51], v[108:111]
    ds_read_b128 v[68:71], v17 offset:2624
    v_mfma_f32_16x16x32_bf16 v[112:115], v[88:91], v[48:51], v[112:115]
    ds_read_b128 v[72:75], v17 offset:5184
    v_mfma_f32_16x16x32_bf16 v[116:119], v[80:83], v[52:55], v[116:119]
    ds_read_b128 v[76:79], v17 offset:7744
    v_mfma_f32_16x16x32_bf16 v[120:123], v[84:87], v[52:55], v[120:123]
    ds_read_b64_tr_b16 v[92:93], v18 offset:27648
    v_mfma_f32_16x16x32_bf16 v[124:127], v[88:91], v[52:55], v[124:127]
    ds_read_b64_tr_b16 v[94:95], v18 offset:28544
    v_mfma_f32_16x16x32_bf16 v[128:131], v[80:83], v[56:59], v[128:131]
    ds_read_b64_tr_b16 v[96:97], v18 offset:27680
    v_mfma_f32_16x16x32_bf16 v[132:135], v[84:87], v[56:59], v[132:135]
    ds_read_b64_tr_b16 v[98:99], v18 offset:28576
    v_mfma_f32_16x16x32_bf16 v[136:139], v[88:91], v[56:59], v[136:139]
    ds_read_b64_tr_b16 v[100:101], v18 offset:27712
    v_mfma_f32_16x16x32_bf16 v[140:143], v[80:83], v[60:63], v[140:143]
    ds_read_b64_tr_b16 v[102:103], v18 offset:28608
    v_mfma_f32_16x16x32_bf16 v[144:147], v[84:87], v[60:63], v[144:147]
    v_mfma_f32_16x16x32_bf16 v[148:151], v[88:91], v[60:63], v[148:151]
    s_waitcnt lgkmcnt(0)
    v_mfma_f32_16x16x32_bf16 v[104:107], v[92:95], v[64:67], v[104:107]
    s_waitcnt vmcnt(0)
    ds_write_b128 v10, v[20:23] offset:0
    v_mfma_f32_16x16x32_bf16 v[108:111], v[96:99], v[64:67], v[108:111]
    ds_write_b128 v10, v[24:27] offset:5120
    ds_write_b128 v10, v[28:31] offset:10240
    v_mfma_f32_16x16x32_bf16 v[112:115], v[100:103], v[64:67], v[112:115]
    ds_write_b128 v10, v[32:35] offset:15360
    ds_write_b128 v14, v[36:39] offset:20480
    v_mfma_f32_16x16x32_bf16 v[116:119], v[92:95], v[68:71], v[116:119]
    ds_write_b128 v15, v[40:43] offset:20480
    ds_write_b128 v16, v[44:47] offset:20480
    v_mfma_f32_16x16x32_bf16 v[120:123], v[96:99], v[68:71], v[120:123]
    v_add_u32 v10, 4294932480, v10
    v_add_u32 v14, 4294932480, v14
    v_mfma_f32_16x16x32_bf16 v[124:127], v[100:103], v[68:71], v[124:127]
    v_add_u32 v15, 4294932480, v15
    v_add_u32 v16, 4294932480, v16
    v_mfma_f32_16x16x32_bf16 v[128:131], v[92:95], v[72:75], v[128:131]
    buffer_load_dwordx4 v[20:23], v6, s[8:11], s34 offen
    buffer_load_dwordx4 v[24:27], v7, s[8:11], s34 offen
    v_mfma_f32_16x16x32_bf16 v[132:135], v[96:99], v[72:75], v[132:135]
    buffer_load_dwordx4 v[28:31], v8, s[8:11], s34 offen
    buffer_load_dwordx4 v[32:35], v9, s[8:11], s34 offen
    v_mfma_f32_16x16x32_bf16 v[136:139], v[100:103], v[72:75], v[136:139]
    buffer_load_dwordx4 v[36:39], v11, s[12:15], s35 offen
    buffer_load_dwordx4 v[40:43], v12, s[12:15], s35 offen
    v_mfma_f32_16x16x32_bf16 v[140:143], v[92:95], v[76:79], v[140:143]
    buffer_load_dwordx4 v[44:47], v13, s[12:15], s35 offen
    s_add_u32 s34, s34, 128
    v_mfma_f32_16x16x32_bf16 v[144:147], v[96:99], v[76:79], v[144:147]
    s_add_u32 s35, s35, 221184
    v_mfma_f32_16x16x32_bf16 v[148:151], v[100:103], v[76:79], v[148:151]
    v_add_u32 v17, 34816, v17
    v_add_u32 v18, 34816, v18
    s_waitcnt lgkmcnt(0)
    s_barrier
    ds_read_b128 v[48:51], v17 offset:0
    ds_read_b128 v[52:55], v17 offset:2560
    ds_read_b128 v[56:59], v17 offset:5120
    ds_read_b128 v[60:63], v17 offset:7680
    ds_read_b64_tr_b16 v[80:81], v18 offset:20480
    ds_read_b64_tr_b16 v[82:83], v18 offset:21376
    ds_read_b64_tr_b16 v[84:85], v18 offset:20512
    ds_read_b64_tr_b16 v[86:87], v18 offset:21408
    ds_read_b64_tr_b16 v[88:89], v18 offset:20544
    ds_read_b64_tr_b16 v[90:91], v18 offset:21440
    s_waitcnt lgkmcnt(0)
    v_mfma_f32_16x16x32_bf16 v[104:107], v[80:83], v[48:51], v[104:107]
    ds_read_b128 v[64:67], v17 offset:64
    v_mfma_f32_16x16x32_bf16 v[108:111], v[84:87], v[48:51], v[108:111]
    ds_read_b128 v[68:71], v17 offset:2624
    v_mfma_f32_16x16x32_bf16 v[112:115], v[88:91], v[48:51], v[112:115]
    ds_read_b128 v[72:75], v17 offset:5184
    v_mfma_f32_16x16x32_bf16 v[116:119], v[80:83], v[52:55], v[116:119]
    ds_read_b128 v[76:79], v17 offset:7744
    v_mfma_f32_16x16x32_bf16 v[120:123], v[84:87], v[52:55], v[120:123]
    ds_read_b64_tr_b16 v[92:93], v18 offset:27648
    v_mfma_f32_16x16x32_bf16 v[124:127], v[88:91], v[52:55], v[124:127]
    ds_read_b64_tr_b16 v[94:95], v18 offset:28544
    v_mfma_f32_16x16x32_bf16 v[128:131], v[80:83], v[56:59], v[128:131]
    ds_read_b64_tr_b16 v[96:97], v18 offset:27680
    v_mfma_f32_16x16x32_bf16 v[132:135], v[84:87], v[56:59], v[132:135]
    ds_read_b64_tr_b16 v[98:99], v18 offset:28576
    v_mfma_f32_16x16x32_bf16 v[136:139], v[88:91], v[56:59], v[136:139]
    ds_read_b64_tr_b16 v[100:101], v18 offset:27712
    v_mfma_f32_16x16x32_bf16 v[140:143], v[80:83], v[60:63], v[140:143]
    ds_read_b64_tr_b16 v[102:103], v18 offset:28608
    v_mfma_f32_16x16x32_bf16 v[144:147], v[84:87], v[60:63], v[144:147]
    v_mfma_f32_16x16x32_bf16 v[148:151], v[88:91], v[60:63], v[148:151]
    s_waitcnt lgkmcnt(0)
    v_mfma_f32_16x16x32_bf16 v[104:107], v[92:95], v[64:67], v[104:107]
    s_waitcnt vmcnt(0)
    ds_write_b128 v10, v[20:23] offset:0
    v_mfma_f32_16x16x32_bf16 v[108:111], v[96:99], v[64:67], v[108:111]
    ds_write_b128 v10, v[24:27] offset:5120
    ds_write_b128 v10, v[28:31] offset:10240
    v_mfma_f32_16x16x32_bf16 v[112:115], v[100:103], v[64:67], v[112:115]
    ds_write_b128 v10, v[32:35] offset:15360
    ds_write_b128 v14, v[36:39] offset:20480
    v_mfma_f32_16x16x32_bf16 v[116:119], v[92:95], v[68:71], v[116:119]
    ds_write_b128 v15, v[40:43] offset:20480
    ds_write_b128 v16, v[44:47] offset:20480
    v_mfma_f32_16x16x32_bf16 v[120:123], v[96:99], v[68:71], v[120:123]
    v_add_u32 v10, 34816, v10
    v_add_u32 v14, 34816, v14
    v_mfma_f32_16x16x32_bf16 v[124:127], v[100:103], v[68:71], v[124:127]
    v_add_u32 v15, 34816, v15
    v_add_u32 v16, 34816, v16
    v_mfma_f32_16x16x32_bf16 v[128:131], v[92:95], v[72:75], v[128:131]
    buffer_load_dwordx4 v[20:23], v6, s[8:11], s34 offen
    buffer_load_dwordx4 v[24:27], v7, s[8:11], s34 offen
    v_mfma_f32_16x16x32_bf16 v[132:135], v[96:99], v[72:75], v[132:135]
    buffer_load_dwordx4 v[28:31], v8, s[8:11], s34 offen
    buffer_load_dwordx4 v[32:35], v9, s[8:11], s34 offen
    v_mfma_f32_16x16x32_bf16 v[136:139], v[100:103], v[72:75], v[136:139]
    buffer_load_dwordx4 v[36:39], v11, s[12:15], s35 offen
    buffer_load_dwordx4 v[40:43], v12, s[12:15], s35 offen
    v_mfma_f32_16x16x32_bf16 v[140:143], v[92:95], v[76:79], v[140:143]
    buffer_load_dwordx4 v[44:47], v13, s[12:15], s35 offen
    s_add_u32 s34, s34, 128
    v_mfma_f32_16x16x32_bf16 v[144:147], v[96:99], v[76:79], v[144:147]
    s_add_u32 s35, s35, 221184
    v_mfma_f32_16x16x32_bf16 v[148:151], v[100:103], v[76:79], v[148:151]
    v_add_u32 v17, 4294932480, v17
    v_add_u32 v18, 4294932480, v18
    s_waitcnt lgkmcnt(0)
    s_barrier
    ds_read_b128 v[48:51], v17 offset:0
    ds_read_b128 v[52:55], v17 offset:2560
    ds_read_b128 v[56:59], v17 offset:5120
    ds_read_b128 v[60:63], v17 offset:7680
    ds_read_b64_tr_b16 v[80:81], v18 offset:20480
    ds_read_b64_tr_b16 v[82:83], v18 offset:21376
    ds_read_b64_tr_b16 v[84:85], v18 offset:20512
    ds_read_b64_tr_b16 v[86:87], v18 offset:21408
    ds_read_b64_tr_b16 v[88:89], v18 offset:20544
    ds_read_b64_tr_b16 v[90:91], v18 offset:21440
    s_waitcnt lgkmcnt(0)
    v_mfma_f32_16x16x32_bf16 v[104:107], v[80:83], v[48:51], v[104:107]
    ds_read_b128 v[64:67], v17 offset:64
    v_mfma_f32_16x16x32_bf16 v[108:111], v[84:87], v[48:51], v[108:111]
    ds_read_b128 v[68:71], v17 offset:2624
    v_mfma_f32_16x16x32_bf16 v[112:115], v[88:91], v[48:51], v[112:115]
    ds_read_b128 v[72:75], v17 offset:5184
    v_mfma_f32_16x16x32_bf16 v[116:119], v[80:83], v[52:55], v[116:119]
    ds_read_b128 v[76:79], v17 offset:7744
    v_mfma_f32_16x16x32_bf16 v[120:123], v[84:87], v[52:55], v[120:123]
    ds_read_b64_tr_b16 v[92:93], v18 offset:27648
    v_mfma_f32_16x16x32_bf16 v[124:127], v[88:91], v[52:55], v[124:127]
    ds_read_b64_tr_b16 v[94:95], v18 offset:28544
    v_mfma_f32_16x16x32_bf16 v[128:131], v[80:83], v[56:59], v[128:131]
    ds_read_b64_tr_b16 v[96:97], v18 offset:27680
    v_mfma_f32_16x16x32_bf16 v[132:135], v[84:87], v[56:59], v[132:135]
    ds_read_b64_tr_b16 v[98:99], v18 offset:28576
    v_mfma_f32_16x16x32_bf16 v[136:139], v[88:91], v[56:59], v[136:139]
    ds_read_b64_tr_b16 v[100:101], v18 offset:27712
    v_mfma_f32_16x16x32_bf16 v[140:143], v[80:83], v[60:63], v[140:143]
    ds_read_b64_tr_b16 v[102:103], v18 offset:28608
    v_mfma_f32_16x16x32_bf16 v[144:147], v[84:87], v[60:63], v[144:147]
    v_mfma_f32_16x16x32_bf16 v[148:151], v[88:91], v[60:63], v[148:151]
    s_waitcnt lgkmcnt(0)
    v_mfma_f32_16x16x32_bf16 v[104:107], v[92:95], v[64:67], v[104:107]
    s_waitcnt vmcnt(0)
    ds_write_b128 v10, v[20:23] offset:0
    v_mfma_f32_16x16x32_bf16 v[108:111], v[96:99], v[64:67], v[108:111]
    ds_write_b128 v10, v[24:27] offset:5120
    ds_write_b128 v10, v[28:31] offset:10240
    v_mfma_f32_16x16x32_bf16 v[112:115], v[100:103], v[64:67], v[112:115]
    ds_write_b128 v10, v[32:35] offset:15360
    ds_write_b128 v14, v[36:39] offset:20480
    v_mfma_f32_16x16x32_bf16 v[116:119], v[92:95], v[68:71], v[116:119]
    ds_write_b128 v15, v[40:43] offset:20480
    ds_write_b128 v16, v[44:47] offset:20480
    v_mfma_f32_16x16x32_bf16 v[120:123], v[96:99], v[68:71], v[120:123]
    v_add_u32 v10, 4294932480, v10
    v_add_u32 v14, 4294932480, v14
    v_mfma_f32_16x16x32_bf16 v[124:127], v[100:103], v[68:71], v[124:127]
    v_add_u32 v15, 4294932480, v15
    v_add_u32 v16, 4294932480, v16
    v_mfma_f32_16x16x32_bf16 v[128:131], v[92:95], v[72:75], v[128:131]
    buffer_load_dwordx4 v[20:23], v6, s[8:11], s34 offen
    buffer_load_dwordx4 v[24:27], v7, s[8:11], s34 offen
    v_mfma_f32_16x16x32_bf16 v[132:135], v[96:99], v[72:75], v[132:135]
    buffer_load_dwordx4 v[28:31], v8, s[8:11], s34 offen
    buffer_load_dwordx4 v[32:35], v9, s[8:11], s34 offen
    v_mfma_f32_16x16x32_bf16 v[136:139], v[100:103], v[72:75], v[136:139]
    buffer_load_dwordx4 v[36:39], v11, s[12:15], s35 offen
    buffer_load_dwordx4 v[40:43], v12, s[12:15], s35 offen
    v_mfma_f32_16x16x32_bf16 v[140:143], v[92:95], v[76:79], v[140:143]
    buffer_load_dwordx4 v[44:47], v13, s[12:15], s35 offen
    s_add_u32 s34, s34, 128
    v_mfma_f32_16x16x32_bf16 v[144:147], v[96:99], v[76:79], v[144:147]
    s_add_u32 s35, s35, 221184
    v_mfma_f32_16x16x32_bf16 v[148:151], v[100:103], v[76:79], v[148:151]
    v_add_u32 v17, 34816, v17
    v_add_u32 v18, 34816, v18
    s_waitcnt lgkmcnt(0)
    s_barrier
    ds_read_b128 v[48:51], v17 offset:0
    ds_read_b128 v[52:55], v17 offset:2560
    ds_read_b128 v[56:59], v17 offset:5120
    ds_read_b128 v[60:63], v17 offset:7680
    ds_read_b64_tr_b16 v[80:81], v18 offset:20480
    ds_read_b64_tr_b16 v[82:83], v18 offset:21376
    ds_read_b64_tr_b16 v[84:85], v18 offset:20512
    ds_read_b64_tr_b16 v[86:87], v18 offset:21408
    ds_read_b64_tr_b16 v[88:89], v18 offset:20544
    ds_read_b64_tr_b16 v[90:91], v18 offset:21440
    s_waitcnt lgkmcnt(0)
    v_mfma_f32_16x16x32_bf16 v[104:107], v[80:83], v[48:51], v[104:107]
    ds_read_b128 v[64:67], v17 offset:64
    v_mfma_f32_16x16x32_bf16 v[108:111], v[84:87], v[48:51], v[108:111]
    ds_read_b128 v[68:71], v17 offset:2624
    v_mfma_f32_16x16x32_bf16 v[112:115], v[88:91], v[48:51], v[112:115]
    ds_read_b128 v[72:75], v17 offset:5184
    v_mfma_f32_16x16x32_bf16 v[116:119], v[80:83], v[52:55], v[116:119]
    ds_read_b128 v[76:79], v17 offset:7744
    v_mfma_f32_16x16x32_bf16 v[120:123], v[84:87], v[52:55], v[120:123]
    ds_read_b64_tr_b16 v[92:93], v18 offset:27648
    v_mfma_f32_16x16x32_bf16 v[124:127], v[88:91], v[52:55], v[124:127]
    ds_read_b64_tr_b16 v[94:95], v18 offset:28544
    v_mfma_f32_16x16x32_bf16 v[128:131], v[80:83], v[56:59], v[128:131]
    ds_read_b64_tr_b16 v[96:97], v18 offset:27680
    v_mfma_f32_16x16x32_bf16 v[132:135], v[84:87], v[56:59], v[132:135]
    ds_read_b64_tr_b16 v[98:99], v18 offset:28576
    v_mfma_f32_16x16x32_bf16 v[136:139], v[88:91], v[56:59], v[136:139]
    ds_read_b64_tr_b16 v[100:101], v18 offset:27712
    v_mfma_f32_16x16x32_bf16 v[140:143], v[80:83], v[60:63], v[140:143]
    ds_read_b64_tr_b16 v[102:103], v18 offset:28608
    v_mfma_f32_16x16x32_bf16 v[144:147], v[84:87], v[60:63], v[144:147]
    v_mfma_f32_16x16x32_bf16 v[148:151], v[88:91], v[60:63], v[148:151]
    s_waitcnt lgkmcnt(0)
    v_mfma_f32_16x16x32_bf16 v[104:107], v[92:95], v[64:67], v[104:107]
    s_waitcnt vmcnt(0)
    ds_write_b128 v10, v[20:23] offset:0
    v_mfma_f32_16x16x32_bf16 v[108:111], v[96:99], v[64:67], v[108:111]
    ds_write_b128 v10, v[24:27] offset:5120
    ds_write_b128 v10, v[28:31] offset:10240
    v_mfma_f32_16x16x32_bf16 v[112:115], v[100:103], v[64:67], v[112:115]
    ds_write_b128 v10, v[32:35] offset:15360
    ds_write_b128 v14, v[36:39] offset:20480
    v_mfma_f32_16x16x32_bf16 v[116:119], v[92:95], v[68:71], v[116:119]
    ds_write_b128 v15, v[40:43] offset:20480
    ds_write_b128 v16, v[44:47] offset:20480
    v_mfma_f32_16x16x32_bf16 v[120:123], v[96:99], v[68:71], v[120:123]
    v_add_u32 v10, 34816, v10
    v_add_u32 v14, 34816, v14
    v_mfma_f32_16x16x32_bf16 v[124:127], v[100:103], v[68:71], v[124:127]
    v_add_u32 v15, 34816, v15
    v_add_u32 v16, 34816, v16
    v_mfma_f32_16x16x32_bf16 v[128:131], v[92:95], v[72:75], v[128:131]
    buffer_load_dwordx4 v[20:23], v6, s[8:11], s34 offen
    buffer_load_dwordx4 v[24:27], v7, s[8:11], s34 offen
    v_mfma_f32_16x16x32_bf16 v[132:135], v[96:99], v[72:75], v[132:135]
    buffer_load_dwordx4 v[28:31], v8, s[8:11], s34 offen
    buffer_load_dwordx4 v[32:35], v9, s[8:11], s34 offen
    v_mfma_f32_16x16x32_bf16 v[136:139], v[100:103], v[72:75], v[136:139]
    buffer_load_dwordx4 v[36:39], v11, s[12:15], s35 offen
    buffer_load_dwordx4 v[40:43], v12, s[12:15], s35 offen
    v_mfma_f32_16x16x32_bf16 v[140:143], v[92:95], v[76:79], v[140:143]
    buffer_load_dwordx4 v[44:47], v13, s[12:15], s35 offen
    s_add_u32 s34, s34, 128
    v_mfma_f32_16x16x32_bf16 v[144:147], v[96:99], v[76:79], v[144:147]
    s_add_u32 s35, s35, 221184
    v_mfma_f32_16x16x32_bf16 v[148:151], v[100:103], v[76:79], v[148:151]
    v_add_u32 v17, 4294932480, v17
    v_add_u32 v18, 4294932480, v18
    s_waitcnt lgkmcnt(0)
    s_barrier
    ds_read_b128 v[48:51], v17 offset:0
    ds_read_b128 v[52:55], v17 offset:2560
    ds_read_b128 v[56:59], v17 offset:5120
    ds_read_b128 v[60:63], v17 offset:7680
    ds_read_b64_tr_b16 v[80:81], v18 offset:20480
    ds_read_b64_tr_b16 v[82:83], v18 offset:21376
    ds_read_b64_tr_b16 v[84:85], v18 offset:20512
    ds_read_b64_tr_b16 v[86:87], v18 offset:21408
    ds_read_b64_tr_b16 v[88:89], v18 offset:20544
    ds_read_b64_tr_b16 v[90:91], v18 offset:21440
    s_waitcnt lgkmcnt(0)
    v_mfma_f32_16x16x32_bf16 v[104:107], v[80:83], v[48:51], v[104:107]
    ds_read_b128 v[64:67], v17 offset:64
    v_mfma_f32_16x16x32_bf16 v[108:111], v[84:87], v[48:51], v[108:111]
    ds_read_b128 v[68:71], v17 offset:2624
    v_mfma_f32_16x16x32_bf16 v[112:115], v[88:91], v[48:51], v[112:115]
    ds_read_b128 v[72:75], v17 offset:5184
    v_mfma_f32_16x16x32_bf16 v[116:119], v[80:83], v[52:55], v[116:119]
    ds_read_b128 v[76:79], v17 offset:7744
    v_mfma_f32_16x16x32_bf16 v[120:123], v[84:87], v[52:55], v[120:123]
    ds_read_b64_tr_b16 v[92:93], v18 offset:27648
    v_mfma_f32_16x16x32_bf16 v[124:127], v[88:91], v[52:55], v[124:127]
    ds_read_b64_tr_b16 v[94:95], v18 offset:28544
    v_mfma_f32_16x16x32_bf16 v[128:131], v[80:83], v[56:59], v[128:131]
    ds_read_b64_tr_b16 v[96:97], v18 offset:27680
    v_mfma_f32_16x16x32_bf16 v[132:135], v[84:87], v[56:59], v[132:135]
    ds_read_b64_tr_b16 v[98:99], v18 offset:28576
    v_mfma_f32_16x16x32_bf16 v[136:139], v[88:91], v[56:59], v[136:139]
    ds_read_b64_tr_b16 v[100:101], v18 offset:27712
    v_mfma_f32_16x16x32_bf16 v[140:143], v[80:83], v[60:63], v[140:143]
    ds_read_b64_tr_b16 v[102:103], v18 offset:28608
    v_mfma_f32_16x16x32_bf16 v[144:147], v[84:87], v[60:63], v[144:147]
    v_mfma_f32_16x16x32_bf16 v[148:151], v[88:91], v[60:63], v[148:151]
    s_waitcnt lgkmcnt(0)
    v_mfma_f32_16x16x32_bf16 v[104:107], v[92:95], v[64:67], v[104:107]
    s_waitcnt vmcnt(0)
    ds_write_b128 v10, v[20:23] offset:0
    v_mfma_f32_16x16x32_bf16 v[108:111], v[96:99], v[64:67], v[108:111]
    ds_write_b128 v10, v[24:27] offset:5120
    ds_write_b128 v10, v[28:31] offset:10240
    v_mfma_f32_16x16x32_bf16 v[112:115], v[100:103], v[64:67], v[112:115]
    ds_write_b128 v10, v[32:35] offset:15360
    ds_write_b128 v14, v[36:39] offset:20480
    v_mfma_f32_16x16x32_bf16 v[116:119], v[92:95], v[68:71], v[116:119]
    ds_write_b128 v15, v[40:43] offset:20480
    ds_write_b128 v16, v[44:47] offset:20480
    v_mfma_f32_16x16x32_bf16 v[120:123], v[96:99], v[68:71], v[120:123]
    v_add_u32 v10, 4294932480, v10
    v_add_u32 v14, 4294932480, v14
    v_mfma_f32_16x16x32_bf16 v[124:127], v[100:103], v[68:71], v[124:127]
    v_add_u32 v15, 4294932480, v15
    v_add_u32 v16, 4294932480, v16
    v_mfma_f32_16x16x32_bf16 v[128:131], v[92:95], v[72:75], v[128:131]
    buffer_load_dwordx4 v[20:23], v6, s[8:11], s34 offen
    buffer_load_dwordx4 v[24:27], v7, s[8:11], s34 offen
    v_mfma_f32_16x16x32_bf16 v[132:135], v[96:99], v[72:75], v[132:135]
    buffer_load_dwordx4 v[28:31], v8, s[8:11], s34 offen
    buffer_load_dwordx4 v[32:35], v9, s[8:11], s34 offen
    v_mfma_f32_16x16x32_bf16 v[136:139], v[100:103], v[72:75], v[136:139]
    buffer_load_dwordx4 v[36:39], v11, s[12:15], s35 offen
    buffer_load_dwordx4 v[40:43], v12, s[12:15], s35 offen
    v_mfma_f32_16x16x32_bf16 v[140:143], v[92:95], v[76:79], v[140:143]
    buffer_load_dwordx4 v[44:47], v13, s[12:15], s35 offen
    s_add_u32 s34, s34, 128
    v_mfma_f32_16x16x32_bf16 v[144:147], v[96:99], v[76:79], v[144:147]
    s_add_u32 s35, s35, 221184
    v_mfma_f32_16x16x32_bf16 v[148:151], v[100:103], v[76:79], v[148:151]
    v_add_u32 v17, 34816, v17
    v_add_u32 v18, 34816, v18
    s_waitcnt lgkmcnt(0)
    s_barrier
    ds_read_b128 v[48:51], v17 offset:0
    ds_read_b128 v[52:55], v17 offset:2560
    ds_read_b128 v[56:59], v17 offset:5120
    ds_read_b128 v[60:63], v17 offset:7680
    ds_read_b64_tr_b16 v[80:81], v18 offset:20480
    ds_read_b64_tr_b16 v[82:83], v18 offset:21376
    ds_read_b64_tr_b16 v[84:85], v18 offset:20512
    ds_read_b64_tr_b16 v[86:87], v18 offset:21408
    ds_read_b64_tr_b16 v[88:89], v18 offset:20544
    ds_read_b64_tr_b16 v[90:91], v18 offset:21440
    s_waitcnt lgkmcnt(0)
    v_mfma_f32_16x16x32_bf16 v[104:107], v[80:83], v[48:51], v[104:107]
    ds_read_b128 v[64:67], v17 offset:64
    v_mfma_f32_16x16x32_bf16 v[108:111], v[84:87], v[48:51], v[108:111]
    ds_read_b128 v[68:71], v17 offset:2624
    v_mfma_f32_16x16x32_bf16 v[112:115], v[88:91], v[48:51], v[112:115]
    ds_read_b128 v[72:75], v17 offset:5184
    v_mfma_f32_16x16x32_bf16 v[116:119], v[80:83], v[52:55], v[116:119]
    ds_read_b128 v[76:79], v17 offset:7744
    v_mfma_f32_16x16x32_bf16 v[120:123], v[84:87], v[52:55], v[120:123]
    ds_read_b64_tr_b16 v[92:93], v18 offset:27648
    v_mfma_f32_16x16x32_bf16 v[124:127], v[88:91], v[52:55], v[124:127]
    ds_read_b64_tr_b16 v[94:95], v18 offset:28544
    v_mfma_f32_16x16x32_bf16 v[128:131], v[80:83], v[56:59], v[128:131]
    ds_read_b64_tr_b16 v[96:97], v18 offset:27680
    v_mfma_f32_16x16x32_bf16 v[132:135], v[84:87], v[56:59], v[132:135]
    ds_read_b64_tr_b16 v[98:99], v18 offset:28576
    v_mfma_f32_16x16x32_bf16 v[136:139], v[88:91], v[56:59], v[136:139]
    ds_read_b64_tr_b16 v[100:101], v18 offset:27712
    v_mfma_f32_16x16x32_bf16 v[140:143], v[80:83], v[60:63], v[140:143]
    ds_read_b64_tr_b16 v[102:103], v18 offset:28608
    v_mfma_f32_16x16x32_bf16 v[144:147], v[84:87], v[60:63], v[144:147]
    v_mfma_f32_16x16x32_bf16 v[148:151], v[88:91], v[60:63], v[148:151]
    s_waitcnt lgkmcnt(0)
    v_mfma_f32_16x16x32_bf16 v[104:107], v[92:95], v[64:67], v[104:107]
    s_waitcnt vmcnt(0)
    ds_write_b128 v10, v[20:23] offset:0
    v_mfma_f32_16x16x32_bf16 v[108:111], v[96:99], v[64:67], v[108:111]
    ds_write_b128 v10, v[24:27] offset:5120
    ds_write_b128 v10, v[28:31] offset:10240
    v_mfma_f32_16x16x32_bf16 v[112:115], v[100:103], v[64:67], v[112:115]
    ds_write_b128 v10, v[32:35] offset:15360
    ds_write_b128 v14, v[36:39] offset:20480
    v_mfma_f32_16x16x32_bf16 v[116:119], v[92:95], v[68:71], v[116:119]
    ds_write_b128 v15, v[40:43] offset:20480
    ds_write_b128 v16, v[44:47] offset:20480
    v_mfma_f32_16x16x32_bf16 v[120:123], v[96:99], v[68:71], v[120:123]
    v_add_u32 v10, 34816, v10
    v_add_u32 v14, 34816, v14
    v_mfma_f32_16x16x32_bf16 v[124:127], v[100:103], v[68:71], v[124:127]
    v_add_u32 v15, 34816, v15
    v_add_u32 v16, 34816, v16
    v_mfma_f32_16x16x32_bf16 v[128:131], v[92:95], v[72:75], v[128:131]
    buffer_load_dwordx4 v[20:23], v6, s[8:11], s34 offen
    buffer_load_dwordx4 v[24:27], v7, s[8:11], s34 offen
    v_mfma_f32_16x16x32_bf16 v[132:135], v[96:99], v[72:75], v[132:135]
    buffer_load_dwordx4 v[28:31], v8, s[8:11], s34 offen
    buffer_load_dwordx4 v[32:35], v9, s[8:11], s34 offen
    v_mfma_f32_16x16x32_bf16 v[136:139], v[100:103], v[72:75], v[136:139]
    buffer_load_dwordx4 v[36:39], v11, s[12:15], s35 offen
    buffer_load_dwordx4 v[40:43], v12, s[12:15], s35 offen
    v_mfma_f32_16x16x32_bf16 v[140:143], v[92:95], v[76:79], v[140:143]
    buffer_load_dwordx4 v[44:47], v13, s[12:15], s35 offen
    s_add_u32 s34, s34, 128
    v_mfma_f32_16x16x32_bf16 v[144:147], v[96:99], v[76:79], v[144:147]
    s_add_u32 s35, s35, 221184
    v_mfma_f32_16x16x32_bf16 v[148:151], v[100:103], v[76:79], v[148:151]
    v_add_u32 v17, 4294932480, v17
    v_add_u32 v18, 4294932480, v18
    s_waitcnt lgkmcnt(0)
    s_barrier
    ds_read_b128 v[48:51], v17 offset:0
    ds_read_b128 v[52:55], v17 offset:2560
    ds_read_b128 v[56:59], v17 offset:5120
    ds_read_b128 v[60:63], v17 offset:7680
    ds_read_b64_tr_b16 v[80:81], v18 offset:20480
    ds_read_b64_tr_b16 v[82:83], v18 offset:21376
    ds_read_b64_tr_b16 v[84:85], v18 offset:20512
    ds_read_b64_tr_b16 v[86:87], v18 offset:21408
    ds_read_b64_tr_b16 v[88:89], v18 offset:20544
    ds_read_b64_tr_b16 v[90:91], v18 offset:21440
    s_waitcnt lgkmcnt(0)
    v_mfma_f32_16x16x32_bf16 v[104:107], v[80:83], v[48:51], v[104:107]
    ds_read_b128 v[64:67], v17 offset:64
    v_mfma_f32_16x16x32_bf16 v[108:111], v[84:87], v[48:51], v[108:111]
    ds_read_b128 v[68:71], v17 offset:2624
    v_mfma_f32_16x16x32_bf16 v[112:115], v[88:91], v[48:51], v[112:115]
    ds_read_b128 v[72:75], v17 offset:5184
    v_mfma_f32_16x16x32_bf16 v[116:119], v[80:83], v[52:55], v[116:119]
    ds_read_b128 v[76:79], v17 offset:7744
    v_mfma_f32_16x16x32_bf16 v[120:123], v[84:87], v[52:55], v[120:123]
    ds_read_b64_tr_b16 v[92:93], v18 offset:27648
    v_mfma_f32_16x16x32_bf16 v[124:127], v[88:91], v[52:55], v[124:127]
    ds_read_b64_tr_b16 v[94:95], v18 offset:28544
    v_mfma_f32_16x16x32_bf16 v[128:131], v[80:83], v[56:59], v[128:131]
    ds_read_b64_tr_b16 v[96:97], v18 offset:27680
    v_mfma_f32_16x16x32_bf16 v[132:135], v[84:87], v[56:59], v[132:135]
    ds_read_b64_tr_b16 v[98:99], v18 offset:28576
    v_mfma_f32_16x16x32_bf16 v[136:139], v[88:91], v[56:59], v[136:139]
    ds_read_b64_tr_b16 v[100:101], v18 offset:27712
    v_mfma_f32_16x16x32_bf16 v[140:143], v[80:83], v[60:63], v[140:143]
    ds_read_b64_tr_b16 v[102:103], v18 offset:28608
    v_mfma_f32_16x16x32_bf16 v[144:147], v[84:87], v[60:63], v[144:147]
    v_mfma_f32_16x16x32_bf16 v[148:151], v[88:91], v[60:63], v[148:151]
    s_waitcnt lgkmcnt(0)
    v_mfma_f32_16x16x32_bf16 v[104:107], v[92:95], v[64:67], v[104:107]
    s_waitcnt vmcnt(0)
    ds_write_b128 v10, v[20:23] offset:0
    v_mfma_f32_16x16x32_bf16 v[108:111], v[96:99], v[64:67], v[108:111]
    ds_write_b128 v10, v[24:27] offset:5120
    ds_write_b128 v10, v[28:31] offset:10240
    v_mfma_f32_16x16x32_bf16 v[112:115], v[100:103], v[64:67], v[112:115]
    ds_write_b128 v10, v[32:35] offset:15360
    ds_write_b128 v14, v[36:39] offset:20480
    v_mfma_f32_16x16x32_bf16 v[116:119], v[92:95], v[68:71], v[116:119]
    ds_write_b128 v15, v[40:43] offset:20480
    ds_write_b128 v16, v[44:47] offset:20480
    v_mfma_f32_16x16x32_bf16 v[120:123], v[96:99], v[68:71], v[120:123]
    v_add_u32 v10, 4294932480, v10
    v_add_u32 v14, 4294932480, v14
    v_mfma_f32_16x16x32_bf16 v[124:127], v[100:103], v[68:71], v[124:127]
    v_add_u32 v15, 4294932480, v15
    v_add_u32 v16, 4294932480, v16
    v_mfma_f32_16x16x32_bf16 v[128:131], v[92:95], v[72:75], v[128:131]
    buffer_load_dwordx4 v[20:23], v6, s[8:11], s34 offen
    buffer_load_dwordx4 v[24:27], v7, s[8:11], s34 offen
    v_mfma_f32_16x16x32_bf16 v[132:135], v[96:99], v[72:75], v[132:135]
    buffer_load_dwordx4 v[28:31], v8, s[8:11], s34 offen
    buffer_load_dwordx4 v[32:35], v9, s[8:11], s34 offen
    v_mfma_f32_16x16x32_bf16 v[136:139], v[100:103], v[72:75], v[136:139]
    buffer_load_dwordx4 v[36:39], v11, s[12:15], s35 offen
    buffer_load_dwordx4 v[40:43], v12, s[12:15], s35 offen
    v_mfma_f32_16x16x32_bf16 v[140:143], v[92:95], v[76:79], v[140:143]
    buffer_load_dwordx4 v[44:47], v13, s[12:15], s35 offen
    s_add_u32 s34, s34, 128
    v_mfma_f32_16x16x32_bf16 v[144:147], v[96:99], v[76:79], v[144:147]
    s_add_u32 s35, s35, 221184
    v_mfma_f32_16x16x32_bf16 v[148:151], v[100:103], v[76:79], v[148:151]
    v_add_u32 v17, 34816, v17
    v_add_u32 v18, 34816, v18
    s_waitcnt lgkmcnt(0)
    s_barrier
    ds_read_b128 v[48:51], v17 offset:0
    ds_read_b128 v[52:55], v17 offset:2560
    ds_read_b128 v[56:59], v17 offset:5120
    ds_read_b128 v[60:63], v17 offset:7680
    ds_read_b64_tr_b16 v[80:81], v18 offset:20480
    ds_read_b64_tr_b16 v[82:83], v18 offset:21376
    ds_read_b64_tr_b16 v[84:85], v18 offset:20512
    ds_read_b64_tr_b16 v[86:87], v18 offset:21408
    ds_read_b64_tr_b16 v[88:89], v18 offset:20544
    ds_read_b64_tr_b16 v[90:91], v18 offset:21440
    s_waitcnt lgkmcnt(0)
    v_mfma_f32_16x16x32_bf16 v[104:107], v[80:83], v[48:51], v[104:107]
    ds_read_b128 v[64:67], v17 offset:64
    v_mfma_f32_16x16x32_bf16 v[108:111], v[84:87], v[48:51], v[108:111]
    ds_read_b128 v[68:71], v17 offset:2624
    v_mfma_f32_16x16x32_bf16 v[112:115], v[88:91], v[48:51], v[112:115]
    ds_read_b128 v[72:75], v17 offset:5184
    v_mfma_f32_16x16x32_bf16 v[116:119], v[80:83], v[52:55], v[116:119]
    ds_read_b128 v[76:79], v17 offset:7744
    v_mfma_f32_16x16x32_bf16 v[120:123], v[84:87], v[52:55], v[120:123]
    ds_read_b64_tr_b16 v[92:93], v18 offset:27648
    v_mfma_f32_16x16x32_bf16 v[124:127], v[88:91], v[52:55], v[124:127]
    ds_read_b64_tr_b16 v[94:95], v18 offset:28544
    v_mfma_f32_16x16x32_bf16 v[128:131], v[80:83], v[56:59], v[128:131]
    ds_read_b64_tr_b16 v[96:97], v18 offset:27680
    v_mfma_f32_16x16x32_bf16 v[132:135], v[84:87], v[56:59], v[132:135]
    ds_read_b64_tr_b16 v[98:99], v18 offset:28576
    v_mfma_f32_16x16x32_bf16 v[136:139], v[88:91], v[56:59], v[136:139]
    ds_read_b64_tr_b16 v[100:101], v18 offset:27712
    v_mfma_f32_16x16x32_bf16 v[140:143], v[80:83], v[60:63], v[140:143]
    ds_read_b64_tr_b16 v[102:103], v18 offset:28608
    v_mfma_f32_16x16x32_bf16 v[144:147], v[84:87], v[60:63], v[144:147]
    v_mfma_f32_16x16x32_bf16 v[148:151], v[88:91], v[60:63], v[148:151]
    s_waitcnt lgkmcnt(0)
    v_mfma_f32_16x16x32_bf16 v[104:107], v[92:95], v[64:67], v[104:107]
    s_waitcnt vmcnt(0)
    v_mfma_f32_16x16x32_bf16 v[108:111], v[96:99], v[64:67], v[108:111]
    ds_write_b128 v10, v[20:23] offset:0
    v_mfma_f32_16x16x32_bf16 v[112:115], v[100:103], v[64:67], v[112:115]
    ds_write_b128 v10, v[24:27] offset:5120
    v_mfma_f32_16x16x32_bf16 v[116:119], v[92:95], v[68:71], v[116:119]
    ds_write_b128 v10, v[28:31] offset:10240
    v_mfma_f32_16x16x32_bf16 v[120:123], v[96:99], v[68:71], v[120:123]
    ds_write_b128 v10, v[32:35] offset:15360
    v_mfma_f32_16x16x32_bf16 v[124:127], v[100:103], v[68:71], v[124:127]
    ds_write_b128 v14, v[36:39] offset:20480
    v_mfma_f32_16x16x32_bf16 v[128:131], v[92:95], v[72:75], v[128:131]
    ds_write_b128 v15, v[40:43] offset:20480
    v_mfma_f32_16x16x32_bf16 v[132:135], v[96:99], v[72:75], v[132:135]
    ds_write_b128 v16, v[44:47] offset:20480
    v_mfma_f32_16x16x32_bf16 v[136:139], v[100:103], v[72:75], v[136:139]
    v_add_u32 v10, 34816, v10
    v_mfma_f32_16x16x32_bf16 v[140:143], v[92:95], v[76:79], v[140:143]
    v_add_u32 v14, 34816, v14
    v_mfma_f32_16x16x32_bf16 v[144:147], v[96:99], v[76:79], v[144:147]
    v_add_u32 v15, 34816, v15
    v_mfma_f32_16x16x32_bf16 v[148:151], v[100:103], v[76:79], v[148:151]
    v_add_u32 v16, 34816, v16
    v_add_u32 v17, 4294932480, v17
    v_add_u32 v18, 4294932480, v18
    s_waitcnt lgkmcnt(0)
    s_barrier
    ds_read_b128 v[48:51], v17 offset:0
    ds_read_b128 v[52:55], v17 offset:2560
    ds_read_b128 v[56:59], v17 offset:5120
    ds_read_b128 v[60:63], v17 offset:7680
    ds_read_b64_tr_b16 v[80:81], v18 offset:20480
    ds_read_b64_tr_b16 v[82:83], v18 offset:21376
    ds_read_b64_tr_b16 v[84:85], v18 offset:20512
    ds_read_b64_tr_b16 v[86:87], v18 offset:21408
    ds_read_b64_tr_b16 v[88:89], v18 offset:20544
    ds_read_b64_tr_b16 v[90:91], v18 offset:21440
    s_waitcnt lgkmcnt(0)
    v_mfma_f32_16x16x32_bf16 v[104:107], v[80:83], v[48:51], v[104:107]
    ds_read_b128 v[64:67], v17 offset:64
    v_mfma_f32_16x16x32_bf16 v[108:111], v[84:87], v[48:51], v[108:111]
    ds_read_b128 v[68:71], v17 offset:2624
    v_mfma_f32_16x16x32_bf16 v[112:115], v[88:91], v[48:51], v[112:115]
    ds_read_b128 v[72:75], v17 offset:5184
    v_mfma_f32_16x16x32_bf16 v[116:119], v[80:83], v[52:55], v[116:119]
    ds_read_b128 v[76:79], v17 offset:7744
    v_mfma_f32_16x16x32_bf16 v[120:123], v[84:87], v[52:55], v[120:123]
    ds_read_b64_tr_b16 v[92:93], v18 offset:27648
    v_mfma_f32_16x16x32_bf16 v[124:127], v[88:91], v[52:55], v[124:127]
    ds_read_b64_tr_b16 v[94:95], v18 offset:28544
    v_mfma_f32_16x16x32_bf16 v[128:131], v[80:83], v[56:59], v[128:131]
    ds_read_b64_tr_b16 v[96:97], v18 offset:27680
    v_mfma_f32_16x16x32_bf16 v[132:135], v[84:87], v[56:59], v[132:135]
    ds_read_b64_tr_b16 v[98:99], v18 offset:28576
    v_mfma_f32_16x16x32_bf16 v[136:139], v[88:91], v[56:59], v[136:139]
    ds_read_b64_tr_b16 v[100:101], v18 offset:27712
    v_mfma_f32_16x16x32_bf16 v[140:143], v[80:83], v[60:63], v[140:143]
    ds_read_b64_tr_b16 v[102:103], v18 offset:28608
    v_mfma_f32_16x16x32_bf16 v[144:147], v[84:87], v[60:63], v[144:147]
    v_mfma_f32_16x16x32_bf16 v[148:151], v[88:91], v[60:63], v[148:151]
    s_waitcnt lgkmcnt(0)
    v_mfma_f32_16x16x32_bf16 v[104:107], v[92:95], v[64:67], v[104:107]
    v_mfma_f32_16x16x32_bf16 v[108:111], v[96:99], v[64:67], v[108:111]
    v_mfma_f32_16x16x32_bf16 v[112:115], v[100:103], v[64:67], v[112:115]
    v_mfma_f32_16x16x32_bf16 v[116:119], v[92:95], v[68:71], v[116:119]
    v_mfma_f32_16x16x32_bf16 v[120:123], v[96:99], v[68:71], v[120:123]
    v_mfma_f32_16x16x32_bf16 v[124:127], v[100:103], v[68:71], v[124:127]
    v_mfma_f32_16x16x32_bf16 v[128:131], v[92:95], v[72:75], v[128:131]
    v_mfma_f32_16x16x32_bf16 v[132:135], v[96:99], v[72:75], v[132:135]
    v_mfma_f32_16x16x32_bf16 v[136:139], v[100:103], v[72:75], v[136:139]
    v_mfma_f32_16x16x32_bf16 v[140:143], v[92:95], v[76:79], v[140:143]
    v_mfma_f32_16x16x32_bf16 v[144:147], v[96:99], v[76:79], v[144:147]
    v_mfma_f32_16x16x32_bf16 v[148:151], v[100:103], v[76:79], v[148:151]
    s_nop 7
    s_nop 7
    v_cvt_pk_bf16_f32 v20, v104, v105
    v_cvt_pk_bf16_f32 v21, v106, v107
    buffer_store_dwordx2 v[20:21], v19, s[16:19], 0 offen offset:0
    s_nop 1
    v_cvt_pk_bf16_f32 v20, v108, v109
    v_cvt_pk_bf16_f32 v21, v110, v111
    buffer_store_dwordx2 v[20:21], v19, s[16:19], 0 offen offset:32
    s_nop 1
    v_cvt_pk_bf16_f32 v20, v112, v113
    v_cvt_pk_bf16_f32 v21, v114, v115
    buffer_store_dwordx2 v[20:21], v19, s[16:19], 0 offen offset:64
    s_nop 1
    v_add_u32 v19, 55296, v19
    v_cvt_pk_bf16_f32 v20, v116, v117
    v_cvt_pk_bf16_f32 v21, v118, v119
    buffer_store_dwordx2 v[20:21], v19, s[16:19], 0 offen offset:0
    s_nop 1
    v_cvt_pk_bf16_f32 v20, v120, v121
    v_cvt_pk_bf16_f32 v21, v122, v123
    buffer_store_dwordx2 v[20:21], v19, s[16:19], 0 offen offset:32
    s_nop 1
    v_cvt_pk_bf16_f32 v20, v124, v125
    v_cvt_pk_bf16_f32 v21, v126, v127
    buffer_store_dwordx2 v[20:21], v19, s[16:19], 0 offen offset:64
    s_nop 1
    v_add_u32 v19, 55296, v19
    v_cvt_pk_bf16_f32 v20, v128, v129
    v_cvt_pk_bf16_f32 v21, v130, v131
    buffer_store_dwordx2 v[20:21], v19, s[16:19], 0 offen offset:0
    s_nop 1
    v_cvt_pk_bf16_f32 v20, v132, v133
    v_cvt_pk_bf16_f32 v21, v134, v135
    buffer_store_dwordx2 v[20:21], v19, s[16:19], 0 offen offset:32
    s_nop 1
    v_cvt_pk_bf16_f32 v20, v136, v137
    v_cvt_pk_bf16_f32 v21, v138, v139
    buffer_store_dwordx2 v[20:21], v19, s[16:19], 0 offen offset:64
    s_nop 1
    v_add_u32 v19, 55296, v19
    v_cvt_pk_bf16_f32 v20, v140, v141
    v_cvt_pk_bf16_f32 v21, v142, v143
    buffer_store_dwordx2 v[20:21], v19, s[16:19], 0 offen offset:0
    s_nop 1
    v_cvt_pk_bf16_f32 v20, v144, v145
    v_cvt_pk_bf16_f32 v21, v146, v147
    buffer_store_dwordx2 v[20:21], v19, s[16:19], 0 offen offset:32
    s_nop 1
    v_cvt_pk_bf16_f32 v20, v148, v149
    v_cvt_pk_bf16_f32 v21, v150, v151
    buffer_store_dwordx2 v[20:21], v19, s[16:19], 0 offen offset:64
    s_nop 1
    s_waitcnt vmcnt(0)
k_qkv_kernel_end:
    s_endpgm
.section .rodata,"a"
.p2align 6
.amdhsa_kernel k_qkv_kernel
  .amdhsa_next_free_vgpr 152
  .amdhsa_next_free_sgpr 80
  .amdhsa_accum_offset 152
  .amdhsa_group_segment_fixed_size 0
  .amdhsa_kernarg_size 88
  .amdhsa_user_sgpr_count 2
  .amdhsa_user_sgpr_kernarg_segment_ptr 1
  .amdhsa_system_sgpr_workgroup_id_x 1
.end_amdhsa_kernel
.text
.globl k_attn_kernel
.p2align 8
.type k_attn_kernel,@function
k_attn_kernel:
    s_cmp_ge_u32 s2, 512
    s_cbranch_scc1 k_attn_kernel_end
    s_load_dwordx2 s[4:5], s[0:1], 80
    s_and_b32 s6, s2, 31
    s_lshr_b32 s7, s2, 5
    s_waitcnt lgkmcnt(0)
    s_mov_b32 s8, s4
    s_mov_b32 s9, s5
    s_mov_b32 s10, 7077888
    s_mov_b32 s11, 0x00020000
    s_add_u32 s12, s4, 7077888
    s_addc_u32 s13, s5, 0
    s_mov_b32 s14, 2359296
    s_mov_b32 s15, 0x00020000
    s_mul_i32 s16, s6, 36
    s_mov_b32 s18, 0x3eae1a93
    v_and_b32 v1, 63, v0
    v_mov_b32 v16, 0
    v_mov_b32 v17, 0
    v_mov_b32 v18, 0
    v_mov_b32 v19, 0
    v_add_u32 v2, 0, v0
    v_lshlrev_b32 v2, 4, v2
    ds_write_b128 v2, v[16:19]
    v_add_u32 v2, 256, v0
    v_lshlrev_b32 v2, 4, v2
    ds_write_b128 v2, v[16:19]
    v_add_u32 v2, 512, v0
    v_lshlrev_b32 v2, 4, v2
    ds_write_b128 v2, v[16:19]
    v_add_u32 v2, 768, v0
    v_lshlrev_b32 v2, 4, v2
    ds_write_b128 v2, v[16:19]
    v_add_u32 v2, 1024, v0
    v_lshlrev_b32 v2, 4, v2
    v_cmp_gt_u32 vcc, 128, v0
    s_and_saveexec_b64 s[20:21], vcc
    ds_write_b128 v2, v[16:19]
    s_mov_b64 exec, s[20:21]
    s_waitcnt lgkmcnt(0)
    s_barrier
    v_cmp_gt_u32 vcc, 128, v0
    s_and_saveexec_b64 s[20:21], vcc
    v_lshrrev_b32 v2, 6, v0
    v_mul_u32_u24 v2, 9216, v2
    v_mul_u32_u24 v3, 64, v1
    v_add_u32 v2, v2, v3
    v_mov_b32 v3, 0x3f80
    ds_write_b16 v2, v3 offset:5156
    s_mov_b64 exec, s[20:21]
    v_lshrrev_b32 v2, 2, v0
    v_and_b32 v3, 3, v0
    v_mul_u32_u24 v6, 3456, v2
    v_add_u32 v6, s16, v6
    v_lshrrev_b32 v4, 1, v3
    v_mul_u32_u24 v5, 1152, v4
    v_add_u32 v6, v6, v5
    v_add_u32 v7, 1184, v6
    v_and_b32 v5, 1, v3
    v_lshlrev_b32 v5, 4, v5
    v_add_u32 v6, v6, v5
    v_add_u32 v6, 1152, v6
    v_mul_u32_u24 v8, 80, v2
    v_mul_u32_u24 v9, 64, v2
    v_add_u32 v9, 5120, v9
    v_cmp_eq_u32 vcc, 1, v4
    s_nop 1
    v_cndmask_b32 v8, v8, v9, vcc
    v_add_u32 v9, 32, v8
    v_add_u32 v8, v8, v5
    v_and_b32 v2, 31, v1
    v_mul_u32_u24 v10, 80, v2
    v_lshrrev_b32 v3, 5, v1
    v_lshlrev_b32 v4, 4, v3
    v_add_u32 v10, v10, v4
    v_and_b32 v2, 15, v1
    v_lshrrev_b32 v2, 2, v2
    v_lshlrev_b32 v4, 2, v3
    v_add_u32 v2, v2, v4
    v_mul_u32_u24 v11, 64, v2
    v_lshrrev_b32 v2, 4, v1
    v_and_b32 v2, 1, v2
    v_lshlrev_b32 v2, 5, v2
    v_and_b32 v4, 3, v1
    v_lshlrev_b32 v4, 3, v4
    v_add_u32 v11, v11, v2
    v_add_u32 v11, v11, v4
    v_add_u32 v11, 5120, v11
    v_lshrrev_b32 v2, 6, v0
    v_lshlrev_b32 v2, 5, v2
    v_and_b32 v4, 31, v1
    v_add_u32 v2, v2, v4
    s_lshl_b32 s20, s7, 7
    v_add_u32 v2, s20, v2
    v_mul_u32_u24 v15, 1152, v2
    v_add_u32 v15, s16, v15
    v_mul_u32_u24 v2, 3456, v2
    v_add_u32 v2, s16, v2
    v_lshlrev_b32 v4, 4, v3
    v_add_u32 v4, v2, v4
    buffer_load_dwordx4 v[24:27], v4, s[8:11], 0 offen
    buffer_load_dword v28, v2, s[8:11], 0 offen offset:32
    v_mov_b32 v29, 0
    v_mov_b32 v30, 0
    v_mov_b32 v31, 0
    s_waitcnt vmcnt(0)
    v_cmp_eq_u32 vcc, 0, v3
    s_nop 1
    v_cndmask_b32 v28, 0, v28, vcc
    v_mov_b32 v12, 0xff800000
    v_mov_b32 v112, 0
    v_mov_b32 v113, 0
    v_mov_b32 v114, 0
    v_mov_b32 v115, 0
    v_mov_b32 v116, 0
    v_mov_b32 v117, 0
    v_mov_b32 v118, 0
    v_mov_b32 v119, 0
    v_mov_b32 v120, 0
    v_mov_b32 v121, 0
    v_mov_b32 v122, 0
    v_mov_b32 v123, 0
    v_mov_b32 v124, 0
    v_mov_b32 v125, 0
    v_mov_b32 v126, 0
    v_mov_b32 v127, 0
    s_mov_b32 s17, 0
    buffer_load_dwordx4 v[16:19], v6, s[8:11], s17 offen
    buffer_load_dword v20, v7, s[8:11], s17 offen
    s_add_u32 s17, s17, 221184
    s_waitcnt vmcnt(0)
    ds_write_b128 v8, v[16:19] offset:0
    ds_write_b32 v9, v20 offset:0
    buffer_load_dwordx4 v[16:19], v6, s[8:11], s17 offen
    buffer_load_dword v20, v7, s[8:11], s17 offen
    s_add_u32 s17, s17, 221184
    s_waitcnt lgkmcnt(0)
    s_barrier
    s_mov_b32 s19, 0
k_attn_kernel_loop:
    ds_read_b128 v[32:35], v10 offset:0
    ds_read_b128 v[36:39], v10 offset:32
    ds_read_b128 v[40:43], v10 offset:2560
    ds_read_b128 v[44:47], v10 offset:2592
    ds_read_b64_tr_b16 v[48:49], v11 offset:0
    ds_read_b64_tr_b16 v[50:51], v11 offset:512
    ds_read_b64_tr_b16 v[52:53], v11 offset:1024
    ds_read_b64_tr_b16 v[54:55], v11 offset:1536
    ds_read_b64_tr_b16 v[56:57], v11 offset:2048
    ds_read_b64_tr_b16 v[58:59], v11 offset:2560
    ds_read_b64_tr_b16 v[60:61], v11 offset:3072
    ds_read_b64_tr_b16 v[62:63], v11 offset:3584
    s_waitcnt lgkmcnt(8)
    v_mfma_f32_32x32x16_bf16 v[80:95], v[32:35], v[24:27], 0
    v_mfma_f32_32x32x16_bf16 v[80:95], v[36:39], v[28:31], v[80:95]
    v_mfma_f32_32x32x16_bf16 v[96:111], v[40:43], v[24:27], 0
    v_mfma_f32_32x32x16_bf16 v[96:111], v[44:47], v[28:31], v[96:111]
    s_nop 7
    s_nop 3
    v_max3_f32 v2, v80, v81, v82
    v_max3_f32 v2, v2, v83, v84
    v_max3_f32 v2, v2, v85, v86
    v_max3_f32 v2, v2, v87, v88
    v_max3_f32 v2, v2, v89, v90
    v_max3_f32 v2, v2, v91, v92
    v_max3_f32 v2, v2, v93, v94
    v_max3_f32 v2, v2, v95, v96
    v_max3_f32 v2, v2, v97, v98
    v_max3_f32 v2, v2, v99, v100
    v_max3_f32 v2, v2, v101, v102
    v_max3_f32 v2, v2, v103, v104
    v_max3_f32 v2, v2, v105, v106
    v_max3_f32 v2, v2, v107, v108
    v_max3_f32 v2, v2, v109, v110
    v_max_f32 v2, v2, v111
    v_mov_b32 v3, v2
    s_nop 1
    v_permlane32_swap_b32 v2, v3
    s_nop 1
    v_max_f32 v2, v2, v3
    v_max_f32 v2, v2, v12
    v_sub_f32 v3, v12, v2
    v_mul_f32 v3, s18, v3
    v_exp_f32 v13, v3
    v_mov_b32 v12, v2
    v_mul_f32 v14, s18, v2
    v_fma_f32 v80, v80, s18, -v14
    v_fma_f32 v81, v81, s18, -v14
    v_fma_f32 v82, v82, s18, -v14
    v_fma_f32 v83, v83, s18, -v14
    v_fma_f32 v84, v84, s18, -v14
    v_fma_f32 v85, v85, s18, -v14
    v_fma_f32 v86, v86, s18, -v14
    v_fma_f32 v87, v87, s18, -v14
    v_fma_f32 v88, v88, s18, -v14
    v_fma_f32 v89, v89, s18, -v14
    v_fma_f32 v90, v90, s18, -v14
    v_fma_f32 v91, v91, s18, -v14
    v_fma_f32 v92, v92, s18, -v14
    v_fma_f32 v93, v93, s18, -v14
    v_fma_f32 v94, v94, s18, -v14
    v_fma_f32 v95, v95, s18, -v14
    v_fma_f32 v96, v96, s18, -v14
    v_fma_f32 v97, v97, s18, -v14
    v_fma_f32 v98, v98, s18, -v14
    v_fma_f32 v99, v99, s18, -v14
    v_fma_f32 v100, v100, s18, -v14
    v_fma_f32 v101, v101, s18, -v14
    v_fma_f32 v102, v102, s18, -v14
    v_fma_f32 v103, v103, s18, -v14
    v_fma_f32 v104, v104, s18, -v14
    v_fma_f32 v105, v105, s18, -v14
    v_fma_f32 v106, v106, s18, -v14
    v_fma_f32 v107, v107, s18, -v14
    v_fma_f32 v108, v108, s18, -v14
    v_fma_f32 v109, v109, s18, -v14
    v_fma_f32 v110, v110, s18, -v14
    v_fma_f32 v111, v111, s18, -v14
    v_exp_f32 v80, v80
    v_exp_f32 v81, v81
    v_exp_f32 v82, v82
    v_exp_f32 v83, v83
    v_exp_f32 v84, v84
    v_exp_f32 v85, v85
    v_exp_f32 v86, v86
    v_exp_f32 v87, v87
    v_exp_f32 v88, v88
    v_exp_f32 v89, v89
    v_exp_f32 v90, v90
    v_exp_f32 v91, v91
    v_exp_f32 v92, v92
    v_exp_f32 v93, v93
    v_exp_f32 v94, v94
    v_exp_f32 v95, v95
    v_exp_f32 v96, v96
    v_exp_f32 v97, v97
    v_exp_f32 v98, v98
    v_exp_f32 v99, v99
    v_exp_f32 v100, v100
    v_exp_f32 v101, v101
    v_exp_f32 v102, v102
    v_exp_f32 v103, v103
    v_exp_f32 v104, v104
    v_exp_f32 v105, v105
    v_exp_f32 v106, v106
    v_exp_f32 v107, v107
    v_exp_f32 v108, v108
    v_exp_f32 v109, v109
    v_exp_f32 v110, v110
    v_exp_f32 v111, v111
    v_mul_f32 v112, v112, v13
    v_mul_f32 v113, v113, v13
    v_mul_f32 v114, v114, v13
    v_mul_f32 v115, v115, v13
    v_mul_f32 v116, v116, v13
    v_mul_f32 v117, v117, v13
    v_mul_f32 v118, v118, v13
    v_mul_f32 v119, v119, v13
    v_mul_f32 v120, v120, v13
    v_mul_f32 v121, v121, v13
    v_mul_f32 v122, v122, v13
    v_mul_f32 v123, v123, v13
    v_mul_f32 v124, v124, v13
    v_mul_f32 v125, v125, v13
    v_mul_f32 v126, v126, v13
    v_mul_f32 v127, v127, v13
    v_cvt_pk_bf16_f32 v64, v80, v81
    v_cvt_pk_bf16_f32 v65, v82, v83
    v_cvt_pk_bf16_f32 v66, v84, v85
    v_cvt_pk_bf16_f32 v67, v86, v87
    v_cvt_pk_bf16_f32 v68, v88, v89
    v_cvt_pk_bf16_f32 v69, v90, v91
    v_cvt_pk_bf16_f32 v70, v92, v93
    v_cvt_pk_bf16_f32 v71, v94, v95
    v_cvt_pk_bf16_f32 v72, v96, v97
    v_cvt_pk_bf16_f32 v73, v98, v99
    v_cvt_pk_bf16_f32 v74, v100, v101
    v_cvt_pk_bf16_f32 v75, v102, v103
    v_cvt_pk_bf16_f32 v76, v104, v105
    v_cvt_pk_bf16_f32 v77, v106, v107
    v_cvt_pk_bf16_f32 v78, v108, v109
    v_cvt_pk_bf16_f32 v79, v110, v111
    s_waitcnt lgkmcnt(0)
    s_nop 1
    v_mfma_f32_32x32x16_bf16 v[112:127], v[48:51], v[64:67], v[112:127]
    v_mfma_f32_32x32x16_bf16 v[112:127], v[52:55], v[68:71], v[112:127]
    v_mfma_f32_32x32x16_bf16 v[112:127], v[56:59], v[72:75], v[112:127]
    v_mfma_f32_32x32x16_bf16 v[112:127], v[60:63], v[76:79], v[112:127]
    s_waitcnt vmcnt(0)
    ds_write_b128 v8, v[16:19] offset:9216
    ds_write_b32 v9, v20 offset:9216
    buffer_load_dwordx4 v[16:19], v6, s[8:11], s17 offen
    buffer_load_dword v20, v7, s[8:11], s17 offen
    s_add_u32 s17, s17, 221184
    s_waitcnt lgkmcnt(0)
    s_barrier
    ds_read_b128 v[32:35], v10 offset:9216
    ds_read_b128 v[36:39], v10 offset:9248
    ds_read_b128 v[40:43], v10 offset:11776
    ds_read_b128 v[44:47], v10 offset:11808
    ds_read_b64_tr_b16 v[48:49], v11 offset:9216
    ds_read_b64_tr_b16 v[50:51], v11 offset:9728
    ds_read_b64_tr_b16 v[52:53], v11 offset:10240
    ds_read_b64_tr_b16 v[54:55], v11 offset:10752
    ds_read_b64_tr_b16 v[56:57], v11 offset:11264
    ds_read_b64_tr_b16 v[58:59], v11 offset:11776
    ds_read_b64_tr_b16 v[60:61], v11 offset:12288
    ds_read_b64_tr_b16 v[62:63], v11 offset:12800
    s_waitcnt lgkmcnt(8)
    v_mfma_f32_32x32x16_bf16 v[80:95], v[32:35], v[24:27], 0
    v_mfma_f32_32x32x16_bf16 v[80:95], v[36:39], v[28:31], v[80:95]
    v_mfma_f32_32x32x16_bf16 v[96:111], v[40:43], v[24:27], 0
    v_mfma_f32_32x32x16_bf16 v[96:111], v[44:47], v[28:31], v[96:111]
    s_nop 7
    s_nop 3
    v_max3_f32 v2, v80, v81, v82
    v_max3_f32 v2, v2, v83, v84
    v_max3_f32 v2, v2, v85, v86
    v_max3_f32 v2, v2, v87, v88
    v_max3_f32 v2, v2, v89, v90
    v_max3_f32 v2, v2, v91, v92
    v_max3_f32 v2, v2, v93, v94
    v_max3_f32 v2, v2, v95, v96
    v_max3_f32 v2, v2, v97, v98
    v_max3_f32 v2, v2, v99, v100
    v_max3_f32 v2, v2, v101, v102
    v_max3_f32 v2, v2, v103, v104
    v_max3_f32 v2, v2, v105, v106
    v_max3_f32 v2, v2, v107, v108
    v_max3_f32 v2, v2, v109, v110
    v_max_f32 v2, v2, v111
    v_mov_b32 v3, v2
    s_nop 1
    v_permlane32_swap_b32 v2, v3
    s_nop 1
    v_max_f32 v2, v2, v3
    v_max_f32 v2, v2, v12
    v_sub_f32 v3, v12, v2
    v_mul_f32 v3, s18, v3
    v_exp_f32 v13, v3
    v_mov_b32 v12, v2
    v_mul_f32 v14, s18, v2
    v_fma_f32 v80, v80, s18, -v14
    v_fma_f32 v81, v81, s18, -v14
    v_fma_f32 v82, v82, s18, -v14
    v_fma_f32 v83, v83, s18, -v14
    v_fma_f32 v84, v84, s18, -v14
    v_fma_f32 v85, v85, s18, -v14
    v_fma_f32 v86, v86, s18, -v14
    v_fma_f32 v87, v87, s18, -v14
    v_fma_f32 v88, v88, s18, -v14
    v_fma_f32 v89, v89, s18, -v14
    v_fma_f32 v90, v90, s18, -v14
    v_fma_f32 v91, v91, s18, -v14
    v_fma_f32 v92, v92, s18, -v14
    v_fma_f32 v93, v93, s18, -v14
    v_fma_f32 v94, v94, s18, -v14
    v_fma_f32 v95, v95, s18, -v14
    v_fma_f32 v96, v96, s18, -v14
    v_fma_f32 v97, v97, s18, -v14
    v_fma_f32 v98, v98, s18, -v14
    v_fma_f32 v99, v99, s18, -v14
    v_fma_f32 v100, v100, s18, -v14
    v_fma_f32 v101, v101, s18, -v14
    v_fma_f32 v102, v102, s18, -v14
    v_fma_f32 v103, v103, s18, -v14
    v_fma_f32 v104, v104, s18, -v14
    v_fma_f32 v105, v105, s18, -v14
    v_fma_f32 v106, v106, s18, -v14
    v_fma_f32 v107, v107, s18, -v14
    v_fma_f32 v108, v108, s18, -v14
    v_fma_f32 v109, v109, s18, -v14
    v_fma_f32 v110, v110, s18, -v14
    v_fma_f32 v111, v111, s18, -v14
    v_exp_f32 v80, v80
    v_exp_f32 v81, v81
    v_exp_f32 v82, v82
    v_exp_f32 v83, v83
    v_exp_f32 v84, v84
    v_exp_f32 v85, v85
    v_exp_f32 v86, v86
    v_exp_f32 v87, v87
    v_exp_f32 v88, v88
    v_exp_f32 v89, v89
    v_exp_f32 v90, v90
    v_exp_f32 v91, v91
    v_exp_f32 v92, v92
    v_exp_f32 v93, v93
    v_exp_f32 v94, v94
    v_exp_f32 v95, v95
    v_exp_f32 v96, v96
    v_exp_f32 v97, v97
    v_exp_f32 v98, v98
    v_exp_f32 v99, v99
    v_exp_f32 v100, v100
    v_exp_f32 v101, v101
    v_exp_f32 v102, v102
    v_exp_f32 v103, v103
    v_exp_f32 v104, v104
    v_exp_f32 v105, v105
    v_exp_f32 v106, v106
    v_exp_f32 v107, v107
    v_exp_f32 v108, v108
    v_exp_f32 v109, v109
    v_exp_f32 v110, v110
    v_exp_f32 v111, v111
    v_mul_f32 v112, v112, v13
    v_mul_f32 v113, v113, v13
    v_mul_f32 v114, v114, v13
    v_mul_f32 v115, v115, v13
    v_mul_f32 v116, v116, v13
    v_mul_f32 v117, v117, v13
    v_mul_f32 v118, v118, v13
    v_mul_f32 v119, v119, v13
    v_mul_f32 v120, v120, v13
    v_mul_f32 v121, v121, v13
    v_mul_f32 v122, v122, v13
    v_mul_f32 v123, v123, v13
    v_mul_f32 v124, v124, v13
    v_mul_f32 v125, v125, v13
    v_mul_f32 v126, v126, v13
    v_mul_f32 v127, v127, v13
    v_cvt_pk_bf16_f32 v64, v80, v81
    v_cvt_pk_bf16_f32 v65, v82, v83
    v_cvt_pk_bf16_f32 v66, v84, v85
    v_cvt_pk_bf16_f32 v67, v86, v87
    v_cvt_pk_bf16_f32 v68, v88, v89
    v_cvt_pk_bf16_f32 v69, v90, v91
    v_cvt_pk_bf16_f32 v70, v92, v93
    v_cvt_pk_bf16_f32 v71, v94, v95
    v_cvt_pk_bf16_f32 v72, v96, v97
    v_cvt_pk_bf16_f32 v73, v98, v99
    v_cvt_pk_bf16_f32 v74, v100, v101
    v_cvt_pk_bf16_f32 v75, v102, v103
    v_cvt_pk_bf16_f32 v76, v104, v105
    v_cvt_pk_bf16_f32 v77, v106, v107
    v_cvt_pk_bf16_f32 v78, v108, v109
    v_cvt_pk_bf16_f32 v79, v110, v111
    s_waitcnt lgkmcnt(0)
    s_nop 1
    v_mfma_f32_32x32x16_bf16 v[112:127], v[48:51], v[64:67], v[112:127]
    v_mfma_f32_32x32x16_bf16 v[112:127], v[52:55], v[68:71], v[112:127]
    v_mfma_f32_32x32x16_bf16 v[112:127], v[56:59], v[72:75], v[112:127]
    v_mfma_f32_32x32x16_bf16 v[112:127], v[60:63], v[76:79], v[112:127]
    s_add_u32 s19, s19, 2
    s_cmp_ge_u32 s19, 32
    s_cbranch_scc1 k_attn_kernel_fin
    s_waitcnt vmcnt(0)
    ds_write_b128 v8, v[16:19] offset:0
    ds_write_b32 v9, v20 offset:0
    buffer_load_dwordx4 v[16:19], v6, s[8:11], s17 offen
    buffer_load_dword v20, v7, s[8:11], s17 offen
    s_add_u32 s17, s17, 221184
    s_waitcnt lgkmcnt(0)
    s_barrier
    s_branch k_attn_kernel_loop
k_attn_kernel_fin:
    s_waitcnt vmcnt(0)
    s_nop 7
    s_nop 7
    v_mov_b32 v2, v122
    v_mov_b32 v3, v122
    s_nop 1
    v_permlane32_swap_b32 v2, v3
    s_nop 1
    v_rcp_f32 v2, v2
    s_nop 0
    v_mul_f32 v112, v112, v2
    v_mul_f32 v113, v113, v2
    v_mul_f32 v114, v114, v2
    v_mul_f32 v115, v115, v2
    v_mul_f32 v116, v116, v2
    v_mul_f32 v117, v117, v2
    v_mul_f32 v118, v118, v2
    v_mul_f32 v119, v119, v2
    v_mul_f32 v120, v120, v2
    v_mul_f32 v121, v121, v2
    v_cvt_pk_bf16_f32 v64, v112, v113
    v_cvt_pk_bf16_f32 v65, v114, v115
    v_cvt_pk_bf16_f32 v66, v116, v117
    v_cvt_pk_bf16_f32 v67, v118, v119
    v_cvt_pk_bf16_f32 v68, v120, v121
    v_lshrrev_b32 v3, 5, v1
    v_lshlrev_b32 v3, 3, v3
    v_add_u32 v3, v15, v3
    buffer_store_dwordx2 v[64:65], v3, s[12:15], 0 offen
    buffer_store_dwordx2 v[66:67], v3, s[12:15], 0 offen offset:16
    v_cmp_gt_u32 vcc, 32, v1
    s_and_saveexec_b64 s[20:21], vcc
    buffer_store_dword v68, v3, s[12:15], 0 offen offset:32
    s_waitcnt vmcnt(0)
k_attn_kernel_end:
    s_endpgm
.section .rodata,"a"
.p2align 6
.amdhsa_kernel k_attn_kernel
  .amdhsa_next_free_vgpr 128
  .amdhsa_next_free_sgpr 32
  .amdhsa_accum_offset 128
  .amdhsa_group_segment_fixed_size 0
  .amdhsa_kernarg_size 88
  .amdhsa_user_sgpr_count 2
  .amdhsa_user_sgpr_kernarg_segment_ptr 1
  .amdhsa_system_sgpr_workgroup_id_x 1
.end_amdhsa_kernel
.text
.globl k_wo_kernel
.p2align 8
.type k_wo_kernel,@function
k_wo_kernel:
    s_cmp_ge_u32 s2, 288
    s_cbranch_scc1 k_wo_kernel_end
    s_load_dwordx2 s[36:37], s[0:1], 80
    s_load_dwordx2 s[38:39], s[0:1], 16
    s_load_dwordx2 s[40:41], s[0:1], 0
    s_mov_b32 s3, 0
    s_mov_b32 s6, s2
    s_mul_i32 s4, s6, 57
    s_lshr_b32 s4, s4, 9
    s_mul_i32 s5, s4, 9
    s_sub_u32 s5, s6, s5
    s_waitcnt lgkmcnt(0)
    s_add_u32 s8, s36, 7077888
    s_addc_u32 s9, s37, 0
    s_mov_b32 s10, 2359296
    s_mov_b32 s11, 0x00020000
    s_mov_b32 s12, s38
    s_mov_b32 s13, s39
    s_mov_b32 s14, 663552
    s_mov_b32 s15, 0x00020000
    s_add_u32 s16, s36, 9437184
    s_addc_u32 s17, s37, 0
    s_mov_b32 s18, 2359296
    s_mov_b32 s19, 0x00020000
    s_mov_b32 s20, s40
    s_mov_b32 s21, s41
    s_mov_b32 s22, 2359296
    s_mov_b32 s23, 0x00020000
    s_mul_i32 s32, s4, 64
    s_mul_i32 s33, s5, 64
    s_mul_i32 s34, s3, 1152
    s_mul_i32 s35, s3, 663552
    v_and_b32 v5, 63, v0
    v_lshrrev_b32 v1, 3, v0
    v_and_b32 v2, 7, v0
    v_lshlrev_b32 v2, 4, v2
    v_mul_u32_u24 v8, 160, v1
    v_add_u32 v8, v8, v2
    v_add_u32 v3, s32, v1
    v_mul_u32_u24 v3, 1152, v3
    v_add_u32 v6, v3, v2
    v_add_u32 v7, 36864, v6
    v_add_u32 v1, 0, v0
    v_mul_u32_u24 v2, 32, v1
    v_lshrrev_b32 v2, 8, v2
    v_mul_u32_u24 v3, 8, v2
    v_sub_u32 v3, v1, v3
    v_lshlrev_b32 v3, 4, v3
    v_mul_u32_u24 v11, 160, v2
    v_add_u32 v11, v11, v3
    v_mul_u32_u24 v9, 1152, v2
    v_add_u32 v9, v9, v3
    v_mov_b32 v4, s33
    v_lshlrev_b32 v4, 1, v4
    v_add_u32 v9, v9, v4
    v_add_u32 v1, 256, v0
    v_mul_u32_u24 v2, 32, v1
    v_lshrrev_b32 v2, 8, v2
    v_mul_u32_u24 v3, 8, v2
    v_sub_u32 v3, v1, v3
    v_lshlrev_b32 v3, 4, v3
    v_mul_u32_u24 v12, 160, v2
    v_add_u32 v12, v12, v3
    v_mul_u32_u24 v10, 1152, v2
    v_add_u32 v10, v10, v3
    v_mov_b32 v4, s33
    v_lshlrev_b32 v4, 1, v4
    v_add_u32 v10, v10, v4
    v_lshrrev_b32 v1, 7, v0
    v_mul_u32_u24 v1, 32, v1
    v_and_b32 v2, 15, v0
    v_add_u32 v1, v1, v2
    v_mul_u32_u24 v13, 160, v1
    v_lshrrev_b32 v2, 4, v5
    v_lshlrev_b32 v3, 4, v2
    v_add_u32 v13, v13, v3
    v_add_u32 v1, s32, v1
    v_mul_u32_u24 v15, 1152, v1
    v_lshrrev_b32 v4, 6, v0
    v_and_b32 v4, 1, v4
    v_mul_u32_u24 v4, 32, v4
    v_lshlrev_b32 v3, 2, v2
    v_add_u32 v3, v3, v4
    v_add_u32 v3, s33, v3
    v_mul_u32_u24 v3, 2, v3
    v_add_u32 v15, v15, v3
    v_and_b32 v1, 15, v0
    v_lshrrev_b32 v1, 2, v1
    v_lshlrev_b32 v3, 3, v2
    v_add_u32 v1, v1, v3
    v_mul_u32_u24 v14, 160, v1
    v_and_b32 v1, 3, v0
    v_lshlrev_b32 v1, 3, v1
    v_add_u32 v14, v14, v1
    v_lshlrev_b32 v4, 1, v4
    v_add_u32 v14, v14, v4
    v_mov_b32 v64, 0
    v_mov_b32 v65, 0
    v_mov_b32 v66, 0
    v_mov_b32 v67, 0
    v_mov_b32 v68, 0
    v_mov_b32 v69, 0
    v_mov_b32 v70, 0
    v_mov_b32 v71, 0
    v_mov_b32 v72, 0
    v_mov_b32 v73, 0
    v_mov_b32 v74, 0
    v_mov_b32 v75, 0
    v_mov_b32 v76, 0
    v_mov_b32 v77, 0
    v_mov_b32 v78, 0
    v_mov_b32 v79, 0
    buffer_load_dwordx4 v[16:19], v6, s[8:11], s34 offen
    buffer_load_dwordx4 v[20:23], v7, s[8:11], s34 offen
    buffer_load_dwordx4 v[24:27], v9, s[12:15], s35 offen
    buffer_load_dwordx4 v[28:31], v10, s[12:15], s35 offen
    s_add_u32 s34, s34, 128
    s_add_u32 s35, s35, 73728
    s_waitcnt vmcnt(0)
    ds_write_b128 v8, v[16:19] offset:0
    ds_write_b128 v8, v[20:23] offset:5120
    ds_write_b128 v11, v[24:27] offset:10240
    ds_write_b128 v12, v[28:31] offset:10240
    v_add_u32 v8, 20480, v8
    v_add_u32 v11, 20480, v11
    v_add_u32 v12, 20480, v12
    buffer_load_dwordx4 v[16:19], v6, s[8:11], s34 offen
    buffer_load_dwordx4 v[20:23], v7, s[8:11], s34 offen
    buffer_load_dwordx4 v[24:27], v9, s[12:15], s35 offen
    buffer_load_dwordx4 v[28:31], v10, s[12:15], s35 offen
    s_add_u32 s34, s34, 128
    s_add_u32 s35, s35, 73728
    s_waitcnt lgkmcnt(0)
    s_barrier
    ds_read_b128 v[32:35], v13 offset:0
    ds_read_b128 v[36:39], v13 offset:2560
    ds_read_b64_tr_b16 v[48:49], v14 offset:10240
    ds_read_b64_tr_b16 v[50:51], v14 offset:10880
    ds_read_b64_tr_b16 v[52:53], v14 offset:10272
    ds_read_b64_tr_b16 v[54:55], v14 offset:10912
    s_waitcnt lgkmcnt(0)
    v_mfma_f32_16x16x32_bf16 v[64:67], v[48:51], v[32:35], v[64:67]
    ds_read_b128 v[40:43], v13 offset:64
    ds_read_b128 v[44:47], v13 offset:2624
    v_mfma_f32_16x16x32_bf16 v[68:71], v[52:55], v[32:35], v[68:71]
    ds_read_b64_tr_b16 v[56:57], v14 offset:15360
    ds_read_b64_tr_b16 v[58:59], v14 offset:16000
    v_mfma_f32_16x16x32_bf16 v[72:75], v[48:51], v[36:39], v[72:75]
    ds_read_b64_tr_b16 v[60:61], v14 offset:15392
    ds_read_b64_tr_b16 v[62:63], v14 offset:16032
    v_mfma_f32_16x16x32_bf16 v[76:79], v[52:55], v[36:39], v[76:79]
    s_waitcnt lgkmcnt(0)
    v_mfma_f32_16x16x32_bf16 v[64:67], v[56:59], v[40:43], v[64:67]
    s_waitcnt vmcnt(0)
    ds_write_b128 v8, v[16:19] offset:0
    ds_write_b128 v8, v[20:23] offset:5120
    ds_write_b128 v11, v[24:27] offset:10240
    v_mfma_f32_16x16x32_bf16 v[68:71], v[60:63], v[40:43], v[68:71]
    ds_write_b128 v12, v[28:31] offset:10240
    v_add_u32 v8, 4294946816, v8
    v_add_u32 v11, 4294946816, v11
    v_add_u32 v12, 4294946816, v12
    v_mfma_f32_16x16x32_bf16 v[72:75], v[56:59], v[44:47], v[72:75]
    buffer_load_dwordx4 v[16:19], v6, s[8:11], s34 offen
    buffer_load_dwordx4 v[20:23], v7, s[8:11], s34 offen
    buffer_load_dwordx4 v[24:27], v9, s[12:15], s35 offen
    buffer_load_dwordx4 v[28:31], v10, s[12:15], s35 offen
    v_mfma_f32_16x16x32_bf16 v[76:79], v[60:63], v[44:47], v[76:79]
    s_add_u32 s34, s34, 128
    s_add_u32 s35, s35, 73728
    v_add_u32 v13, 20480, v13
    v_add_u32 v14, 20480, v14
    s_waitcnt lgkmcnt(0)
    s_barrier
    ds_read_b128 v[32:35], v13 offset:0
    ds_read_b128 v[36:39], v13 offset:2560
    ds_read_b64_tr_b16 v[48:49], v14 offset:10240
    ds_read_b64_tr_b16 v[50:51], v14 offset:10880
    ds_read_b64_tr_b16 v[52:53], v14 offset:10272
    ds_read_b64_tr_b16 v[54:55], v14 offset:10912
    s_waitcnt lgkmcnt(0)
    v_mfma_f32_16x16x32_bf16 v[64:67], v[48:51], v[32:35], v[64:67]
    ds_read_b128 v[40:43], v13 offset:64
    ds_read_b128 v[44:47], v13 offset:2624
    v_mfma_f32_16x16x32_bf16 v[68:71], v[52:55], v[32:35], v[68:71]
    ds_read_b64_tr_b16 v[56:57], v14 offset:15360
    ds_read_b64_tr_b16 v[58:59], v14 offset:16000
    v_mfma_f32_16x16x32_bf16 v[72:75], v[48:51], v[36:39], v[72:75]
    ds_read_b64_tr_b16 v[60:61], v14 offset:15392
    ds_read_b64_tr_b16 v[62:63], v14 offset:16032
    v_mfma_f32_16x16x32_bf16 v[76:79], v[52:55], v[36:39], v[76:79]
    s_waitcnt lgkmcnt(0)
    v_mfma_f32_16x16x32_bf16 v[64:67], v[56:59], v[40:43], v[64:67]
    s_waitcnt vmcnt(0)
    ds_write_b128 v8, v[16:19] offset:0
    ds_write_b128 v8, v[20:23] offset:5120
    ds_write_b128 v11, v[24:27] offset:10240
    v_mfma_f32_16x16x32_bf16 v[68:71], v[60:63], v[40:43], v[68:71]
    ds_write_b128 v12, v[28:31] offset:10240
    v_add_u32 v8, 20480, v8
    v_add_u32 v11, 20480, v11
    v_add_u32 v12, 20480, v12
    v_mfma_f32_16x16x32_bf16 v[72:75], v[56:59], v[44:47], v[72:75]
    buffer_load_dwordx4 v[16:19], v6, s[8:11], s34 offen
    buffer_load_dwordx4 v[20:23], v7, s[8:11], s34 offen
    buffer_load_dwordx4 v[24:27], v9, s[12:15], s35 offen
    buffer_load_dwordx4 v[28:31], v10, s[12:15], s35 offen
    v_mfma_f32_16x16x32_bf16 v[76:79], v[60:63], v[44:47], v[76:79]
    s_add_u32 s34, s34, 128
    s_add_u32 s35, s35, 73728
    v_add_u32 v13, 4294946816, v13
    v_add_u32 v14, 4294946816, v14
    s_waitcnt lgkmcnt(0)
    s_barrier
    ds_read_b128 v[32:35], v13 offset:0
    ds_read_b128 v[36:39], v13 offset:2560
    ds_read_b64_tr_b16 v[48:49], v14 offset:10240
    ds_read_b64_tr_b16 v[50:51], v14 offset:10880
    ds_read_b64_tr_b16 v[52:53], v14 offset:10272
    ds_read_b64_tr_b16 v[54:55], v14 offset:10912
    s_waitcnt lgkmcnt(0)
    v_mfma_f32_16x16x32_bf16 v[64:67], v[48:51], v[32:35], v[64:67]
    ds_read_b128 v[40:43], v13 offset:64
    ds_read_b128 v[44:47], v13 offset:2624
    v_mfma_f32_16x16x32_bf16 v[68:71], v[52:55], v[32:35], v[68:71]
    ds_read_b64_tr_b16 v[56:57], v14 offset:15360
    ds_read_b64_tr_b16 v[58:59], v14 offset:16000
    v_mfma_f32_16x16x32_bf16 v[72:75], v[48:51], v[36:39], v[72:75]
    ds_read_b64_tr_b16 v[60:61], v14 offset:15392
    ds_read_b64_tr_b16 v[62:63], v14 offset:16032
    v_mfma_f32_16x16x32_bf16 v[76:79], v[52:55], v[36:39], v[76:79]
    s_waitcnt lgkmcnt(0)
    v_mfma_f32_16x16x32_bf16 v[64:67], v[56:59], v[40:43], v[64:67]
    s_waitcnt vmcnt(0)
    ds_write_b128 v8, v[16:19] offset:0
    ds_write_b128 v8, v[20:23] offset:5120
    ds_write_b128 v11, v[24:27] offset:10240
    v_mfma_f32_16x16x32_bf16 v[68:71], v[60:63], v[40:43], v[68:71]
    ds_write_b128 v12, v[28:31] offset:10240
    v_add_u32 v8, 4294946816, v8
    v_add_u32 v11, 4294946816, v11
    v_add_u32 v12, 4294946816, v12
    v_mfma_f32_16x16x32_bf16 v[72:75], v[56:59], v[44:47], v[72:75]
    buffer_load_dwordx4 v[16:19], v6, s[8:11], s34 offen
    buffer_load_dwordx4 v[20:23], v7, s[8:11], s34 offen
    buffer_load_dwordx4 v[24:27], v9, s[12:15], s35 offen
    buffer_load_dwordx4 v[28:31], v10, s[12:15], s35 offen
    v_mfma_f32_16x16x32_bf16 v[76:79], v[60:63], v[44:47], v[76:79]
    s_add_u32 s34, s34, 128
    s_add_u32 s35, s35, 73728
    v_add_u32 v13, 20480, v13
    v_add_u32 v14, 20480, v14
    s_waitcnt lgkmcnt(0)
    s_barrier
    ds_read_b128 v[32:35], v13 offset:0
    ds_read_b128 v[36:39], v13 offset:2560
    ds_read_b64_tr_b16 v[48:49], v14 offset:10240
    ds_read_b64_tr_b16 v[50:51], v14 offset:10880
    ds_read_b64_tr_b16 v[52:53], v14 offset:10272
    ds_read_b64_tr_b16 v[54:55], v14 offset:10912
    s_waitcnt lgkmcnt(0)
    v_mfma_f32_16x16x32_bf16 v[64:67], v[48:51], v[32:35], v[64:67]
    ds_read_b128 v[40:43], v13 offset:64
    ds_read_b128 v[44:47], v13 offset:2624
    v_mfma_f32_16x16x32_bf16 v[68:71], v[52:55], v[32:35], v[68:71]
    ds_read_b64_tr_b16 v[56:57], v14 offset:15360
    ds_read_b64_tr_b16 v[58:59], v14 offset:16000
    v_mfma_f32_16x16x32_bf16 v[72:75], v[48:51], v[36:39], v[72:75]
    ds_read_b64_tr_b16 v[60:61], v14 offset:15392
    ds_read_b64_tr_b16 v[62:63], v14 offset:16032
    v_mfma_f32_16x16x32_bf16 v[76:79], v[52:55], v[36:39], v[76:79]
    s_waitcnt lgkmcnt(0)
    v_mfma_f32_16x16x32_bf16 v[64:67], v[56:59], v[40:43], v[64:67]
    s_waitcnt vmcnt(0)
    ds_write_b128 v8, v[16:19] offset:0
    ds_write_b128 v8, v[20:23] offset:5120
    ds_write_b128 v11, v[24:27] offset:10240
    v_mfma_f32_16x16x32_bf16 v[68:71], v[60:63], v[40:43], v[68:71]
    ds_write_b128 v12, v[28:31] offset:10240
    v_add_u32 v8, 20480, v8
    v_add_u32 v11, 20480, v11
    v_add_u32 v12, 20480, v12
    v_mfma_f32_16x16x32_bf16 v[72:75], v[56:59], v[44:47], v[72:75]
    buffer_load_dwordx4 v[16:19], v6, s[8:11], s34 offen
    buffer_load_dwordx4 v[20:23], v7, s[8:11], s34 offen
    buffer_load_dwordx4 v[24:27], v9, s[12:15], s35 offen
    buffer_load_dwordx4 v[28:31], v10, s[12:15], s35 offen
    v_mfma_f32_16x16x32_bf16 v[76:79], v[60:63], v[44:47], v[76:79]
    s_add_u32 s34, s34, 128
    s_add_u32 s35, s35, 73728
    v_add_u32 v13, 4294946816, v13
    v_add_u32 v14, 4294946816, v14
    s_waitcnt lgkmcnt(0)
    s_barrier
    ds_read_b128 v[32:35], v13 offset:0
    ds_read_b128 v[36:39], v13 offset:2560
    ds_read_b64_tr_b16 v[48:49], v14 offset:10240
    ds_read_b64_tr_b16 v[50:51], v14 offset:10880
    ds_read_b64_tr_b16 v[52:53], v14 offset:10272
    ds_read_b64_tr_b16 v[54:55], v14 offset:10912
    s_waitcnt lgkmcnt(0)
    v_mfma_f32_16x16x32_bf16 v[64:67], v[48:51], v[32:35], v[64:67]
    ds_read_b128 v[40:43], v13 offset:64
    ds_read_b128 v[44:47], v13 offset:2624
    v_mfma_f32_16x16x32_bf16 v[68:71], v[52:55], v[32:35], v[68:71]
    ds_read_b64_tr_b16 v[56:57], v14 offset:15360
    ds_read_b64_tr_b16 v[58:59], v14 offset:16000
    v_mfma_f32_16x16x32_bf16 v[72:75], v[48:51], v[36:39], v[72:75]
    ds_read_b64_tr_b16 v[60:61], v14 offset:15392
    ds_read_b64_tr_b16 v[62:63], v14 offset:16032
    v_mfma_f32_16x16x32_bf16 v[76:79], v[52:55], v[36:39], v[76:79]
    s_waitcnt lgkmcnt(0)
    v_mfma_f32_16x16x32_bf16 v[64:67], v[56:59], v[40:43], v[64:67]
    s_waitcnt vmcnt(0)
    ds_write_b128 v8, v[16:19] offset:0
    ds_write_b128 v8, v[20:23] offset:5120
    ds_write_b128 v11, v[24:27] offset:10240
    v_mfma_f32_16x16x32_bf16 v[68:71], v[60:63], v[40:43], v[68:71]
    ds_write_b128 v12, v[28:31] offset:10240
    v_add_u32 v8, 4294946816, v8
    v_add_u32 v11, 4294946816, v11
    v_add_u32 v12, 4294946816, v12
    v_mfma_f32_16x16x32_bf16 v[72:75], v[56:59], v[44:47], v[72:75]
    buffer_load_dwordx4 v[16:19], v6, s[8:11], s34 offen
    buffer_load_dwordx4 v[20:23], v7, s[8:11], s34 offen
    buffer_load_dwordx4 v[24:27], v9, s[12:15], s35 offen
    buffer_load_dwordx4 v[28:31], v10, s[12:15], s35 offen
    v_mfma_f32_16x16x32_bf16 v[76:79], v[60:63], v[44:47], v[76:79]
    s_add_u32 s34, s34, 128
    s_add_u32 s35, s35, 73728
    v_add_u32 v13, 20480, v13
    v_add_u32 v14, 20480, v14
    s_waitcnt lgkmcnt(0)
    s_barrier
    ds_read_b128 v[32:35], v13 offset:0
    ds_read_b128 v[36:39], v13 offset:2560
    ds_read_b64_tr_b16 v[48:49], v14 offset:10240
    ds_read_b64_tr_b16 v[50:51], v14 offset:10880
    ds_read_b64_tr_b16 v[52:53], v14 offset:10272
    ds_read_b64_tr_b16 v[54:55], v14 offset:10912
    s_waitcnt lgkmcnt(0)
    v_mfma_f32_16x16x32_bf16 v[64:67], v[48:51], v[32:35], v[64:67]
    ds_read_b128 v[40:43], v13 offset:64
    ds_read_b128 v[44:47], v13 offset:2624
    v_mfma_f32_16x16x32_bf16 v[68:71], v[52:55], v[32:35], v[68:71]
    ds_read_b64_tr_b16 v[56:57], v14 offset:15360
    ds_read_b64_tr_b16 v[58:59], v14 offset:16000
    v_mfma_f32_16x16x32_bf16 v[72:75], v[48:51], v[36:39], v[72:75]
    ds_read_b64_tr_b16 v[60:61], v14 offset:15392
    ds_read_b64_tr_b16 v[62:63], v14 offset:16032
    v_mfma_f32_16x16x32_bf16 v[76:79], v[52:55], v[36:39], v[76:79]
    s_waitcnt lgkmcnt(0)
    v_mfma_f32_16x16x32_bf16 v[64:67], v[56:59], v[40:43], v[64:67]
    s_waitcnt vmcnt(0)
    ds_write_b128 v8, v[16:19] offset:0
    ds_write_b128 v8, v[20:23] offset:5120
    ds_write_b128 v11, v[24:27] offset:10240
    v_mfma_f32_16x16x32_bf16 v[68:71], v[60:63], v[40:43], v[68:71]
    ds_write_b128 v12, v[28:31] offset:10240
    v_add_u32 v8, 20480, v8
    v_add_u32 v11, 20480, v11
    v_add_u32 v12, 20480, v12
    v_mfma_f32_16x16x32_bf16 v[72:75], v[56:59], v[44:47], v[72:75]
    buffer_load_dwordx4 v[16:19], v6, s[8:11], s34 offen
    buffer_load_dwordx4 v[20:23], v7, s[8:11], s34 offen
    buffer_load_dwordx4 v[24:27], v9, s[12:15], s35 offen
    buffer_load_dwordx4 v[28:31], v10, s[12:15], s35 offen
    v_mfma_f32_16x16x32_bf16 v[76:79], v[60:63], v[44:47], v[76:79]
    s_add_u32 s34, s34, 128
    s_add_u32 s35, s35, 73728
    v_add_u32 v13, 4294946816, v13
    v_add_u32 v14, 4294946816, v14
    s_waitcnt lgkmcnt(0)
    s_barrier
    ds_read_b128 v[32:35], v13 offset:0
    ds_read_b128 v[36:39], v13 offset:2560
    ds_read_b64_tr_b16 v[48:49], v14 offset:10240
    ds_read_b64_tr_b16 v[50:51], v14 offset:10880
    ds_read_b64_tr_b16 v[52:53], v14 offset:10272
    ds_read_b64_tr_b16 v[54:55], v14 offset:10912
    s_waitcnt lgkmcnt(0)
    v_mfma_f32_16x16x32_bf16 v[64:67], v[48:51], v[32:35], v[64:67]
    ds_read_b128 v[40:43], v13 offset:64
    ds_read_b128 v[44:47], v13 offset:2624
    v_mfma_f32_16x16x32_bf16 v[68:71], v[52:55], v[32:35], v[68:71]
    ds_read_b64_tr_b16 v[56:57], v14 offset:15360
    ds_read_b64_tr_b16 v[58:59], v14 offset:16000
    v_mfma_f32_16x16x32_bf16 v[72:75], v[48:51], v[36:39], v[72:75]
    ds_read_b64_tr_b16 v[60:61], v14 offset:15392
    ds_read_b64_tr_b16 v[62:63], v14 offset:16032
    v_mfma_f32_16x16x32_bf16 v[76:79], v[52:55], v[36:39], v[76:79]
    s_waitcnt lgkmcnt(0)
    v_mfma_f32_16x16x32_bf16 v[64:67], v[56:59], v[40:43], v[64:67]
    s_waitcnt vmcnt(0)
    ds_write_b128 v8, v[16:19] offset:0
    ds_write_b128 v8, v[20:23] offset:5120
    ds_write_b128 v11, v[24:27] offset:10240
    v_mfma_f32_16x16x32_bf16 v[68:71], v[60:63], v[40:43], v[68:71]
    ds_write_b128 v12, v[28:31] offset:10240
    v_add_u32 v8, 4294946816, v8
    v_add_u32 v11, 4294946816, v11
    v_add_u32 v12, 4294946816, v12
    v_mfma_f32_16x16x32_bf16 v[72:75], v[56:59], v[44:47], v[72:75]
    buffer_load_dwordx4 v[16:19], v6, s[8:11], s34 offen
    buffer_load_dwordx4 v[20:23], v7, s[8:11], s34 offen
    buffer_load_dwordx4 v[24:27], v9, s[12:15], s35 offen
    buffer_load_dwordx4 v[28:31], v10, s[12:15], s35 offen
    v_mfma_f32_16x16x32_bf16 v[76:79], v[60:63], v[44:47], v[76:79]
    s_add_u32 s34, s34, 128
    s_add_u32 s35, s35, 73728
    v_add_u32 v13, 20480, v13
    v_add_u32 v14, 20480, v14
    s_waitcnt lgkmcnt(0)
    s_barrier
    ds_read_b128 v[32:35], v13 offset:0
    ds_read_b128 v[36:39], v13 offset:2560
    ds_read_b64_tr_b16 v[48:49], v14 offset:10240
    ds_read_b64_tr_b16 v[50:51], v14 offset:10880
    ds_read_b64_tr_b16 v[52:53], v14 offset:10272
    ds_read_b64_tr_b16 v[54:55], v14 offset:10912
    s_waitcnt lgkmcnt(0)
    v_mfma_f32_16x16x32_bf16 v[64:67], v[48:51], v[32:35], v[64:67]
    ds_read_b128 v[40:43], v13 offset:64
    ds_read_b128 v[44:47], v13 offset:2624
    v_mfma_f32_16x16x32_bf16 v[68:71], v[52:55], v[32:35], v[68:71]
    ds_read_b64_tr_b16 v[56:57], v14 offset:15360
    ds_read_b64_tr_b16 v[58:59], v14 offset:16000
    v_mfma_f32_16x16x32_bf16 v[72:75], v[48:51], v[36:39], v[72:75]
    ds_read_b64_tr_b16 v[60:61], v14 offset:15392
    ds_read_b64_tr_b16 v[62:63], v14 offset:16032
    v_mfma_f32_16x16x32_bf16 v[76:79], v[52:55], v[36:39], v[76:79]
    s_waitcnt lgkmcnt(0)
    v_mfma_f32_16x16x32_bf16 v[64:67], v[56:59], v[40:43], v[64:67]
    s_waitcnt vmcnt(0)
    ds_write_b128 v8, v[16:19] offset:0
    v_mfma_f32_16x16x32_bf16 v[68:71], v[60:63], v[40:43], v[68:71]
    ds_write_b128 v8, v[20:23] offset:5120
    ds_write_b128 v11, v[24:27] offset:10240
    v_mfma_f32_16x16x32_bf16 v[72:75], v[56:59], v[44:47], v[72:75]
    ds_write_b128 v12, v[28:31] offset:10240
    v_add_u32 v8, 20480, v8
    v_mfma_f32_16x16x32_bf16 v[76:79], v[60:63], v[44:47], v[76:79]
    v_add_u32 v11, 20480, v11
    v_add_u32 v12, 20480, v12
    v_add_u32 v13, 4294946816, v13
    v_add_u32 v14, 4294946816, v14
    s_waitcnt lgkmcnt(0)
    s_barrier
    ds_read_b128 v[32:35], v13 offset:0
    ds_read_b128 v[36:39], v13 offset:2560
    ds_read_b64_tr_b16 v[48:49], v14 offset:10240
    ds_read_b64_tr_b16 v[50:51], v14 offset:10880
    ds_read_b64_tr_b16 v[52:53], v14 offset:10272
    ds_read_b64_tr_b16 v[54:55], v14 offset:10912
    s_waitcnt lgkmcnt(0)
    v_mfma_f32_16x16x32_bf16 v[64:67], v[48:51], v[32:35], v[64:67]
    ds_read_b128 v[40:43], v13 offset:64
    ds_read_b128 v[44:47], v13 offset:2624
    v_mfma_f32_16x16x32_bf16 v[68:71], v[52:55], v[32:35], v[68:71]
    ds_read_b64_tr_b16 v[56:57], v14 offset:15360
    ds_read_b64_tr_b16 v[58:59], v14 offset:16000
    v_mfma_f32_16x16x32_bf16 v[72:75], v[48:51], v[36:39], v[72:75]
    ds_read_b64_tr_b16 v[60:61], v14 offset:15392
    ds_read_b64_tr_b16 v[62:63], v14 offset:16032
    v_mfma_f32_16x16x32_bf16 v[76:79], v[52:55], v[36:39], v[76:79]
    s_waitcnt lgkmcnt(0)
    v_mfma_f32_16x16x32_bf16 v[64:67], v[56:59], v[40:43], v[64:67]
    v_mfma_f32_16x16x32_bf16 v[68:71], v[60:63], v[40:43], v[68:71]
    v_mfma_f32_16x16x32_bf16 v[72:75], v[56:59], v[44:47], v[72:75]
    v_mfma_f32_16x16x32_bf16 v[76:79], v[60:63], v[44:47], v[76:79]
    s_nop 7
    s_nop 7
    buffer_load_dwordx2 v[18:19], v15, s[20:23], 0 offen offset:0
    v_cvt_pk_bf16_f32 v16, v64, v65
    v_cvt_pk_bf16_f32 v17, v66, v67
    s_waitcnt vmcnt(0)
    v_lshlrev_b32 v20, 16, v16
    v_and_b32 v21, 0xffff0000, v16
    v_lshlrev_b32 v22, 16, v18
    v_and_b32 v23, 0xffff0000, v18
    v_add_f32 v20, v20, v22
    v_add_f32 v21, v21, v23
    v_cvt_pk_bf16_f32 v16, v20, v21
    v_lshlrev_b32 v20, 16, v17
    v_and_b32 v21, 0xffff0000, v17
    v_lshlrev_b32 v22, 16, v19
    v_and_b32 v23, 0xffff0000, v19
    v_add_f32 v20, v20, v22
    v_add_f32 v21, v21, v23
    v_cvt_pk_bf16_f32 v17, v20, v21
    buffer_store_dwordx2 v[16:17], v15, s[16:19], 0 offen offset:0
    s_nop 1
    buffer_load_dwordx2 v[18:19], v15, s[20:23], 0 offen offset:32
    v_cvt_pk_bf16_f32 v16, v68, v69
    v_cvt_pk_bf16_f32 v17, v70, v71
    s_waitcnt vmcnt(0)
    v_lshlrev_b32 v20, 16, v16
    v_and_b32 v21, 0xffff0000, v16
    v_lshlrev_b32 v22, 16, v18
    v_and_b32 v23, 0xffff0000, v18
    v_add_f32 v20, v20, v22
    v_add_f32 v21, v21, v23
    v_cvt_pk_bf16_f32 v16, v20, v21
    v_lshlrev_b32 v20, 16, v17
    v_and_b32 v21, 0xffff0000, v17
    v_lshlrev_b32 v22, 16, v19
    v_and_b32 v23, 0xffff0000, v19
    v_add_f32 v20, v20, v22
    v_add_f32 v21, v21, v23
    v_cvt_pk_bf16_f32 v17, v20, v21
    buffer_store_dwordx2 v[16:17], v15, s[16:19], 0 offen offset:32
    s_nop 1
    v_add_u32 v15, 18432, v15
    buffer_load_dwordx2 v[18:19], v15, s[20:23], 0 offen offset:0
    v_cvt_pk_bf16_f32 v16, v72, v73
    v_cvt_pk_bf16_f32 v17, v74, v75
    s_waitcnt vmcnt(0)
    v_lshlrev_b32 v20, 16, v16
    v_and_b32 v21, 0xffff0000, v16
    v_lshlrev_b32 v22, 16, v18
    v_and_b32 v23, 0xffff0000, v18
    v_add_f32 v20, v20, v22
    v_add_f32 v21, v21, v23
    v_cvt_pk_bf16_f32 v16, v20, v21
    v_lshlrev_b32 v20, 16, v17
    v_and_b32 v21, 0xffff0000, v17
    v_lshlrev_b32 v22, 16, v19
    v_and_b32 v23, 0xffff0000, v19
    v_add_f32 v20, v20, v22
    v_add_f32 v21, v21, v23
    v_cvt_pk_bf16_f32 v17, v20, v21
    buffer_store_dwordx2 v[16:17], v15, s[16:19], 0 offen offset:0
    s_nop 1
    buffer_load_dwordx2 v[18:19], v15, s[20:23], 0 offen offset:32
    v_cvt_pk_bf16_f32 v16, v76, v77
    v_cvt_pk_bf16_f32 v17, v78, v79
    s_waitcnt vmcnt(0)
    v_lshlrev_b32 v20, 16, v16
    v_and_b32 v21, 0xffff0000, v16
    v_lshlrev_b32 v22, 16, v18
    v_and_b32 v23, 0xffff0000, v18
    v_add_f32 v20, v20, v22
    v_add_f32 v21, v21, v23
    v_cvt_pk_bf16_f32 v16, v20, v21
    v_lshlrev_b32 v20, 16, v17
    v_and_b32 v21, 0xffff0000, v17
    v_lshlrev_b32 v22, 16, v19
    v_and_b32 v23, 0xffff0000, v19
    v_add_f32 v20, v20, v22
    v_add_f32 v21, v21, v23
    v_cvt_pk_bf16_f32 v17, v20, v21
    buffer_store_dwordx2 v[16:17], v15, s[16:19], 0 offen offset:32
    s_nop 1
    s_waitcnt vmcnt(0)
k_wo_kernel_end:
    s_endpgm
.section .rodata,"a"
.p2align 6
.amdhsa_kernel k_wo_kernel
  .amdhsa_next_free_vgpr 80
  .amdhsa_next_free_sgpr 80
  .amdhsa_accum_offset 80
  .amdhsa_group_segment_fixed_size 0
  .amdhsa_kernarg_size 88
  .amdhsa_user_sgpr_count 2
  .amdhsa_user_sgpr_kernarg_segment_ptr 1
  .amdhsa_system_sgpr_workgroup_id_x 1
.end_amdhsa_kernel
.text
.globl k_ln2_kernel
.p2align 8
.type k_ln2_kernel,@function
k_ln2_kernel:
    s_cmp_ge_u32 s2, 64
    s_cbranch_scc1 k_ln2_kernel_end
    s_load_dwordx2 s[4:5], s[0:1], 80
    s_load_dwordx2 s[6:7], s[0:1], 80
    s_waitcnt lgkmcnt(0)
    s_add_u32 s8, s4, 9437184
    s_addc_u32 s9, s5, 0
    s_mov_b32 s10, 2359296
    s_mov_b32 s11, 0x00020000
    s_add_u32 s12, s6, 11796480
    s_addc_u32 s13, s7, 0
    s_mov_b32 s14, 2359296
    s_mov_b32 s15, 0x00020000
    s_add_u32 s16, s6, 56623104
    s_addc_u32 s17, s7, 0
    s_mov_b32 s18, 2359296
    s_mov_b32 s19, 0x00020000
    s_lshl_b32 s20, s2, 5
    v_lshrrev_b32 v5, 3, v0
    v_add_u32 v5, s20, v5
    v_mul_u32_u24 v5, 1152, v5
    v_and_b32 v4, 7, v0
    v_lshlrev_b32 v4, 4, v4
    v_add_u32 v5, v5, v4
    buffer_load_dwordx4 v[8:11], v5, s[8:11], 0 offen offset:0
    buffer_load_dwordx4 v[12:15], v5, s[8:11], 0 offen offset:128
    buffer_load_dwordx4 v[16:19], v5, s[8:11], 0 offen offset:256
    buffer_load_dwordx4 v[20:23], v5, s[8:11], 0 offen offset:384
    buffer_load_dwordx4 v[24:27], v5, s[8:11], 0 offen offset:512
    buffer_load_dwordx4 v[28:31], v5, s[8:11], 0 offen offset:640
    buffer_load_dwordx4 v[32:35], v5, s[8:11], 0 offen offset:768
    buffer_load_dwordx4 v[36:39], v5, s[8:11], 0 offen offset:896
    buffer_load_dwordx4 v[40:43], v5, s[8:11], 0 offen offset:1024
    v_mov_b32 v6, 0x3f803f80
    s_waitcnt vmcnt(0)
    v_mov_b32 v1, 0
    v_lshlrev_b32 v3, 16, v8
    v_and_b32 v4, 0xffff0000, v8
    v_add_f32 v1, v1, v3
    v_add_f32 v1, v1, v4
    v_lshlrev_b32 v3, 16, v9
    v_and_b32 v4, 0xffff0000, v9
    v_add_f32 v1, v1, v3
    v_add_f32 v1, v1, v4
    v_lshlrev_b32 v3, 16, v10
    v_and_b32 v4, 0xffff0000, v10
    v_add_f32 v1, v1, v3
    v_add_f32 v1, v1, v4
    v_lshlrev_b32 v3, 16, v11
    v_and_b32 v4, 0xffff0000, v11
    v_add_f32 v1, v1, v3
    v_add_f32 v1, v1, v4
    v_lshlrev_b32 v3, 16, v12
    v_and_b32 v4, 0xffff0000, v12
    v_add_f32 v1, v1, v3
    v_add_f32 v1, v1, v4
    v_lshlrev_b32 v3, 16, v13
    v_and_b32 v4, 0xffff0000, v13
    v_add_f32 v1, v1, v3
    v_add_f32 v1, v1, v4
    v_lshlrev_b32 v3, 16, v14
    v_and_b32 v4, 0xffff0000, v14
    v_add_f32 v1, v1, v3
    v_add_f32 v1, v1, v4
    v_lshlrev_b32 v3, 16, v15
    v_and_b32 v4, 0xffff0000, v15
    v_add_f32 v1, v1, v3
    v_add_f32 v1, v1, v4
    v_lshlrev_b32 v3, 16, v16
    v_and_b32 v4, 0xffff0000, v16
    v_add_f32 v1, v1, v3
    v_add_f32 v1, v1, v4
    v_lshlrev_b32 v3, 16, v17
    v_and_b32 v4, 0xffff0000, v17
    v_add_f32 v1, v1, v3
    v_add_f32 v1, v1, v4
    v_lshlrev_b32 v3, 16, v18
    v_and_b32 v4, 0xffff0000, v18
    v_add_f32 v1, v1, v3
    v_add_f32 v1, v1, v4
    v_lshlrev_b32 v3, 16, v19
    v_and_b32 v4, 0xffff0000, v19
    v_add_f32 v1, v1, v3
    v_add_f32 v1, v1, v4
    v_lshlrev_b32 v3, 16, v20
    v_and_b32 v4, 0xffff0000, v20
    v_add_f32 v1, v1, v3
    v_add_f32 v1, v1, v4
    v_lshlrev_b32 v3, 16, v21
    v_and_b32 v4, 0xffff0000, v21
    v_add_f32 v1, v1, v3
    v_add_f32 v1, v1, v4
    v_lshlrev_b32 v3, 16, v22
    v_and_b32 v4, 0xffff0000, v22
    v_add_f32 v1, v1, v3
    v_add_f32 v1, v1, v4
    v_lshlrev_b32 v3, 16, v23
    v_and_b32 v4, 0xffff0000, v23
    v_add_f32 v1, v1, v3
    v_add_f32 v1, v1, v4
    v_lshlrev_b32 v3, 16, v24
    v_and_b32 v4, 0xffff0000, v24
    v_add_f32 v1, v1, v3
    v_add_f32 v1, v1, v4
    v_lshlrev_b32 v3, 16, v25
    v_and_b32 v4, 0xffff0000, v25
    v_add_f32 v1, v1, v3
    v_add_f32 v1, v1, v4
    v_lshlrev_b32 v3, 16, v26
    v_and_b32 v4, 0xffff0000, v26
    v_add_f32 v1, v1, v3
    v_add_f32 v1, v1, v4
    v_lshlrev_b32 v3, 16, v27
    v_and_b32 v4, 0xffff0000, v27
    v_add_f32 v1, v1, v3
    v_add_f32 v1, v1, v4
    v_lshlrev_b32 v3, 16, v28
    v_and_b32 v4, 0xffff0000, v28
    v_add_f32 v1, v1, v3
    v_add_f32 v1, v1, v4
    v_lshlrev_b32 v3, 16, v29
    v_and_b32 v4, 0xffff0000, v29
    v_add_f32 v1, v1, v3
    v_add_f32 v1, v1, v4
    v_lshlrev_b32 v3, 16, v30
    v_and_b32 v4, 0xffff0000, v30
    v_add_f32 v1, v1, v3
    v_add_f32 v1, v1, v4
    v_lshlrev_b32 v3, 16, v31
    v_and_b32 v4, 0xffff0000, v31
    v_add_f32 v1, v1, v3
    v_add_f32 v1, v1, v4
    v_lshlrev_b32 v3, 16, v32
    v_and_b32 v4, 0xffff0000, v32
    v_add_f32 v1, v1, v3
    v_add_f32 v1, v1, v4
    v_lshlrev_b32 v3, 16, v33
    v_and_b32 v4, 0xffff0000, v33
    v_add_f32 v1, v1, v3
    v_add_f32 v1, v1, v4
    v_lshlrev_b32 v3, 16, v34
    v_and_b32 v4, 0xffff0000, v34
    v_add_f32 v1, v1, v3
    v_add_f32 v1, v1, v4
    v_lshlrev_b32 v3, 16, v35
    v_and_b32 v4, 0xffff0000, v35
    v_add_f32 v1, v1, v3
    v_add_f32 v1, v1, v4
    v_lshlrev_b32 v3, 16, v36
    v_and_b32 v4, 0xffff0000, v36
    v_add_f32 v1, v1, v3
    v_add_f32 v1, v1, v4
    v_lshlrev_b32 v3, 16, v37
    v_and_b32 v4, 0xffff0000, v37
    v_add_f32 v1, v1, v3
    v_add_f32 v1, v1, v4
    v_lshlrev_b32 v3, 16, v38
    v_and_b32 v4, 0xffff0000, v38
    v_add_f32 v1, v1, v3
    v_add_f32 v1, v1, v4
    v_lshlrev_b32 v3, 16, v39
    v_and_b32 v4, 0xffff0000, v39
    v_add_f32 v1, v1, v3
    v_add_f32 v1, v1, v4
    v_lshlrev_b32 v3, 16, v40
    v_and_b32 v4, 0xffff0000, v40
    v_add_f32 v1, v1, v3
    v_add_f32 v1, v1, v4
    v_lshlrev_b32 v3, 16, v41
    v_and_b32 v4, 0xffff0000, v41
    v_add_f32 v1, v1, v3
    v_add_f32 v1, v1, v4
    v_lshlrev_b32 v3, 16, v42
    v_and_b32 v4, 0xffff0000, v42
    v_add_f32 v1, v1, v3
    v_add_f32 v1, v1, v4
    v_lshlrev_b32 v3, 16, v43
    v_and_b32 v4, 0xffff0000, v43
    v_add_f32 v1, v1, v3
    v_add_f32 v1, v1, v4
    s_nop 1
    v_add_f32_dpp v1, v1, v1 quad_perm:[1,0,3,2] row_mask:0xf bank_mask:0xf
    s_nop 1
    v_add_f32_dpp v1, v1, v1 quad_perm:[2,3,0,1] row_mask:0xf bank_mask:0xf
    s_nop 1
    v_add_f32_dpp v1, v1, v1 row_half_mirror row_mask:0xf bank_mask:0xf
    v_mul_f32 v1, 0x3ae38e39, v1
    v_mov_b32 v2, 0
    v_lshlrev_b32 v3, 16, v8
    v_and_b32 v4, 0xffff0000, v8
    v_sub_f32 v3, v3, v1
    v_sub_f32 v4, v4, v1
    v_fmac_f32 v2, v3, v3
    v_fmac_f32 v2, v4, v4
    v_lshlrev_b32 v3, 16, v9
    v_and_b32 v4, 0xffff0000, v9
    v_sub_f32 v3, v3, v1
    v_sub_f32 v4, v4, v1
    v_fmac_f32 v2, v3, v3
    v_fmac_f32 v2, v4, v4
    v_lshlrev_b32 v3, 16, v10
    v_and_b32 v4, 0xffff0000, v10
    v_sub_f32 v3, v3, v1
    v_sub_f32 v4, v4, v1
    v_fmac_f32 v2, v3, v3
    v_fmac_f32 v2, v4, v4
    v_lshlrev_b32 v3, 16, v11
    v_and_b32 v4, 0xffff0000, v11
    v_sub_f32 v3, v3, v1
    v_sub_f32 v4, v4, v1
    v_fmac_f32 v2, v3, v3
    v_fmac_f32 v2, v4, v4
    v_lshlrev_b32 v3, 16, v12
    v_and_b32 v4, 0xffff0000, v12
    v_sub_f32 v3, v3, v1
    v_sub_f32 v4, v4, v1
    v_fmac_f32 v2, v3, v3
    v_fmac_f32 v2, v4, v4
    v_lshlrev_b32 v3, 16, v13
    v_and_b32 v4, 0xffff0000, v13
    v_sub_f32 v3, v3, v1
    v_sub_f32 v4, v4, v1
    v_fmac_f32 v2, v3, v3
    v_fmac_f32 v2, v4, v4
    v_lshlrev_b32 v3, 16, v14
    v_and_b32 v4, 0xffff0000, v14
    v_sub_f32 v3, v3, v1
    v_sub_f32 v4, v4, v1
    v_fmac_f32 v2, v3, v3
    v_fmac_f32 v2, v4, v4
    v_lshlrev_b32 v3, 16, v15
    v_and_b32 v4, 0xffff0000, v15
    v_sub_f32 v3, v3, v1
    v_sub_f32 v4, v4, v1
    v_fmac_f32 v2, v3, v3
    v_fmac_f32 v2, v4, v4
    v_lshlrev_b32 v3, 16, v16
    v_and_b32 v4, 0xffff0000, v16
    v_sub_f32 v3, v3, v1
    v_sub_f32 v4, v4, v1
    v_fmac_f32 v2, v3, v3
    v_fmac_f32 v2, v4, v4
    v_lshlrev_b32 v3, 16, v17
    v_and_b32 v4, 0xffff0000, v17
    v_sub_f32 v3, v3, v1
    v_sub_f32 v4, v4, v1
    v_fmac_f32 v2, v3, v3
    v_fmac_f32 v2, v4, v4
    v_lshlrev_b32 v3, 16, v18
    v_and_b32 v4, 0xffff0000, v18
    v_sub_f32 v3, v3, v1
    v_sub_f32 v4, v4, v1
    v_fmac_f32 v2, v3, v3
    v_fmac_f32 v2, v4, v4
    v_lshlrev_b32 v3, 16, v19
    v_and_b32 v4, 0xffff0000, v19
    v_sub_f32 v3, v3, v1
    v_sub_f32 v4, v4, v1
    v_fmac_f32 v2, v3, v3
    v_fmac_f32 v2, v4, v4
    v_lshlrev_b32 v3, 16, v20
    v_and_b32 v4, 0xffff0000, v20
    v_sub_f32 v3, v3, v1
    v_sub_f32 v4, v4, v1
    v_fmac_f32 v2, v3, v3
    v_fmac_f32 v2, v4, v4
    v_lshlrev_b32 v3, 16, v21
    v_and_b32 v4, 0xffff0000, v21
    v_sub_f32 v3, v3, v1
    v_sub_f32 v4, v4, v1
    v_fmac_f32 v2, v3, v3
    v_fmac_f32 v2, v4, v4
    v_lshlrev_b32 v3, 16, v22
    v_and_b32 v4, 0xffff0000, v22
    v_sub_f32 v3, v3, v1
    v_sub_f32 v4, v4, v1
    v_fmac_f32 v2, v3, v3
    v_fmac_f32 v2, v4, v4
    v_lshlrev_b32 v3, 16, v23
    v_and_b32 v4, 0xffff0000, v23
    v_sub_f32 v3, v3, v1
    v_sub_f32 v4, v4, v1
    v_fmac_f32 v2, v3, v3
    v_fmac_f32 v2, v4, v4
    v_lshlrev_b32 v3, 16, v24
    v_and_b32 v4, 0xffff0000, v24
    v_sub_f32 v3, v3, v1
    v_sub_f32 v4, v4, v1
    v_fmac_f32 v2, v3, v3
    v_fmac_f32 v2, v4, v4
    v_lshlrev_b32 v3, 16, v25
    v_and_b32 v4, 0xffff0000, v25
    v_sub_f32 v3, v3, v1
    v_sub_f32 v4, v4, v1
    v_fmac_f32 v2, v3, v3
    v_fmac_f32 v2, v4, v4
    v_lshlrev_b32 v3, 16, v26
    v_and_b32 v4, 0xffff0000, v26
    v_sub_f32 v3, v3, v1
    v_sub_f32 v4, v4, v1
    v_fmac_f32 v2, v3, v3
    v_fmac_f32 v2, v4, v4
    v_lshlrev_b32 v3, 16, v27
    v_and_b32 v4, 0xffff0000, v27
    v_sub_f32 v3, v3, v1
    v_sub_f32 v4, v4, v1
    v_fmac_f32 v2, v3, v3
    v_fmac_f32 v2, v4, v4
    v_lshlrev_b32 v3, 16, v28
    v_and_b32 v4, 0xffff0000, v28
    v_sub_f32 v3, v3, v1
    v_sub_f32 v4, v4, v1
    v_fmac_f32 v2, v3, v3
    v_fmac_f32 v2, v4, v4
    v_lshlrev_b32 v3, 16, v29
    v_and_b32 v4, 0xffff0000, v29
    v_sub_f32 v3, v3, v1
    v_sub_f32 v4, v4, v1
    v_fmac_f32 v2, v3, v3
    v_fmac_f32 v2, v4, v4
    v_lshlrev_b32 v3, 16, v30
    v_and_b32 v4, 0xffff0000, v30
    v_sub_f32 v3, v3, v1
    v_sub_f32 v4, v4, v1
    v_fmac_f32 v2, v3, v3
    v_fmac_f32 v2, v4, v4
    v_lshlrev_b32 v3, 16, v31
    v_and_b32 v4, 0xffff0000, v31
    v_sub_f32 v3, v3, v1
    v_sub_f32 v4, v4, v1
    v_fmac_f32 v2, v3, v3
    v_fmac_f32 v2, v4, v4
    v_lshlrev_b32 v3, 16, v32
    v_and_b32 v4, 0xffff0000, v32
    v_sub_f32 v3, v3, v1
    v_sub_f32 v4, v4, v1
    v_fmac_f32 v2, v3, v3
    v_fmac_f32 v2, v4, v4
    v_lshlrev_b32 v3, 16, v33
    v_and_b32 v4, 0xffff0000, v33
    v_sub_f32 v3, v3, v1
    v_sub_f32 v4, v4, v1
    v_fmac_f32 v2, v3, v3
    v_fmac_f32 v2, v4, v4
    v_lshlrev_b32 v3, 16, v34
    v_and_b32 v4, 0xffff0000, v34
    v_sub_f32 v3, v3, v1
    v_sub_f32 v4, v4, v1
    v_fmac_f32 v2, v3, v3
    v_fmac_f32 v2, v4, v4
    v_lshlrev_b32 v3, 16, v35
    v_and_b32 v4, 0xffff0000, v35
    v_sub_f32 v3, v3, v1
    v_sub_f32 v4, v4, v1
    v_fmac_f32 v2, v3, v3
    v_fmac_f32 v2, v4, v4
    v_lshlrev_b32 v3, 16, v36
    v_and_b32 v4, 0xffff0000, v36
    v_sub_f32 v3, v3, v1
    v_sub_f32 v4, v4, v1
    v_fmac_f32 v2, v3, v3
    v_fmac_f32 v2, v4, v4
    v_lshlrev_b32 v3, 16, v37
    v_and_b32 v4, 0xffff0000, v37
    v_sub_f32 v3, v3, v1
    v_sub_f32 v4, v4, v1
    v_fmac_f32 v2, v3, v3
    v_fmac_f32 v2, v4, v4
    v_lshlrev_b32 v3, 16, v38
    v_and_b32 v4, 0xffff0000, v38
    v_sub_f32 v3, v3, v1
    v_sub_f32 v4, v4, v1
    v_fmac_f32 v2, v3, v3
    v_fmac_f32 v2, v4, v4
    v_lshlrev_b32 v3, 16, v39
    v_and_b32 v4, 0xffff0000, v39
    v_sub_f32 v3, v3, v1
    v_sub_f32 v4, v4, v1
    v_fmac_f32 v2, v3, v3
    v_fmac_f32 v2, v4, v4
    v_lshlrev_b32 v3, 16, v40
    v_and_b32 v4, 0xffff0000, v40
    v_sub_f32 v3, v3, v1
    v_sub_f32 v4, v4, v1
    v_fmac_f32 v2, v3, v3
    v_fmac_f32 v2, v4, v4
    v_lshlrev_b32 v3, 16, v41
    v_and_b32 v4, 0xffff0000, v41
    v_sub_f32 v3, v3, v1
    v_sub_f32 v4, v4, v1
    v_fmac_f32 v2, v3, v3
    v_fmac_f32 v2, v4, v4
    v_lshlrev_b32 v3, 16, v42
    v_and_b32 v4, 0xffff0000, v42
    v_sub_f32 v3, v3, v1
    v_sub_f32 v4, v4, v1
    v_fmac_f32 v2, v3, v3
    v_fmac_f32 v2, v4, v4
    v_lshlrev_b32 v3, 16, v43
    v_and_b32 v4, 0xffff0000, v43
    v_sub_f32 v3, v3, v1
    v_sub_f32 v4, v4, v1
    v_fmac_f32 v2, v3, v3
    v_fmac_f32 v2, v4, v4
    s_nop 1
    v_add_f32_dpp v2, v2, v2 quad_perm:[1,0,3,2] row_mask:0xf bank_mask:0xf
    s_nop 1
    v_add_f32_dpp v2, v2, v2 quad_perm:[2,3,0,1] row_mask:0xf bank_mask:0xf
    s_nop 1
    v_add_f32_dpp v2, v2, v2 row_half_mirror row_mask:0xf bank_mask:0xf
    v_mul_f32 v2, 0x3ae38e39, v2
    v_add_f32 v2, 0x3727c5ac, v2
    v_rsq_f32 v2, v2
    s_nop 1
    v_mul_f32 v1, v1, v2
    v_sub_f32 v1, 0, v1
    v_lshlrev_b32 v3, 16, v8
    v_and_b32 v4, 0xffff0000, v8
    v_fma_f32 v3, v3, v2, v1
    v_fma_f32 v4, v4, v2, v1
    v_cvt_pk_bf16_f32 v8, v3, v4
    v_lshlrev_b32 v3, 16, v9
    v_and_b32 v4, 0xffff0000, v9
    v_fma_f32 v3, v3, v2, v1
    v_fma_f32 v4, v4, v2, v1
    v_cvt_pk_bf16_f32 v9, v3, v4
    v_lshlrev_b32 v3, 16, v10
    v_and_b32 v4, 0xffff0000, v10
    v_fma_f32 v3, v3, v2, v1
    v_fma_f32 v4, v4, v2, v1
    v_cvt_pk_bf16_f32 v10, v3, v4
    v_lshlrev_b32 v3, 16, v11
    v_and_b32 v4, 0xffff0000, v11
    v_fma_f32 v3, v3, v2, v1
    v_fma_f32 v4, v4, v2, v1
    v_cvt_pk_bf16_f32 v11, v3, v4
    v_lshlrev_b32 v3, 16, v12
    v_and_b32 v4, 0xffff0000, v12
    v_fma_f32 v3, v3, v2, v1
    v_fma_f32 v4, v4, v2, v1
    v_cvt_pk_bf16_f32 v12, v3, v4
    v_lshlrev_b32 v3, 16, v13
    v_and_b32 v4, 0xffff0000, v13
    v_fma_f32 v3, v3, v2, v1
    v_fma_f32 v4, v4, v2, v1
    v_cvt_pk_bf16_f32 v13, v3, v4
    v_lshlrev_b32 v3, 16, v14
    v_and_b32 v4, 0xffff0000, v14
    v_fma_f32 v3, v3, v2, v1
    v_fma_f32 v4, v4, v2, v1
    v_cvt_pk_bf16_f32 v14, v3, v4
    v_lshlrev_b32 v3, 16, v15
    v_and_b32 v4, 0xffff0000, v15
    v_fma_f32 v3, v3, v2, v1
    v_fma_f32 v4, v4, v2, v1
    v_cvt_pk_bf16_f32 v15, v3, v4
    v_lshlrev_b32 v3, 16, v16
    v_and_b32 v4, 0xffff0000, v16
    v_fma_f32 v3, v3, v2, v1
    v_fma_f32 v4, v4, v2, v1
    v_cvt_pk_bf16_f32 v16, v3, v4
    v_lshlrev_b32 v3, 16, v17
    v_and_b32 v4, 0xffff0000, v17
    v_fma_f32 v3, v3, v2, v1
    v_fma_f32 v4, v4, v2, v1
    v_cvt_pk_bf16_f32 v17, v3, v4
    v_lshlrev_b32 v3, 16, v18
    v_and_b32 v4, 0xffff0000, v18
    v_fma_f32 v3, v3, v2, v1
    v_fma_f32 v4, v4, v2, v1
    v_cvt_pk_bf16_f32 v18, v3, v4
    v_lshlrev_b32 v3, 16, v19
    v_and_b32 v4, 0xffff0000, v19
    v_fma_f32 v3, v3, v2, v1
    v_fma_f32 v4, v4, v2, v1
    v_cvt_pk_bf16_f32 v19, v3, v4
    v_lshlrev_b32 v3, 16, v20
    v_and_b32 v4, 0xffff0000, v20
    v_fma_f32 v3, v3, v2, v1
    v_fma_f32 v4, v4, v2, v1
    v_cvt_pk_bf16_f32 v20, v3, v4
    v_lshlrev_b32 v3, 16, v21
    v_and_b32 v4, 0xffff0000, v21
    v_fma_f32 v3, v3, v2, v1
    v_fma_f32 v4, v4, v2, v1
    v_cvt_pk_bf16_f32 v21, v3, v4
    v_lshlrev_b32 v3, 16, v22
    v_and_b32 v4, 0xffff0000, v22
    v_fma_f32 v3, v3, v2, v1
    v_fma_f32 v4, v4, v2, v1
    v_cvt_pk_bf16_f32 v22, v3, v4
    v_lshlrev_b32 v3, 16, v23
    v_and_b32 v4, 0xffff0000, v23
    v_fma_f32 v3, v3, v2, v1
    v_fma_f32 v4, v4, v2, v1
    v_cvt_pk_bf16_f32 v23, v3, v4
    v_lshlrev_b32 v3, 16, v24
    v_and_b32 v4, 0xffff0000, v24
    v_fma_f32 v3, v3, v2, v1
    v_fma_f32 v4, v4, v2, v1
    v_cvt_pk_bf16_f32 v24, v3, v4
    v_lshlrev_b32 v3, 16, v25
    v_and_b32 v4, 0xffff0000, v25
    v_fma_f32 v3, v3, v2, v1
    v_fma_f32 v4, v4, v2, v1
    v_cvt_pk_bf16_f32 v25, v3, v4
    v_lshlrev_b32 v3, 16, v26
    v_and_b32 v4, 0xffff0000, v26
    v_fma_f32 v3, v3, v2, v1
    v_fma_f32 v4, v4, v2, v1
    v_cvt_pk_bf16_f32 v26, v3, v4
    v_lshlrev_b32 v3, 16, v27
    v_and_b32 v4, 0xffff0000, v27
    v_fma_f32 v3, v3, v2, v1
    v_fma_f32 v4, v4, v2, v1
    v_cvt_pk_bf16_f32 v27, v3, v4
    v_lshlrev_b32 v3, 16, v28
    v_and_b32 v4, 0xffff0000, v28
    v_fma_f32 v3, v3, v2, v1
    v_fma_f32 v4, v4, v2, v1
    v_cvt_pk_bf16_f32 v28, v3, v4
    v_lshlrev_b32 v3, 16, v29
    v_and_b32 v4, 0xffff0000, v29
    v_fma_f32 v3, v3, v2, v1
    v_fma_f32 v4, v4, v2, v1
    v_cvt_pk_bf16_f32 v29, v3, v4
    v_lshlrev_b32 v3, 16, v30
    v_and_b32 v4, 0xffff0000, v30
    v_fma_f32 v3, v3, v2, v1
    v_fma_f32 v4, v4, v2, v1
    v_cvt_pk_bf16_f32 v30, v3, v4
    v_lshlrev_b32 v3, 16, v31
    v_and_b32 v4, 0xffff0000, v31
    v_fma_f32 v3, v3, v2, v1
    v_fma_f32 v4, v4, v2, v1
    v_cvt_pk_bf16_f32 v31, v3, v4
    v_lshlrev_b32 v3, 16, v32
    v_and_b32 v4, 0xffff0000, v32
    v_fma_f32 v3, v3, v2, v1
    v_fma_f32 v4, v4, v2, v1
    v_cvt_pk_bf16_f32 v32, v3, v4
    v_lshlrev_b32 v3, 16, v33
    v_and_b32 v4, 0xffff0000, v33
    v_fma_f32 v3, v3, v2, v1
    v_fma_f32 v4, v4, v2, v1
    v_cvt_pk_bf16_f32 v33, v3, v4
    v_lshlrev_b32 v3, 16, v34
    v_and_b32 v4, 0xffff0000, v34
    v_fma_f32 v3, v3, v2, v1
    v_fma_f32 v4, v4, v2, v1
    v_cvt_pk_bf16_f32 v34, v3, v4
    v_lshlrev_b32 v3, 16, v35
    v_and_b32 v4, 0xffff0000, v35
    v_fma_f32 v3, v3, v2, v1
    v_fma_f32 v4, v4, v2, v1
    v_cvt_pk_bf16_f32 v35, v3, v4
    v_lshlrev_b32 v3, 16, v36
    v_and_b32 v4, 0xffff0000, v36
    v_fma_f32 v3, v3, v2, v1
    v_fma_f32 v4, v4, v2, v1
    v_cvt_pk_bf16_f32 v36, v3, v4
    v_lshlrev_b32 v3, 16, v37
    v_and_b32 v4, 0xffff0000, v37
    v_fma_f32 v3, v3, v2, v1
    v_fma_f32 v4, v4, v2, v1
    v_cvt_pk_bf16_f32 v37, v3, v4
    v_lshlrev_b32 v3, 16, v38
    v_and_b32 v4, 0xffff0000, v38
    v_fma_f32 v3, v3, v2, v1
    v_fma_f32 v4, v4, v2, v1
    v_cvt_pk_bf16_f32 v38, v3, v4
    v_lshlrev_b32 v3, 16, v39
    v_and_b32 v4, 0xffff0000, v39
    v_fma_f32 v3, v3, v2, v1
    v_fma_f32 v4, v4, v2, v1
    v_cvt_pk_bf16_f32 v39, v3, v4
    v_lshlrev_b32 v3, 16, v40
    v_and_b32 v4, 0xffff0000, v40
    v_fma_f32 v3, v3, v2, v1
    v_fma_f32 v4, v4, v2, v1
    v_cvt_pk_bf16_f32 v40, v3, v4
    v_lshlrev_b32 v3, 16, v41
    v_and_b32 v4, 0xffff0000, v41
    v_fma_f32 v3, v3, v2, v1
    v_fma_f32 v4, v4, v2, v1
    v_cvt_pk_bf16_f32 v41, v3, v4
    v_lshlrev_b32 v3, 16, v42
    v_and_b32 v4, 0xffff0000, v42
    v_fma_f32 v3, v3, v2, v1
    v_fma_f32 v4, v4, v2, v1
    v_cvt_pk_bf16_f32 v42, v3, v4
    v_lshlrev_b32 v3, 16, v43
    v_and_b32 v4, 0xffff0000, v43
    v_fma_f32 v3, v3, v2, v1
    v_fma_f32 v4, v4, v2, v1
    v_cvt_pk_bf16_f32 v43, v3, v4
    buffer_store_dwordx4 v[8:11], v5, s[12:15], 0 offen offset:0
    buffer_store_dwordx4 v[12:15], v5, s[12:15], 0 offen offset:128
    buffer_store_dwordx4 v[16:19], v5, s[12:15], 0 offen offset:256
    buffer_store_dwordx4 v[20:23], v5, s[12:15], 0 offen offset:384
    buffer_store_dwordx4 v[24:27], v5, s[12:15], 0 offen offset:512
    buffer_store_dwordx4 v[28:31], v5, s[12:15], 0 offen offset:640
    buffer_store_dwordx4 v[32:35], v5, s[12:15], 0 offen offset:768
    buffer_store_dwordx4 v[36:39], v5, s[12:15], 0 offen offset:896
    buffer_store_dwordx4 v[40:43], v5, s[12:15], 0 offen offset:1024
    s_waitcnt vmcnt(0)
    v_mov_b32 v1, 0
    v_lshlrev_b32 v3, 16, v8
    v_and_b32 v4, 0xffff0000, v8
    v_add_f32 v1, v1, v3
    v_add_f32 v1, v1, v4
    v_lshlrev_b32 v3, 16, v9
    v_and_b32 v4, 0xffff0000, v9
    v_add_f32 v1, v1, v3
    v_add_f32 v1, v1, v4
    v_lshlrev_b32 v3, 16, v10
    v_and_b32 v4, 0xffff0000, v10
    v_add_f32 v1, v1, v3
    v_add_f32 v1, v1, v4
    v_lshlrev_b32 v3, 16, v11
    v_and_b32 v4, 0xffff0000, v11
    v_add_f32 v1, v1, v3
    v_add_f32 v1, v1, v4
    v_lshlrev_b32 v3, 16, v12
    v_and_b32 v4, 0xffff0000, v12
    v_add_f32 v1, v1, v3
    v_add_f32 v1, v1, v4
    v_lshlrev_b32 v3, 16, v13
    v_and_b32 v4, 0xffff0000, v13
    v_add_f32 v1, v1, v3
    v_add_f32 v1, v1, v4
    v_lshlrev_b32 v3, 16, v14
    v_and_b32 v4, 0xffff0000, v14
    v_add_f32 v1, v1, v3
    v_add_f32 v1, v1, v4
    v_lshlrev_b32 v3, 16, v15
    v_and_b32 v4, 0xffff0000, v15
    v_add_f32 v1, v1, v3
    v_add_f32 v1, v1, v4
    v_lshlrev_b32 v3, 16, v16
    v_and_b32 v4, 0xffff0000, v16
    v_add_f32 v1, v1, v3
    v_add_f32 v1, v1, v4
    v_lshlrev_b32 v3, 16, v17
    v_and_b32 v4, 0xffff0000, v17
    v_add_f32 v1, v1, v3
    v_add_f32 v1, v1, v4
    v_lshlrev_b32 v3, 16, v18
    v_and_b32 v4, 0xffff0000, v18
    v_add_f32 v1, v1, v3
    v_add_f32 v1, v1, v4
    v_lshlrev_b32 v3, 16, v19
    v_and_b32 v4, 0xffff0000, v19
    v_add_f32 v1, v1, v3
    v_add_f32 v1, v1, v4
    v_lshlrev_b32 v3, 16, v20
    v_and_b32 v4, 0xffff0000, v20
    v_add_f32 v1, v1, v3
    v_add_f32 v1, v1, v4
    v_lshlrev_b32 v3, 16, v21
    v_and_b32 v4, 0xffff0000, v21
    v_add_f32 v1, v1, v3
    v_add_f32 v1, v1, v4
    v_lshlrev_b32 v3, 16, v22
    v_and_b32 v4, 0xffff0000, v22
    v_add_f32 v1, v1, v3
    v_add_f32 v1, v1, v4
    v_lshlrev_b32 v3, 16, v23
    v_and_b32 v4, 0xffff0000, v23
    v_add_f32 v1, v1, v3
    v_add_f32 v1, v1, v4
    v_lshlrev_b32 v3, 16, v24
    v_and_b32 v4, 0xffff0000, v24
    v_add_f32 v1, v1, v3
    v_add_f32 v1, v1, v4
    v_lshlrev_b32 v3, 16, v25
    v_and_b32 v4, 0xffff0000, v25
    v_add_f32 v1, v1, v3
    v_add_f32 v1, v1, v4
    v_lshlrev_b32 v3, 16, v26
    v_and_b32 v4, 0xffff0000, v26
    v_add_f32 v1, v1, v3
    v_add_f32 v1, v1, v4
    v_lshlrev_b32 v3, 16, v27
    v_and_b32 v4, 0xffff0000, v27
    v_add_f32 v1, v1, v3
    v_add_f32 v1, v1, v4
    v_lshlrev_b32 v3, 16, v28
    v_and_b32 v4, 0xffff0000, v28
    v_add_f32 v1, v1, v3
    v_add_f32 v1, v1, v4
    v_lshlrev_b32 v3, 16, v29
    v_and_b32 v4, 0xffff0000, v29
    v_add_f32 v1, v1, v3
    v_add_f32 v1, v1, v4
    v_lshlrev_b32 v3, 16, v30
    v_and_b32 v4, 0xffff0000, v30
    v_add_f32 v1, v1, v3
    v_add_f32 v1, v1, v4
    v_lshlrev_b32 v3, 16, v31
    v_and_b32 v4, 0xffff0000, v31
    v_add_f32 v1, v1, v3
    v_add_f32 v1, v1, v4
    v_lshlrev_b32 v3, 16, v32
    v_and_b32 v4, 0xffff0000, v32
    v_add_f32 v1, v1, v3
    v_add_f32 v1, v1, v4
    v_lshlrev_b32 v3, 16, v33
    v_and_b32 v4, 0xffff0000, v33
    v_add_f32 v1, v1, v3
    v_add_f32 v1, v1, v4
    v_lshlrev_b32 v3, 16, v34
    v_and_b32 v4, 0xffff0000, v34
    v_add_f32 v1, v1, v3
    v_add_f32 v1, v1, v4
    v_lshlrev_b32 v3, 16, v35
    v_and_b32 v4, 0xffff0000, v35
    v_add_f32 v1, v1, v3
    v_add_f32 v1, v1, v4
    v_lshlrev_b32 v3, 16, v36
    v_and_b32 v4, 0xffff0000, v36
    v_add_f32 v1, v1, v3
    v_add_f32 v1, v1, v4
    v_lshlrev_b32 v3, 16, v37
    v_and_b32 v4, 0xffff0000, v37
    v_add_f32 v1, v1, v3
    v_add_f32 v1, v1, v4
    v_lshlrev_b32 v3, 16, v38
    v_and_b32 v4, 0xffff0000, v38
    v_add_f32 v1, v1, v3
    v_add_f32 v1, v1, v4
    v_lshlrev_b32 v3, 16, v39
    v_and_b32 v4, 0xffff0000, v39
    v_add_f32 v1, v1, v3
    v_add_f32 v1, v1, v4
    v_lshlrev_b32 v3, 16, v40
    v_and_b32 v4, 0xffff0000, v40
    v_add_f32 v1, v1, v3
    v_add_f32 v1, v1, v4
    v_lshlrev_b32 v3, 16, v41
    v_and_b32 v4, 0xffff0000, v41
    v_add_f32 v1, v1, v3
    v_add_f32 v1, v1, v4
    v_lshlrev_b32 v3, 16, v42
    v_and_b32 v4, 0xffff0000, v42
    v_add_f32 v1, v1, v3
    v_add_f32 v1, v1, v4
    v_lshlrev_b32 v3, 16, v43
    v_and_b32 v4, 0xffff0000, v43
    v_add_f32 v1, v1, v3
    v_add_f32 v1, v1, v4
    s_nop 1
    v_add_f32_dpp v1, v1, v1 quad_perm:[1,0,3,2] row_mask:0xf bank_mask:0xf
    s_nop 1
    v_add_f32_dpp v1, v1, v1 quad_perm:[2,3,0,1] row_mask:0xf bank_mask:0xf
    s_nop 1
    v_add_f32_dpp v1, v1, v1 row_half_mirror row_mask:0xf bank_mask:0xf
    v_mul_f32 v1, 0x3ae38e39, v1
    v_mov_b32 v2, 0
    v_lshlrev_b32 v3, 16, v8
    v_and_b32 v4, 0xffff0000, v8
    v_sub_f32 v3, v3, v1
    v_sub_f32 v4, v4, v1
    v_fmac_f32 v2, v3, v3
    v_fmac_f32 v2, v4, v4
    v_lshlrev_b32 v3, 16, v9
    v_and_b32 v4, 0xffff0000, v9
    v_sub_f32 v3, v3, v1
    v_sub_f32 v4, v4, v1
    v_fmac_f32 v2, v3, v3
    v_fmac_f32 v2, v4, v4
    v_lshlrev_b32 v3, 16, v10
    v_and_b32 v4, 0xffff0000, v10
    v_sub_f32 v3, v3, v1
    v_sub_f32 v4, v4, v1
    v_fmac_f32 v2, v3, v3
    v_fmac_f32 v2, v4, v4
    v_lshlrev_b32 v3, 16, v11
    v_and_b32 v4, 0xffff0000, v11
    v_sub_f32 v3, v3, v1
    v_sub_f32 v4, v4, v1
    v_fmac_f32 v2, v3, v3
    v_fmac_f32 v2, v4, v4
    v_lshlrev_b32 v3, 16, v12
    v_and_b32 v4, 0xffff0000, v12
    v_sub_f32 v3, v3, v1
    v_sub_f32 v4, v4, v1
    v_fmac_f32 v2, v3, v3
    v_fmac_f32 v2, v4, v4
    v_lshlrev_b32 v3, 16, v13
    v_and_b32 v4, 0xffff0000, v13
    v_sub_f32 v3, v3, v1
    v_sub_f32 v4, v4, v1
    v_fmac_f32 v2, v3, v3
    v_fmac_f32 v2, v4, v4
    v_lshlrev_b32 v3, 16, v14
    v_and_b32 v4, 0xffff0000, v14
    v_sub_f32 v3, v3, v1
    v_sub_f32 v4, v4, v1
    v_fmac_f32 v2, v3, v3
    v_fmac_f32 v2, v4, v4
    v_lshlrev_b32 v3, 16, v15
    v_and_b32 v4, 0xffff0000, v15
    v_sub_f32 v3, v3, v1
    v_sub_f32 v4, v4, v1
    v_fmac_f32 v2, v3, v3
    v_fmac_f32 v2, v4, v4
    v_lshlrev_b32 v3, 16, v16
    v_and_b32 v4, 0xffff0000, v16
    v_sub_f32 v3, v3, v1
    v_sub_f32 v4, v4, v1
    v_fmac_f32 v2, v3, v3
    v_fmac_f32 v2, v4, v4
    v_lshlrev_b32 v3, 16, v17
    v_and_b32 v4, 0xffff0000, v17
    v_sub_f32 v3, v3, v1
    v_sub_f32 v4, v4, v1
    v_fmac_f32 v2, v3, v3
    v_fmac_f32 v2, v4, v4
    v_lshlrev_b32 v3, 16, v18
    v_and_b32 v4, 0xffff0000, v18
    v_sub_f32 v3, v3, v1
    v_sub_f32 v4, v4, v1
    v_fmac_f32 v2, v3, v3
    v_fmac_f32 v2, v4, v4
    v_lshlrev_b32 v3, 16, v19
    v_and_b32 v4, 0xffff0000, v19
    v_sub_f32 v3, v3, v1
    v_sub_f32 v4, v4, v1
    v_fmac_f32 v2, v3, v3
    v_fmac_f32 v2, v4, v4
    v_lshlrev_b32 v3, 16, v20
    v_and_b32 v4, 0xffff0000, v20
    v_sub_f32 v3, v3, v1
    v_sub_f32 v4, v4, v1
    v_fmac_f32 v2, v3, v3
    v_fmac_f32 v2, v4, v4
    v_lshlrev_b32 v3, 16, v21
    v_and_b32 v4, 0xffff0000, v21
    v_sub_f32 v3, v3, v1
    v_sub_f32 v4, v4, v1
    v_fmac_f32 v2, v3, v3
    v_fmac_f32 v2, v4, v4
    v_lshlrev_b32 v3, 16, v22
    v_and_b32 v4, 0xffff0000, v22
    v_sub_f32 v3, v3, v1
    v_sub_f32 v4, v4, v1
    v_fmac_f32 v2, v3, v3
    v_fmac_f32 v2, v4, v4
    v_lshlrev_b32 v3, 16, v23
    v_and_b32 v4, 0xffff0000, v23
    v_sub_f32 v3, v3, v1
    v_sub_f32 v4, v4, v1
    v_fmac_f32 v2, v3, v3
    v_fmac_f32 v2, v4, v4
    v_lshlrev_b32 v3, 16, v24
    v_and_b32 v4, 0xffff0000, v24
    v_sub_f32 v3, v3, v1
    v_sub_f32 v4, v4, v1
    v_fmac_f32 v2, v3, v3
    v_fmac_f32 v2, v4, v4
    v_lshlrev_b32 v3, 16, v25
    v_and_b32 v4, 0xffff0000, v25
    v_sub_f32 v3, v3, v1
    v_sub_f32 v4, v4, v1
    v_fmac_f32 v2, v3, v3
    v_fmac_f32 v2, v4, v4
    v_lshlrev_b32 v3, 16, v26
    v_and_b32 v4, 0xffff0000, v26
    v_sub_f32 v3, v3, v1
    v_sub_f32 v4, v4, v1
    v_fmac_f32 v2, v3, v3
    v_fmac_f32 v2, v4, v4
    v_lshlrev_b32 v3, 16, v27
    v_and_b32 v4, 0xffff0000, v27
    v_sub_f32 v3, v3, v1
    v_sub_f32 v4, v4, v1
    v_fmac_f32 v2, v3, v3
    v_fmac_f32 v2, v4, v4
    v_lshlrev_b32 v3, 16, v28
    v_and_b32 v4, 0xffff0000, v28
    v_sub_f32 v3, v3, v1
    v_sub_f32 v4, v4, v1
    v_fmac_f32 v2, v3, v3
    v_fmac_f32 v2, v4, v4
    v_lshlrev_b32 v3, 16, v29
    v_and_b32 v4, 0xffff0000, v29
    v_sub_f32 v3, v3, v1
    v_sub_f32 v4, v4, v1
    v_fmac_f32 v2, v3, v3
    v_fmac_f32 v2, v4, v4
    v_lshlrev_b32 v3, 16, v30
    v_and_b32 v4, 0xffff0000, v30
    v_sub_f32 v3, v3, v1
    v_sub_f32 v4, v4, v1
    v_fmac_f32 v2, v3, v3
    v_fmac_f32 v2, v4, v4
    v_lshlrev_b32 v3, 16, v31
    v_and_b32 v4, 0xffff0000, v31
    v_sub_f32 v3, v3, v1
    v_sub_f32 v4, v4, v1
    v_fmac_f32 v2, v3, v3
    v_fmac_f32 v2, v4, v4
    v_lshlrev_b32 v3, 16, v32
    v_and_b32 v4, 0xffff0000, v32
    v_sub_f32 v3, v3, v1
    v_sub_f32 v4, v4, v1
    v_fmac_f32 v2, v3, v3
    v_fmac_f32 v2, v4, v4
    v_lshlrev_b32 v3, 16, v33
    v_and_b32 v4, 0xffff0000, v33
    v_sub_f32 v3, v3, v1
    v_sub_f32 v4, v4, v1
    v_fmac_f32 v2, v3, v3
    v_fmac_f32 v2, v4, v4
    v_lshlrev_b32 v3, 16, v34
    v_and_b32 v4, 0xffff0000, v34
    v_sub_f32 v3, v3, v1
    v_sub_f32 v4, v4, v1
    v_fmac_f32 v2, v3, v3
    v_fmac_f32 v2, v4, v4
    v_lshlrev_b32 v3, 16, v35
    v_and_b32 v4, 0xffff0000, v35
    v_sub_f32 v3, v3, v1
    v_sub_f32 v4, v4, v1
    v_fmac_f32 v2, v3, v3
    v_fmac_f32 v2, v4, v4
    v_lshlrev_b32 v3, 16, v36
    v_and_b32 v4, 0xffff0000, v36
    v_sub_f32 v3, v3, v1
    v_sub_f32 v4, v4, v1
    v_fmac_f32 v2, v3, v3
    v_fmac_f32 v2, v4, v4
    v_lshlrev_b32 v3, 16, v37
    v_and_b32 v4, 0xffff0000, v37
    v_sub_f32 v3, v3, v1
    v_sub_f32 v4, v4, v1
    v_fmac_f32 v2, v3, v3
    v_fmac_f32 v2, v4, v4
    v_lshlrev_b32 v3, 16, v38
    v_and_b32 v4, 0xffff0000, v38
    v_sub_f32 v3, v3, v1
    v_sub_f32 v4, v4, v1
    v_fmac_f32 v2, v3, v3
    v_fmac_f32 v2, v4, v4
    v_lshlrev_b32 v3, 16, v39
    v_and_b32 v4, 0xffff0000, v39
    v_sub_f32 v3, v3, v1
    v_sub_f32 v4, v4, v1
    v_fmac_f32 v2, v3, v3
    v_fmac_f32 v2, v4, v4
    v_lshlrev_b32 v3, 16, v40
    v_and_b32 v4, 0xffff0000, v40
    v_sub_f32 v3, v3, v1
    v_sub_f32 v4, v4, v1
    v_fmac_f32 v2, v3, v3
    v_fmac_f32 v2, v4, v4
    v_lshlrev_b32 v3, 16, v41
    v_and_b32 v4, 0xffff0000, v41
    v_sub_f32 v3, v3, v1
    v_sub_f32 v4, v4, v1
    v_fmac_f32 v2, v3, v3
    v_fmac_f32 v2, v4, v4
    v_lshlrev_b32 v3, 16, v42
    v_and_b32 v4, 0xffff0000, v42
    v_sub_f32 v3, v3, v1
    v_sub_f32 v4, v4, v1
    v_fmac_f32 v2, v3, v3
    v_fmac_f32 v2, v4, v4
    v_lshlrev_b32 v3, 16, v43
    v_and_b32 v4, 0xffff0000, v43
    v_sub_f32 v3, v3, v1
    v_sub_f32 v4, v4, v1
    v_fmac_f32 v2, v3, v3
    v_fmac_f32 v2, v4, v4
    s_nop 1
    v_add_f32_dpp v2, v2, v2 quad_perm:[1,0,3,2] row_mask:0xf bank_mask:0xf
    s_nop 1
    v_add_f32_dpp v2, v2, v2 quad_perm:[2,3,0,1] row_mask:0xf bank_mask:0xf
    s_nop 1
    v_add_f32_dpp v2, v2, v2 row_half_mirror row_mask:0xf bank_mask:0xf
    v_mul_f32 v2, 0x3ae38e39, v2
    v_add_f32 v2, 0x3727c5ac, v2
    v_rsq_f32 v2, v2
    s_nop 1
    v_mul_f32 v1, v1, v2
    v_sub_f32 v1, 0, v1
    v_lshlrev_b32 v3, 16, v8
    v_and_b32 v4, 0xffff0000, v8
    v_fma_f32 v3, v3, v2, v1
    v_fma_f32 v4, v4, v2, v1
    v_cvt_pk_bf16_f32 v8, v3, v4
    v_lshlrev_b32 v3, 16, v9
    v_and_b32 v4, 0xffff0000, v9
    v_fma_f32 v3, v3, v2, v1
    v_fma_f32 v4, v4, v2, v1
    v_cvt_pk_bf16_f32 v9, v3, v4
    v_lshlrev_b32 v3, 16, v10
    v_and_b32 v4, 0xffff0000, v10
    v_fma_f32 v3, v3, v2, v1
    v_fma_f32 v4, v4, v2, v1
    v_cvt_pk_bf16_f32 v10, v3, v4
    v_lshlrev_b32 v3, 16, v11
    v_and_b32 v4, 0xffff0000, v11
    v_fma_f32 v3, v3, v2, v1
    v_fma_f32 v4, v4, v2, v1
    v_cvt_pk_bf16_f32 v11, v3, v4
    v_lshlrev_b32 v3, 16, v12
    v_and_b32 v4, 0xffff0000, v12
    v_fma_f32 v3, v3, v2, v1
    v_fma_f32 v4, v4, v2, v1
    v_cvt_pk_bf16_f32 v12, v3, v4
    v_lshlrev_b32 v3, 16, v13
    v_and_b32 v4, 0xffff0000, v13
    v_fma_f32 v3, v3, v2, v1
    v_fma_f32 v4, v4, v2, v1
    v_cvt_pk_bf16_f32 v13, v3, v4
    v_lshlrev_b32 v3, 16, v14
    v_and_b32 v4, 0xffff0000, v14
    v_fma_f32 v3, v3, v2, v1
    v_fma_f32 v4, v4, v2, v1
    v_cvt_pk_bf16_f32 v14, v3, v4
    v_lshlrev_b32 v3, 16, v15
    v_and_b32 v4, 0xffff0000, v15
    v_fma_f32 v3, v3, v2, v1
    v_fma_f32 v4, v4, v2, v1
    v_cvt_pk_bf16_f32 v15, v3, v4
    v_lshlrev_b32 v3, 16, v16
    v_and_b32 v4, 0xffff0000, v16
    v_fma_f32 v3, v3, v2, v1
    v_fma_f32 v4, v4, v2, v1
    v_cvt_pk_bf16_f32 v16, v3, v4
    v_lshlrev_b32 v3, 16, v17
    v_and_b32 v4, 0xffff0000, v17
    v_fma_f32 v3, v3, v2, v1
    v_fma_f32 v4, v4, v2, v1
    v_cvt_pk_bf16_f32 v17, v3, v4
    v_lshlrev_b32 v3, 16, v18
    v_and_b32 v4, 0xffff0000, v18
    v_fma_f32 v3, v3, v2, v1
    v_fma_f32 v4, v4, v2, v1
    v_cvt_pk_bf16_f32 v18, v3, v4
    v_lshlrev_b32 v3, 16, v19
    v_and_b32 v4, 0xffff0000, v19
    v_fma_f32 v3, v3, v2, v1
    v_fma_f32 v4, v4, v2, v1
    v_cvt_pk_bf16_f32 v19, v3, v4
    v_lshlrev_b32 v3, 16, v20
    v_and_b32 v4, 0xffff0000, v20
    v_fma_f32 v3, v3, v2, v1
    v_fma_f32 v4, v4, v2, v1
    v_cvt_pk_bf16_f32 v20, v3, v4
    v_lshlrev_b32 v3, 16, v21
    v_and_b32 v4, 0xffff0000, v21
    v_fma_f32 v3, v3, v2, v1
    v_fma_f32 v4, v4, v2, v1
    v_cvt_pk_bf16_f32 v21, v3, v4
    v_lshlrev_b32 v3, 16, v22
    v_and_b32 v4, 0xffff0000, v22
    v_fma_f32 v3, v3, v2, v1
    v_fma_f32 v4, v4, v2, v1
    v_cvt_pk_bf16_f32 v22, v3, v4
    v_lshlrev_b32 v3, 16, v23
    v_and_b32 v4, 0xffff0000, v23
    v_fma_f32 v3, v3, v2, v1
    v_fma_f32 v4, v4, v2, v1
    v_cvt_pk_bf16_f32 v23, v3, v4
    v_lshlrev_b32 v3, 16, v24
    v_and_b32 v4, 0xffff0000, v24
    v_fma_f32 v3, v3, v2, v1
    v_fma_f32 v4, v4, v2, v1
    v_cvt_pk_bf16_f32 v24, v3, v4
    v_lshlrev_b32 v3, 16, v25
    v_and_b32 v4, 0xffff0000, v25
    v_fma_f32 v3, v3, v2, v1
    v_fma_f32 v4, v4, v2, v1
    v_cvt_pk_bf16_f32 v25, v3, v4
    v_lshlrev_b32 v3, 16, v26
    v_and_b32 v4, 0xffff0000, v26
    v_fma_f32 v3, v3, v2, v1
    v_fma_f32 v4, v4, v2, v1
    v_cvt_pk_bf16_f32 v26, v3, v4
    v_lshlrev_b32 v3, 16, v27
    v_and_b32 v4, 0xffff0000, v27
    v_fma_f32 v3, v3, v2, v1
    v_fma_f32 v4, v4, v2, v1
    v_cvt_pk_bf16_f32 v27, v3, v4
    v_lshlrev_b32 v3, 16, v28
    v_and_b32 v4, 0xffff0000, v28
    v_fma_f32 v3, v3, v2, v1
    v_fma_f32 v4, v4, v2, v1
    v_cvt_pk_bf16_f32 v28, v3, v4
    v_lshlrev_b32 v3, 16, v29
    v_and_b32 v4, 0xffff0000, v29
    v_fma_f32 v3, v3, v2, v1
    v_fma_f32 v4, v4, v2, v1
    v_cvt_pk_bf16_f32 v29, v3, v4
    v_lshlrev_b32 v3, 16, v30
    v_and_b32 v4, 0xffff0000, v30
    v_fma_f32 v3, v3, v2, v1
    v_fma_f32 v4, v4, v2, v1
    v_cvt_pk_bf16_f32 v30, v3, v4
    v_lshlrev_b32 v3, 16, v31
    v_and_b32 v4, 0xffff0000, v31
    v_fma_f32 v3, v3, v2, v1
    v_fma_f32 v4, v4, v2, v1
    v_cvt_pk_bf16_f32 v31, v3, v4
    v_lshlrev_b32 v3, 16, v32
    v_and_b32 v4, 0xffff0000, v32
    v_fma_f32 v3, v3, v2, v1
    v_fma_f32 v4, v4, v2, v1
    v_cvt_pk_bf16_f32 v32, v3, v4
    v_lshlrev_b32 v3, 16, v33
    v_and_b32 v4, 0xffff0000, v33
    v_fma_f32 v3, v3, v2, v1
    v_fma_f32 v4, v4, v2, v1
    v_cvt_pk_bf16_f32 v33, v3, v4
    v_lshlrev_b32 v3, 16, v34
    v_and_b32 v4, 0xffff0000, v34
    v_fma_f32 v3, v3, v2, v1
    v_fma_f32 v4, v4, v2, v1
    v_cvt_pk_bf16_f32 v34, v3, v4
    v_lshlrev_b32 v3, 16, v35
    v_and_b32 v4, 0xffff0000, v35
    v_fma_f32 v3, v3, v2, v1
    v_fma_f32 v4, v4, v2, v1
    v_cvt_pk_bf16_f32 v35, v3, v4
    v_lshlrev_b32 v3, 16, v36
    v_and_b32 v4, 0xffff0000, v36
    v_fma_f32 v3, v3, v2, v1
    v_fma_f32 v4, v4, v2, v1
    v_cvt_pk_bf16_f32 v36, v3, v4
    v_lshlrev_b32 v3, 16, v37
    v_and_b32 v4, 0xffff0000, v37
    v_fma_f32 v3, v3, v2, v1
    v_fma_f32 v4, v4, v2, v1
    v_cvt_pk_bf16_f32 v37, v3, v4
    v_lshlrev_b32 v3, 16, v38
    v_and_b32 v4, 0xffff0000, v38
    v_fma_f32 v3, v3, v2, v1
    v_fma_f32 v4, v4, v2, v1
    v_cvt_pk_bf16_f32 v38, v3, v4
    v_lshlrev_b32 v3, 16, v39
    v_and_b32 v4, 0xffff0000, v39
    v_fma_f32 v3, v3, v2, v1
    v_fma_f32 v4, v4, v2, v1
    v_cvt_pk_bf16_f32 v39, v3, v4
    v_lshlrev_b32 v3, 16, v40
    v_and_b32 v4, 0xffff0000, v40
    v_fma_f32 v3, v3, v2, v1
    v_fma_f32 v4, v4, v2, v1
    v_cvt_pk_bf16_f32 v40, v3, v4
    v_lshlrev_b32 v3, 16, v41
    v_and_b32 v4, 0xffff0000, v41
    v_fma_f32 v3, v3, v2, v1
    v_fma_f32 v4, v4, v2, v1
    v_cvt_pk_bf16_f32 v41, v3, v4
    v_lshlrev_b32 v3, 16, v42
    v_and_b32 v4, 0xffff0000, v42
    v_fma_f32 v3, v3, v2, v1
    v_fma_f32 v4, v4, v2, v1
    v_cvt_pk_bf16_f32 v42, v3, v4
    v_lshlrev_b32 v3, 16, v43
    v_and_b32 v4, 0xffff0000, v43
    v_fma_f32 v3, v3, v2, v1
    v_fma_f32 v4, v4, v2, v1
    v_cvt_pk_bf16_f32 v43, v3, v4
    buffer_store_dwordx4 v[8:11], v5, s[16:19], 0 offen offset:0
    buffer_store_dwordx4 v[12:15], v5, s[16:19], 0 offen offset:128
    buffer_store_dwordx4 v[16:19], v5, s[16:19], 0 offen offset:256
    buffer_store_dwordx4 v[20:23], v5, s[16:19], 0 offen offset:384
    buffer_store_dwordx4 v[24:27], v5, s[16:19], 0 offen offset:512
    buffer_store_dwordx4 v[28:31], v5, s[16:19], 0 offen offset:640
    buffer_store_dwordx4 v[32:35], v5, s[16:19], 0 offen offset:768
    buffer_store_dwordx4 v[36:39], v5, s[16:19], 0 offen offset:896
    buffer_store_dwordx4 v[40:43], v5, s[16:19], 0 offen offset:1024
    s_waitcnt vmcnt(0)
k_ln2_kernel_end:
    s_endpgm
.section .rodata,"a"
.p2align 6
.amdhsa_kernel k_ln2_kernel
  .amdhsa_next_free_vgpr 48
  .amdhsa_next_free_sgpr 32
  .amdhsa_accum_offset 48
  .amdhsa_group_segment_fixed_size 0
  .amdhsa_kernarg_size 88
  .amdhsa_user_sgpr_count 2
  .amdhsa_user_sgpr_kernarg_segment_ptr 1
  .amdhsa_system_sgpr_workgroup_id_x 1
.end_amdhsa_kernel
.text
.globl k_w1_kernel
.p2align 8
.type k_w1_kernel,@function
k_w1_kernel:
    s_cmp_ge_u32 s2, 288
    s_cbranch_scc1 k_w1_kernel_end
    s_load_dwordx2 s[36:37], s[0:1], 80
    s_load_dwordx2 s[38:39], s[0:1], 32
    s_mov_b32 s3, 0
    s_mov_b32 s6, s2
    s_mul_i32 s4, s6, 57
    s_lshr_b32 s4, s4, 9
    s_mul_i32 s5, s4, 9
    s_sub_u32 s5, s6, s5
    s_waitcnt lgkmcnt(0)
    s_add_u32 s8, s36, 56623104
    s_addc_u32 s9, s37, 0
    s_mov_b32 s10, 2359296
    s_mov_b32 s11, 0x00020000
    s_mov_b32 s12, s38
    s_mov_b32 s13, s39
    s_mov_b32 s14, 663552
    s_mov_b32 s15, 0x00020000
    s_add_u32 s16, s36, 14155776
    s_addc_u32 s17, s37, 0
    s_mov_b32 s18, 2359296
    s_mov_b32 s19, 0x00020000
    s_mul_i32 s32, s4, 64
    s_mul_i32 s33, s5, 64
    s_mul_i32 s34, s3, 1152
    s_mul_i32 s35, s3, 663552
    v_and_b32 v5, 63, v0
    v_lshrrev_b32 v1, 3, v0
    v_and_b32 v2, 7, v0
    v_lshlrev_b32 v2, 4, v2
    v_mul_u32_u24 v8, 160, v1
    v_add_u32 v8, v8, v2
    v_add_u32 v3, s32, v1
    v_mul_u32_u24 v3, 1152, v3
    v_add_u32 v6, v3, v2
    v_add_u32 v7, 36864, v6
    v_add_u32 v1, 0, v0
    v_mul_u32_u24 v2, 32, v1
    v_lshrrev_b32 v2, 8, v2
    v_mul_u32_u24 v3, 8, v2
    v_sub_u32 v3, v1, v3
    v_lshlrev_b32 v3, 4, v3
    v_mul_u32_u24 v11, 160, v2
    v_add_u32 v11, v11, v3
    v_mul_u32_u24 v9, 1152, v2
    v_add_u32 v9, v9, v3
    v_mov_b32 v4, s33
    v_lshlrev_b32 v4, 1, v4
    v_add_u32 v9, v9, v4
    v_add_u32 v1, 256, v0
    v_mul_u32_u24 v2, 32, v1
    v_lshrrev_b32 v2, 8, v2
    v_mul_u32_u24 v3, 8, v2
    v_sub_u32 v3, v1, v3
    v_lshlrev_b32 v3, 4, v3
    v_mul_u32_u24 v12, 160, v2
    v_add_u32 v12, v12, v3
    v_mul_u32_u24 v10, 1152, v2
    v_add_u32 v10, v10, v3
    v_mov_b32 v4, s33
    v_lshlrev_b32 v4, 1, v4
    v_add_u32 v10, v10, v4
    v_lshrrev_b32 v1, 7, v0
    v_mul_u32_u24 v1, 32, v1
    v_and_b32 v2, 15, v0
    v_add_u32 v1, v1, v2
    v_mul_u32_u24 v13, 160, v1
    v_lshrrev_b32 v2, 4, v5
    v_lshlrev_b32 v3, 4, v2
    v_add_u32 v13, v13, v3
    v_add_u32 v1, s32, v1
    v_mul_u32_u24 v15, 1152, v1
    v_lshrrev_b32 v4, 6, v0
    v_and_b32 v4, 1, v4
    v_mul_u32_u24 v4, 32, v4
    v_lshlrev_b32 v3, 2, v2
    v_add_u32 v3, v3, v4
    v_add_u32 v3, s33, v3
    v_mul_u32_u24 v3, 2, v3
    v_add_u32 v15, v15, v3
    v_and_b32 v1, 15, v0
    v_lshrrev_b32 v1, 2, v1
    v_lshlrev_b32 v3, 3, v2
    v_add_u32 v1, v1, v3
    v_mul_u32_u24 v14, 160, v1
    v_and_b32 v1, 3, v0
    v_lshlrev_b32 v1, 3, v1
    v_add_u32 v14, v14, v1
    v_lshlrev_b32 v4, 1, v4
    v_add_u32 v14, v14, v4
    v_mov_b32 v64, 0
    v_mov_b32 v65, 0
    v_mov_b32 v66, 0
    v_mov_b32 v67, 0
    v_mov_b32 v68, 0
    v_mov_b32 v69, 0
    v_mov_b32 v70, 0
    v_mov_b32 v71, 0
    v_mov_b32 v72, 0
    v_mov_b32 v73, 0
    v_mov_b32 v74, 0
    v_mov_b32 v75, 0
    v_mov_b32 v76, 0
    v_mov_b32 v77, 0
    v_mov_b32 v78, 0
    v_mov_b32 v79, 0
    buffer_load_dwordx4 v[16:19], v6, s[8:11], s34 offen
    buffer_load_dwordx4 v[20:23], v7, s[8:11], s34 offen
    buffer_load_dwordx4 v[24:27], v9, s[12:15], s35 offen
    buffer_load_dwordx4 v[28:31], v10, s[12:15], s35 offen
    s_add_u32 s34, s34, 128
    s_add_u32 s35, s35, 73728
    s_waitcnt vmcnt(0)
    ds_write_b128 v8, v[16:19] offset:0
    ds_write_b128 v8, v[20:23] offset:5120
    ds_write_b128 v11, v[24:27] offset:10240
    ds_write_b128 v12, v[28:31] offset:10240
    v_add_u32 v8, 20480, v8
    v_add_u32 v11, 20480, v11
    v_add_u32 v12, 20480, v12
    buffer_load_dwordx4 v[16:19], v6, s[8:11], s34 offen
    buffer_load_dwordx4 v[20:23], v7, s[8:11], s34 offen
    buffer_load_dwordx4 v[24:27], v9, s[12:15], s35 offen
    buffer_load_dwordx4 v[28:31], v10, s[12:15], s35 offen
    s_add_u32 s34, s34, 128
    s_add_u32 s35, s35, 73728
    s_waitcnt lgkmcnt(0)
    s_barrier
    ds_read_b128 v[32:35], v13 offset:0
    ds_read_b128 v[36:39], v13 offset:2560
    ds_read_b64_tr_b16 v[48:49], v14 offset:10240
    ds_read_b64_tr_b16 v[50:51], v14 offset:10880
    ds_read_b64_tr_b16 v[52:53], v14 offset:10272
    ds_read_b64_tr_b16 v[54:55], v14 offset:10912
    s_waitcnt lgkmcnt(0)
    v_mfma_f32_16x16x32_bf16 v[64:67], v[48:51], v[32:35], v[64:67]
    ds_read_b128 v[40:43], v13 offset:64
    ds_read_b128 v[44:47], v13 offset:2624
    v_mfma_f32_16x16x32_bf16 v[68:71], v[52:55], v[32:35], v[68:71]
    ds_read_b64_tr_b16 v[56:57], v14 offset:15360
    ds_read_b64_tr_b16 v[58:59], v14 offset:16000
    v_mfma_f32_16x16x32_bf16 v[72:75], v[48:51], v[36:39], v[72:75]
    ds_read_b64_tr_b16 v[60:61], v14 offset:15392
    ds_read_b64_tr_b16 v[62:63], v14 offset:16032
    v_mfma_f32_16x16x32_bf16 v[76:79], v[52:55], v[36:39], v[76:79]
    s_waitcnt lgkmcnt(0)
    v_mfma_f32_16x16x32_bf16 v[64:67], v[56:59], v[40:43], v[64:67]
    s_waitcnt vmcnt(0)
    ds_write_b128 v8, v[16:19] offset:0
    ds_write_b128 v8, v[20:23] offset:5120
    ds_write_b128 v11, v[24:27] offset:10240
    v_mfma_f32_16x16x32_bf16 v[68:71], v[60:63], v[40:43], v[68:71]
    ds_write_b128 v12, v[28:31] offset:10240
    v_add_u32 v8, 4294946816, v8
    v_add_u32 v11, 4294946816, v11
    v_add_u32 v12, 4294946816, v12
    v_mfma_f32_16x16x32_bf16 v[72:75], v[56:59], v[44:47], v[72:75]
    buffer_load_dwordx4 v[16:19], v6, s[8:11], s34 offen
    buffer_load_dwordx4 v[20:23], v7, s[8:11], s34 offen
    buffer_load_dwordx4 v[24:27], v9, s[12:15], s35 offen
    buffer_load_dwordx4 v[28:31], v10, s[12:15], s35 offen
    v_mfma_f32_16x16x32_bf16 v[76:79], v[60:63], v[44:47], v[76:79]
    s_add_u32 s34, s34, 128
    s_add_u32 s35, s35, 73728
    v_add_u32 v13, 20480, v13
    v_add_u32 v14, 20480, v14
    s_waitcnt lgkmcnt(0)
    s_barrier
    ds_read_b128 v[32:35], v13 offset:0
    ds_read_b128 v[36:39], v13 offset:2560
    ds_read_b64_tr_b16 v[48:49], v14 offset:10240
    ds_read_b64_tr_b16 v[50:51], v14 offset:10880
    ds_read_b64_tr_b16 v[52:53], v14 offset:10272
    ds_read_b64_tr_b16 v[54:55], v14 offset:10912
    s_waitcnt lgkmcnt(0)
    v_mfma_f32_16x16x32_bf16 v[64:67], v[48:51], v[32:35], v[64:67]
    ds_read_b128 v[40:43], v13 offset:64
    ds_read_b128 v[44:47], v13 offset:2624
    v_mfma_f32_16x16x32_bf16 v[68:71], v[52:55], v[32:35], v[68:71]
    ds_read_b64_tr_b16 v[56:57], v14 offset:15360
    ds_read_b64_tr_b16 v[58:59], v14 offset:16000
    v_mfma_f32_16x16x32_bf16 v[72:75], v[48:51], v[36:39], v[72:75]
    ds_read_b64_tr_b16 v[60:61], v14 offset:15392
    ds_read_b64_tr_b16 v[62:63], v14 offset:16032
    v_mfma_f32_16x16x32_bf16 v[76:79], v[52:55], v[36:39], v[76:79]
    s_waitcnt lgkmcnt(0)
    v_mfma_f32_16x16x32_bf16 v[64:67], v[56:59], v[40:43], v[64:67]
    s_waitcnt vmcnt(0)
    ds_write_b128 v8, v[16:19] offset:0
    ds_write_b128 v8, v[20:23] offset:5120
    ds_write_b128 v11, v[24:27] offset:10240
    v_mfma_f32_16x16x32_bf16 v[68:71], v[60:63], v[40:43], v[68:71]
    ds_write_b128 v12, v[28:31] offset:10240
    v_add_u32 v8, 20480, v8
    v_add_u32 v11, 20480, v11
    v_add_u32 v12, 20480, v12
    v_mfma_f32_16x16x32_bf16 v[72:75], v[56:59], v[44:47], v[72:75]
    buffer_load_dwordx4 v[16:19], v6, s[8:11], s34 offen
    buffer_load_dwordx4 v[20:23], v7, s[8:11], s34 offen
    buffer_load_dwordx4 v[24:27], v9, s[12:15], s35 offen
    buffer_load_dwordx4 v[28:31], v10, s[12:15], s35 offen
    v_mfma_f32_16x16x32_bf16 v[76:79], v[60:63], v[44:47], v[76:79]
    s_add_u32 s34, s34, 128
    s_add_u32 s35, s35, 73728
    v_add_u32 v13, 4294946816, v13
    v_add_u32 v14, 4294946816, v14
    s_waitcnt lgkmcnt(0)
    s_barrier
    ds_read_b128 v[32:35], v13 offset:0
    ds_read_b128 v[36:39], v13 offset:2560
    ds_read_b64_tr_b16 v[48:49], v14 offset:10240
    ds_read_b64_tr_b16 v[50:51], v14 offset:10880
    ds_read_b64_tr_b16 v[52:53], v14 offset:10272
    ds_read_b64_tr_b16 v[54:55], v14 offset:10912
    s_waitcnt lgkmcnt(0)
    v_mfma_f32_16x16x32_bf16 v[64:67], v[48:51], v[32:35], v[64:67]
    ds_read_b128 v[40:43], v13 offset:64
    ds_read_b128 v[44:47], v13 offset:2624
    v_mfma_f32_16x16x32_bf16 v[68:71], v[52:55], v[32:35], v[68:71]
    ds_read_b64_tr_b16 v[56:57], v14 offset:15360
    ds_read_b64_tr_b16 v[58:59], v14 offset:16000
    v_mfma_f32_16x16x32_bf16 v[72:75], v[48:51], v[36:39], v[72:75]
    ds_read_b64_tr_b16 v[60:61], v14 offset:15392
    ds_read_b64_tr_b16 v[62:63], v14 offset:16032
    v_mfma_f32_16x16x32_bf16 v[76:79], v[52:55], v[36:39], v[76:79]
    s_waitcnt lgkmcnt(0)
    v_mfma_f32_16x16x32_bf16 v[64:67], v[56:59], v[40:43], v[64:67]
    s_waitcnt vmcnt(0)
    ds_write_b128 v8, v[16:19] offset:0
    ds_write_b128 v8, v[20:23] offset:5120
    ds_write_b128 v11, v[24:27] offset:10240
    v_mfma_f32_16x16x32_bf16 v[68:71], v[60:63], v[40:43], v[68:71]
    ds_write_b128 v12, v[28:31] offset:10240
    v_add_u32 v8, 4294946816, v8
    v_add_u32 v11, 4294946816, v11
    v_add_u32 v12, 4294946816, v12
    v_mfma_f32_16x16x32_bf16 v[72:75], v[56:59], v[44:47], v[72:75]
    buffer_load_dwordx4 v[16:19], v6, s[8:11], s34 offen
    buffer_load_dwordx4 v[20:23], v7, s[8:11], s34 offen
    buffer_load_dwordx4 v[24:27], v9, s[12:15], s35 offen
    buffer_load_dwordx4 v[28:31], v10, s[12:15], s35 offen
    v_mfma_f32_16x16x32_bf16 v[76:79], v[60:63], v[44:47], v[76:79]
    s_add_u32 s34, s34, 128
    s_add_u32 s35, s35, 73728
    v_add_u32 v13, 20480, v13
    v_add_u32 v14, 20480, v14
    s_waitcnt lgkmcnt(0)
    s_barrier
    ds_read_b128 v[32:35], v13 offset:0
    ds_read_b128 v[36:39], v13 offset:2560
    ds_read_b64_tr_b16 v[48:49], v14 offset:10240
    ds_read_b64_tr_b16 v[50:51], v14 offset:10880
    ds_read_b64_tr_b16 v[52:53], v14 offset:10272
    ds_read_b64_tr_b16 v[54:55], v14 offset:10912
    s_waitcnt lgkmcnt(0)
    v_mfma_f32_16x16x32_bf16 v[64:67], v[48:51], v[32:35], v[64:67]
    ds_read_b128 v[40:43], v13 offset:64
    ds_read_b128 v[44:47], v13 offset:2624
    v_mfma_f32_16x16x32_bf16 v[68:71], v[52:55], v[32:35], v[68:71]
    ds_read_b64_tr_b16 v[56:57], v14 offset:15360
    ds_read_b64_tr_b16 v[58:59], v14 offset:16000
    v_mfma_f32_16x16x32_bf16 v[72:75], v[48:51], v[36:39], v[72:75]
    ds_read_b64_tr_b16 v[60:61], v14 offset:15392
    ds_read_b64_tr_b16 v[62:63], v14 offset:16032
    v_mfma_f32_16x16x32_bf16 v[76:79], v[52:55], v[36:39], v[76:79]
    s_waitcnt lgkmcnt(0)
    v_mfma_f32_16x16x32_bf16 v[64:67], v[56:59], v[40:43], v[64:67]
    s_waitcnt vmcnt(0)
    ds_write_b128 v8, v[16:19] offset:0
    ds_write_b128 v8, v[20:23] offset:5120
    ds_write_b128 v11, v[24:27] offset:10240
    v_mfma_f32_16x16x32_bf16 v[68:71], v[60:63], v[40:43], v[68:71]
    ds_write_b128 v12, v[28:31] offset:10240
    v_add_u32 v8, 20480, v8
    v_add_u32 v11, 20480, v11
    v_add_u32 v12, 20480, v12
    v_mfma_f32_16x16x32_bf16 v[72:75], v[56:59], v[44:47], v[72:75]
    buffer_load_dwordx4 v[16:19], v6, s[8:11], s34 offen
    buffer_load_dwordx4 v[20:23], v7, s[8:11], s34 offen
    buffer_load_dwordx4 v[24:27], v9, s[12:15], s35 offen
    buffer_load_dwordx4 v[28:31], v10, s[12:15], s35 offen
    v_mfma_f32_16x16x32_bf16 v[76:79], v[60:63], v[44:47], v[76:79]
    s_add_u32 s34, s34, 128
    s_add_u32 s35, s35, 73728
    v_add_u32 v13, 4294946816, v13
    v_add_u32 v14, 4294946816, v14
    s_waitcnt lgkmcnt(0)
    s_barrier
    ds_read_b128 v[32:35], v13 offset:0
    ds_read_b128 v[36:39], v13 offset:2560
    ds_read_b64_tr_b16 v[48:49], v14 offset:10240
    ds_read_b64_tr_b16 v[50:51], v14 offset:10880
    ds_read_b64_tr_b16 v[52:53], v14 offset:10272
    ds_read_b64_tr_b16 v[54:55], v14 offset:10912
    s_waitcnt lgkmcnt(0)
    v_mfma_f32_16x16x32_bf16 v[64:67], v[48:51], v[32:35], v[64:67]
    ds_read_b128 v[40:43], v13 offset:64
    ds_read_b128 v[44:47], v13 offset:2624
    v_mfma_f32_16x16x32_bf16 v[68:71], v[52:55], v[32:35], v[68:71]
    ds_read_b64_tr_b16 v[56:57], v14 offset:15360
    ds_read_b64_tr_b16 v[58:59], v14 offset:16000
    v_mfma_f32_16x16x32_bf16 v[72:75], v[48:51], v[36:39], v[72:75]
    ds_read_b64_tr_b16 v[60:61], v14 offset:15392
    ds_read_b64_tr_b16 v[62:63], v14 offset:16032
    v_mfma_f32_16x16x32_bf16 v[76:79], v[52:55], v[36:39], v[76:79]
    s_waitcnt lgkmcnt(0)
    v_mfma_f32_16x16x32_bf16 v[64:67], v[56:59], v[40:43], v[64:67]
    s_waitcnt vmcnt(0)
    ds_write_b128 v8, v[16:19] offset:0
    ds_write_b128 v8, v[20:23] offset:5120
    ds_write_b128 v11, v[24:27] offset:10240
    v_mfma_f32_16x16x32_bf16 v[68:71], v[60:63], v[40:43], v[68:71]
    ds_write_b128 v12, v[28:31] offset:10240
    v_add_u32 v8, 4294946816, v8
    v_add_u32 v11, 4294946816, v11
    v_add_u32 v12, 4294946816, v12
    v_mfma_f32_16x16x32_bf16 v[72:75], v[56:59], v[44:47], v[72:75]
    buffer_load_dwordx4 v[16:19], v6, s[8:11], s34 offen
    buffer_load_dwordx4 v[20:23], v7, s[8:11], s34 offen
    buffer_load_dwordx4 v[24:27], v9, s[12:15], s35 offen
    buffer_load_dwordx4 v[28:31], v10, s[12:15], s35 offen
    v_mfma_f32_16x16x32_bf16 v[76:79], v[60:63], v[44:47], v[76:79]
    s_add_u32 s34, s34, 128
    s_add_u32 s35, s35, 73728
    v_add_u32 v13, 20480, v13
    v_add_u32 v14, 20480, v14
    s_waitcnt lgkmcnt(0)
    s_barrier
    ds_read_b128 v[32:35], v13 offset:0
    ds_read_b128 v[36:39], v13 offset:2560
    ds_read_b64_tr_b16 v[48:49], v14 offset:10240
    ds_read_b64_tr_b16 v[50:51], v14 offset:10880
    ds_read_b64_tr_b16 v[52:53], v14 offset:10272
    ds_read_b64_tr_b16 v[54:55], v14 offset:10912
    s_waitcnt lgkmcnt(0)
    v_mfma_f32_16x16x32_bf16 v[64:67], v[48:51], v[32:35], v[64:67]
    ds_read_b128 v[40:43], v13 offset:64
    ds_read_b128 v[44:47], v13 offset:2624
    v_mfma_f32_16x16x32_bf16 v[68:71], v[52:55], v[32:35], v[68:71]
    ds_read_b64_tr_b16 v[56:57], v14 offset:15360
    ds_read_b64_tr_b16 v[58:59], v14 offset:16000
    v_mfma_f32_16x16x32_bf16 v[72:75], v[48:51], v[36:39], v[72:75]
    ds_read_b64_tr_b16 v[60:61], v14 offset:15392
    ds_read_b64_tr_b16 v[62:63], v14 offset:16032
    v_mfma_f32_16x16x32_bf16 v[76:79], v[52:55], v[36:39], v[76:79]
    s_waitcnt lgkmcnt(0)
    v_mfma_f32_16x16x32_bf16 v[64:67], v[56:59], v[40:43], v[64:67]
    s_waitcnt vmcnt(0)
    ds_write_b128 v8, v[16:19] offset:0
    ds_write_b128 v8, v[20:23] offset:5120
    ds_write_b128 v11, v[24:27] offset:10240
    v_mfma_f32_16x16x32_bf16 v[68:71], v[60:63], v[40:43], v[68:71]
    ds_write_b128 v12, v[28:31] offset:10240
    v_add_u32 v8, 20480, v8
    v_add_u32 v11, 20480, v11
    v_add_u32 v12, 20480, v12
    v_mfma_f32_16x16x32_bf16 v[72:75], v[56:59], v[44:47], v[72:75]
    buffer_load_dwordx4 v[16:19], v6, s[8:11], s34 offen
    buffer_load_dwordx4 v[20:23], v7, s[8:11], s34 offen
    buffer_load_dwordx4 v[24:27], v9, s[12:15], s35 offen
    buffer_load_dwordx4 v[28:31], v10, s[12:15], s35 offen
    v_mfma_f32_16x16x32_bf16 v[76:79], v[60:63], v[44:47], v[76:79]
    s_add_u32 s34, s34, 128
    s_add_u32 s35, s35, 73728
    v_add_u32 v13, 4294946816, v13
    v_add_u32 v14, 4294946816, v14
    s_waitcnt lgkmcnt(0)
    s_barrier
    ds_read_b128 v[32:35], v13 offset:0
    ds_read_b128 v[36:39], v13 offset:2560
    ds_read_b64_tr_b16 v[48:49], v14 offset:10240
    ds_read_b64_tr_b16 v[50:51], v14 offset:10880
    ds_read_b64_tr_b16 v[52:53], v14 offset:10272
    ds_read_b64_tr_b16 v[54:55], v14 offset:10912
    s_waitcnt lgkmcnt(0)
    v_mfma_f32_16x16x32_bf16 v[64:67], v[48:51], v[32:35], v[64:67]
    ds_read_b128 v[40:43], v13 offset:64
    ds_read_b128 v[44:47], v13 offset:2624
    v_mfma_f32_16x16x32_bf16 v[68:71], v[52:55], v[32:35], v[68:71]
    ds_read_b64_tr_b16 v[56:57], v14 offset:15360
    ds_read_b64_tr_b16 v[58:59], v14 offset:16000
    v_mfma_f32_16x16x32_bf16 v[72:75], v[48:51], v[36:39], v[72:75]
    ds_read_b64_tr_b16 v[60:61], v14 offset:15392
    ds_read_b64_tr_b16 v[62:63], v14 offset:16032
    v_mfma_f32_16x16x32_bf16 v[76:79], v[52:55], v[36:39], v[76:79]
    s_waitcnt lgkmcnt(0)
    v_mfma_f32_16x16x32_bf16 v[64:67], v[56:59], v[40:43], v[64:67]
    s_waitcnt vmcnt(0)
    ds_write_b128 v8, v[16:19] offset:0
    ds_write_b128 v8, v[20:23] offset:5120
    ds_write_b128 v11, v[24:27] offset:10240
    v_mfma_f32_16x16x32_bf16 v[68:71], v[60:63], v[40:43], v[68:71]
    ds_write_b128 v12, v[28:31] offset:10240
    v_add_u32 v8, 4294946816, v8
    v_add_u32 v11, 4294946816, v11
    v_add_u32 v12, 4294946816, v12
    v_mfma_f32_16x16x32_bf16 v[72:75], v[56:59], v[44:47], v[72:75]
    buffer_load_dwordx4 v[16:19], v6, s[8:11], s34 offen
    buffer_load_dwordx4 v[20:23], v7, s[8:11], s34 offen
    buffer_load_dwordx4 v[24:27], v9, s[12:15], s35 offen
    buffer_load_dwordx4 v[28:31], v10, s[12:15], s35 offen
    v_mfma_f32_16x16x32_bf16 v[76:79], v[60:63], v[44:47], v[76:79]
    s_add_u32 s34, s34, 128
    s_add_u32 s35, s35, 73728
    v_add_u32 v13, 20480, v13
    v_add_u32 v14, 20480, v14
    s_waitcnt lgkmcnt(0)
    s_barrier
    ds_read_b128 v[32:35], v13 offset:0
    ds_read_b128 v[36:39], v13 offset:2560
    ds_read_b64_tr_b16 v[48:49], v14 offset:10240
    ds_read_b64_tr_b16 v[50:51], v14 offset:10880
    ds_read_b64_tr_b16 v[52:53], v14 offset:10272
    ds_read_b64_tr_b16 v[54:55], v14 offset:10912
    s_waitcnt lgkmcnt(0)
    v_mfma_f32_16x16x32_bf16 v[64:67], v[48:51], v[32:35], v[64:67]
    ds_read_b128 v[40:43], v13 offset:64
    ds_read_b128 v[44:47], v13 offset:2624
    v_mfma_f32_16x16x32_bf16 v[68:71], v[52:55], v[32:35], v[68:71]
    ds_read_b64_tr_b16 v[56:57], v14 offset:15360
    ds_read_b64_tr_b16 v[58:59], v14 offset:16000
    v_mfma_f32_16x16x32_bf16 v[72:75], v[48:51], v[36:39], v[72:75]
    ds_read_b64_tr_b16 v[60:61], v14 offset:15392
    ds_read_b64_tr_b16 v[62:63], v14 offset:16032
    v_mfma_f32_16x16x32_bf16 v[76:79], v[52:55], v[36:39], v[76:79]
    s_waitcnt lgkmcnt(0)
    v_mfma_f32_16x16x32_bf16 v[64:67], v[56:59], v[40:43], v[64:67]
    s_waitcnt vmcnt(0)
    ds_write_b128 v8, v[16:19] offset:0
    v_mfma_f32_16x16x32_bf16 v[68:71], v[60:63], v[40:43], v[68:71]
    ds_write_b128 v8, v[20:23] offset:5120
    ds_write_b128 v11, v[24:27] offset:10240
    v_mfma_f32_16x16x32_bf16 v[72:75], v[56:59], v[44:47], v[72:75]
    ds_write_b128 v12, v[28:31] offset:10240
    v_add_u32 v8, 20480, v8
    v_mfma_f32_16x16x32_bf16 v[76:79], v[60:63], v[44:47], v[76:79]
    v_add_u32 v11, 20480, v11
    v_add_u32 v12, 20480, v12
    v_add_u32 v13, 4294946816, v13
    v_add_u32 v14, 4294946816, v14
    s_waitcnt lgkmcnt(0)
    s_barrier
    ds_read_b128 v[32:35], v13 offset:0
    ds_read_b128 v[36:39], v13 offset:2560
    ds_read_b64_tr_b16 v[48:49], v14 offset:10240
    ds_read_b64_tr_b16 v[50:51], v14 offset:10880
    ds_read_b64_tr_b16 v[52:53], v14 offset:10272
    ds_read_b64_tr_b16 v[54:55], v14 offset:10912
    s_waitcnt lgkmcnt(0)
    v_mfma_f32_16x16x32_bf16 v[64:67], v[48:51], v[32:35], v[64:67]
    ds_read_b128 v[40:43], v13 offset:64
    ds_read_b128 v[44:47], v13 offset:2624
    v_mfma_f32_16x16x32_bf16 v[68:71], v[52:55], v[32:35], v[68:71]
    ds_read_b64_tr_b16 v[56:57], v14 offset:15360
    ds_read_b64_tr_b16 v[58:59], v14 offset:16000
    v_mfma_f32_16x16x32_bf16 v[72:75], v[48:51], v[36:39], v[72:75]
    ds_read_b64_tr_b16 v[60:61], v14 offset:15392
    ds_read_b64_tr_b16 v[62:63], v14 offset:16032
    v_mfma_f32_16x16x32_bf16 v[76:79], v[52:55], v[36:39], v[76:79]
    s_waitcnt lgkmcnt(0)
    v_mfma_f32_16x16x32_bf16 v[64:67], v[56:59], v[40:43], v[64:67]
    v_mfma_f32_16x16x32_bf16 v[68:71], v[60:63], v[40:43], v[68:71]
    v_mfma_f32_16x16x32_bf16 v[72:75], v[56:59], v[44:47], v[72:75]
    v_mfma_f32_16x16x32_bf16 v[76:79], v[60:63], v[44:47], v[76:79]
    s_nop 7
    s_nop 7
    v_cvt_pk_bf16_f32 v16, v64, v65
    v_cvt_pk_bf16_f32 v17, v66, v67
    v_lshlrev_b32 v18, 16, v16
    v_and_b32 v19, 0xffff0000, v16
    v_lshlrev_b32 v20, 16, v17
    v_and_b32 v21, 0xffff0000, v17
    s_mov_b32 s6, 0xbdd2d3e8
    s_mov_b32 s7, 0xc0135761
    v_mul_f32 v28, v18, v18
    v_mul_f32 v29, v19, v19
    v_mul_f32 v30, v20, v20
    v_mul_f32 v31, v21, v21
    v_mov_b32 v22, s7
    v_fma_f32 v28, v28, s6, v22
    v_mov_b32 v22, s7
    v_fma_f32 v29, v29, s6, v22
    v_mov_b32 v22, s7
    v_fma_f32 v30, v30, s6, v22
    v_mov_b32 v22, s7
    v_fma_f32 v31, v31, s6, v22
    v_mul_f32 v28, v28, v18
    v_mul_f32 v29, v29, v19
    v_mul_f32 v30, v30, v20
    v_mul_f32 v31, v31, v21
    v_exp_f32 v28, v28
    v_exp_f32 v29, v29
    v_exp_f32 v30, v30
    v_exp_f32 v31, v31
    s_nop 0
    v_add_f32 v28, 1.0, v28
    v_add_f32 v29, 1.0, v29
    v_add_f32 v30, 1.0, v30
    v_add_f32 v31, 1.0, v31
    v_rcp_f32 v28, v28
    v_rcp_f32 v29, v29
    v_rcp_f32 v30, v30
    v_rcp_f32 v31, v31
    s_nop 0
    v_mul_f32 v28, v28, v18
    v_mul_f32 v29, v29, v19
    v_mul_f32 v30, v30, v20
    v_mul_f32 v31, v31, v21
    v_cvt_pk_bf16_f32 v16, v28, v29
    v_cvt_pk_bf16_f32 v17, v30, v31
    buffer_store_dwordx2 v[16:17], v15, s[16:19], 0 offen offset:0
    s_nop 1
    v_cvt_pk_bf16_f32 v16, v68, v69
    v_cvt_pk_bf16_f32 v17, v70, v71
    v_lshlrev_b32 v18, 16, v16
    v_and_b32 v19, 0xffff0000, v16
    v_lshlrev_b32 v20, 16, v17
    v_and_b32 v21, 0xffff0000, v17
    s_mov_b32 s6, 0xbdd2d3e8
    s_mov_b32 s7, 0xc0135761
    v_mul_f32 v28, v18, v18
    v_mul_f32 v29, v19, v19
    v_mul_f32 v30, v20, v20
    v_mul_f32 v31, v21, v21
    v_mov_b32 v22, s7
    v_fma_f32 v28, v28, s6, v22
    v_mov_b32 v22, s7
    v_fma_f32 v29, v29, s6, v22
    v_mov_b32 v22, s7
    v_fma_f32 v30, v30, s6, v22
    v_mov_b32 v22, s7
    v_fma_f32 v31, v31, s6, v22
    v_mul_f32 v28, v28, v18
    v_mul_f32 v29, v29, v19
    v_mul_f32 v30, v30, v20
    v_mul_f32 v31, v31, v21
    v_exp_f32 v28, v28
    v_exp_f32 v29, v29
    v_exp_f32 v30, v30
    v_exp_f32 v31, v31
    s_nop 0
    v_add_f32 v28, 1.0, v28
    v_add_f32 v29, 1.0, v29
    v_add_f32 v30, 1.0, v30
    v_add_f32 v31, 1.0, v31
    v_rcp_f32 v28, v28
    v_rcp_f32 v29, v29
    v_rcp_f32 v30, v30
    v_rcp_f32 v31, v31
    s_nop 0
    v_mul_f32 v28, v28, v18
    v_mul_f32 v29, v29, v19
    v_mul_f32 v30, v30, v20
    v_mul_f32 v31, v31, v21
    v_cvt_pk_bf16_f32 v16, v28, v29
    v_cvt_pk_bf16_f32 v17, v30, v31
    buffer_store_dwordx2 v[16:17], v15, s[16:19], 0 offen offset:32
    s_nop 1
    v_add_u32 v15, 18432, v15
    v_cvt_pk_bf16_f32 v16, v72, v73
    v_cvt_pk_bf16_f32 v17, v74, v75
    v_lshlrev_b32 v18, 16, v16
    v_and_b32 v19, 0xffff0000, v16
    v_lshlrev_b32 v20, 16, v17
    v_and_b32 v21, 0xffff0000, v17
    s_mov_b32 s6, 0xbdd2d3e8
    s_mov_b32 s7, 0xc0135761
    v_mul_f32 v28, v18, v18
    v_mul_f32 v29, v19, v19
    v_mul_f32 v30, v20, v20
    v_mul_f32 v31, v21, v21
    v_mov_b32 v22, s7
    v_fma_f32 v28, v28, s6, v22
    v_mov_b32 v22, s7
    v_fma_f32 v29, v29, s6, v22
    v_mov_b32 v22, s7
    v_fma_f32 v30, v30, s6, v22
    v_mov_b32 v22, s7
    v_fma_f32 v31, v31, s6, v22
    v_mul_f32 v28, v28, v18
    v_mul_f32 v29, v29, v19
    v_mul_f32 v30, v30, v20
    v_mul_f32 v31, v31, v21
    v_exp_f32 v28, v28
    v_exp_f32 v29, v29
    v_exp_f32 v30, v30
    v_exp_f32 v31, v31
    s_nop 0
    v_add_f32 v28, 1.0, v28
    v_add_f32 v29, 1.0, v29
    v_add_f32 v30, 1.0, v30
    v_add_f32 v31, 1.0, v31
    v_rcp_f32 v28, v28
    v_rcp_f32 v29, v29
    v_rcp_f32 v30, v30
    v_rcp_f32 v31, v31
    s_nop 0
    v_mul_f32 v28, v28, v18
    v_mul_f32 v29, v29, v19
    v_mul_f32 v30, v30, v20
    v_mul_f32 v31, v31, v21
    v_cvt_pk_bf16_f32 v16, v28, v29
    v_cvt_pk_bf16_f32 v17, v30, v31
    buffer_store_dwordx2 v[16:17], v15, s[16:19], 0 offen offset:0
    s_nop 1
    v_cvt_pk_bf16_f32 v16, v76, v77
    v_cvt_pk_bf16_f32 v17, v78, v79
    v_lshlrev_b32 v18, 16, v16
    v_and_b32 v19, 0xffff0000, v16
    v_lshlrev_b32 v20, 16, v17
    v_and_b32 v21, 0xffff0000, v17
    s_mov_b32 s6, 0xbdd2d3e8
    s_mov_b32 s7, 0xc0135761
    v_mul_f32 v28, v18, v18
    v_mul_f32 v29, v19, v19
    v_mul_f32 v30, v20, v20
    v_mul_f32 v31, v21, v21
    v_mov_b32 v22, s7
    v_fma_f32 v28, v28, s6, v22
    v_mov_b32 v22, s7
    v_fma_f32 v29, v29, s6, v22
    v_mov_b32 v22, s7
    v_fma_f32 v30, v30, s6, v22
    v_mov_b32 v22, s7
    v_fma_f32 v31, v31, s6, v22
    v_mul_f32 v28, v28, v18
    v_mul_f32 v29, v29, v19
    v_mul_f32 v30, v30, v20
    v_mul_f32 v31, v31, v21
    v_exp_f32 v28, v28
    v_exp_f32 v29, v29
    v_exp_f32 v30, v30
    v_exp_f32 v31, v31
    s_nop 0
    v_add_f32 v28, 1.0, v28
    v_add_f32 v29, 1.0, v29
    v_add_f32 v30, 1.0, v30
    v_add_f32 v31, 1.0, v31
    v_rcp_f32 v28, v28
    v_rcp_f32 v29, v29
    v_rcp_f32 v30, v30
    v_rcp_f32 v31, v31
    s_nop 0
    v_mul_f32 v28, v28, v18
    v_mul_f32 v29, v29, v19
    v_mul_f32 v30, v30, v20
    v_mul_f32 v31, v31, v21
    v_cvt_pk_bf16_f32 v16, v28, v29
    v_cvt_pk_bf16_f32 v17, v30, v31
    buffer_store_dwordx2 v[16:17], v15, s[16:19], 0 offen offset:32
    s_nop 1
    s_waitcnt vmcnt(0)
k_w1_kernel_end:
    s_endpgm
.section .rodata,"a"
.p2align 6
.amdhsa_kernel k_w1_kernel
  .amdhsa_next_free_vgpr 80
  .amdhsa_next_free_sgpr 80
  .amdhsa_accum_offset 80
  .amdhsa_group_segment_fixed_size 0
  .amdhsa_kernarg_size 88
  .amdhsa_user_sgpr_count 2
  .amdhsa_user_sgpr_kernarg_segment_ptr 1
  .amdhsa_system_sgpr_workgroup_id_x 1
.end_amdhsa_kernel
.text
.globl k_w2_kernel
.p2align 8
.type k_w2_kernel,@function
k_w2_kernel:
    s_cmp_ge_u32 s2, 288
    s_cbranch_scc1 k_w2_kernel_end
    s_load_dwordx2 s[36:37], s[0:1], 80
    s_load_dwordx2 s[38:39], s[0:1], 40
    s_mov_b32 s3, 0
    s_mov_b32 s6, s2
    s_mul_i32 s4, s6, 57
    s_lshr_b32 s4, s4, 9
    s_mul_i32 s5, s4, 9
    s_sub_u32 s5, s6, s5
    s_waitcnt lgkmcnt(0)
    s_add_u32 s8, s36, 14155776
    s_addc_u32 s9, s37, 0
    s_mov_b32 s10, 2359296
    s_mov_b32 s11, 0x00020000
    s_mov_b32 s12, s38
    s_mov_b32 s13, s39
    s_mov_b32 s14, 663552
    s_mov_b32 s15, 0x00020000
    s_add_u32 s16, s36, 16515072
    s_addc_u32 s17, s37, 0
    s_mov_b32 s18, 2359296
    s_mov_b32 s19, 0x00020000
    s_add_u32 s20, s36, 11796480
    s_addc_u32 s21, s37, 0
    s_mov_b32 s22, 2359296
    s_mov_b32 s23, 0x00020000
    s_mul_i32 s32, s4, 64
    s_mul_i32 s33, s5, 64
    s_mul_i32 s34, s3, 1152
    s_mul_i32 s35, s3, 663552
    v_and_b32 v5, 63, v0
    v_lshrrev_b32 v1, 3, v0
    v_and_b32 v2, 7, v0
    v_lshlrev_b32 v2, 4, v2
    v_mul_u32_u24 v8, 160, v1
    v_add_u32 v8, v8, v2
    v_add_u32 v3, s32, v1
    v_mul_u32_u24 v3, 1152, v3
    v_add_u32 v6, v3, v2
    v_add_u32 v7, 36864, v6
    v_lshrrev_b32 v16, 1, v2
    v_add_u32 v1, 0, v0
    v_mul_u32_u24 v2, 32, v1
    v_lshrrev_b32 v2, 8, v2
    v_mul_u32_u24 v3, 8, v2
    v_sub_u32 v3, v1, v3
    v_lshlrev_b32 v3, 4, v3
    v_mul_u32_u24 v11, 160, v2
    v_add_u32 v11, v11, v3
    v_mul_u32_u24 v9, 1152, v2
    v_add_u32 v9, v9, v3
    v_mov_b32 v4, s33
    v_lshlrev_b32 v4, 1, v4
    v_add_u32 v9, v9, v4
    v_add_u32 v1, 256, v0
    v_mul_u32_u24 v2, 32, v1
    v_lshrrev_b32 v2, 8, v2
    v_mul_u32_u24 v3, 8, v2
    v_sub_u32 v3, v1, v3
    v_lshlrev_b32 v3, 4, v3
    v_mul_u32_u24 v12, 160, v2
    v_add_u32 v12, v12, v3
    v_mul_u32_u24 v10, 1152, v2
    v_add_u32 v10, v10, v3
    v_mov_b32 v4, s33
    v_lshlrev_b32 v4, 1, v4
    v_add_u32 v10, v10, v4
    v_lshrrev_b32 v1, 7, v0
    v_mul_u32_u24 v1, 32, v1
    v_and_b32 v2, 15, v0
    v_add_u32 v1, v1, v2
    v_mul_u32_u24 v13, 160, v1
    v_lshrrev_b32 v2, 4, v5
    v_lshlrev_b32 v3, 4, v2
    v_add_u32 v13, v13, v3
    v_add_u32 v1, s32, v1
    v_mul_u32_u24 v15, 1152, v1
    v_lshrrev_b32 v4, 6, v0
    v_and_b32 v4, 1, v4
    v_mul_u32_u24 v4, 32, v4
    v_lshlrev_b32 v3, 2, v2
    v_add_u32 v3, v3, v4
    v_add_u32 v3, s33, v3
    v_mul_u32_u24 v3, 2, v3
    v_add_u32 v15, v15, v3
    v_and_b32 v1, 15, v0
    v_lshrrev_b32 v1, 2, v1
    v_lshlrev_b32 v3, 3, v2
    v_add_u32 v1, v1, v3
    v_mul_u32_u24 v14, 160, v1
    v_and_b32 v1, 3, v0
    v_lshlrev_b32 v1, 3, v1
    v_add_u32 v14, v14, v1
    v_lshlrev_b32 v4, 1, v4
    v_add_u32 v14, v14, v4
    v_mov_b32 v68, 0
    v_mov_b32 v69, 0
    v_mov_b32 v70, 0
    v_mov_b32 v71, 0
    v_mov_b32 v72, 0
    v_mov_b32 v73, 0
    v_mov_b32 v74, 0
    v_mov_b32 v75, 0
    v_mov_b32 v76, 0
    v_mov_b32 v77, 0
    v_mov_b32 v78, 0
    v_mov_b32 v79, 0
    v_mov_b32 v80, 0
    v_mov_b32 v81, 0
    v_mov_b32 v82, 0
    v_mov_b32 v83, 0
    v_add_u32 v1, 0, v16
    v_mov_b32 v17, 4294966144
    v_mov_b32 v2, 1152
    v_cmp_le_u32 vcc, 144, v1
    s_nop 1
    v_cndmask_b32 v17, v17, v2, vcc
    v_mov_b32 v2, 4294964992
    v_cmp_le_u32 vcc, 288, v1
    s_nop 1
    v_cndmask_b32 v17, v17, v2, vcc
    v_mov_b32 v2, 2304
    v_cmp_le_u32 vcc, 432, v1
    s_nop 1
    v_cndmask_b32 v17, v17, v2, vcc
    v_add_u32 v2, v6, v17
    buffer_load_dwordx4 v[20:23], v2, s[8:11], s34 offen
    v_add_u32 v2, v7, v17
    buffer_load_dwordx4 v[24:27], v2, s[8:11], s34 offen
    buffer_load_dwordx4 v[28:31], v9, s[12:15], s35 offen
    buffer_load_dwordx4 v[32:35], v10, s[12:15], s35 offen
    s_add_u32 s34, s34, 128
    s_add_u32 s35, s35, 73728
    s_waitcnt vmcnt(0)
    ds_write_b128 v8, v[20:23] offset:0
    ds_write_b128 v8, v[24:27] offset:5120
    ds_write_b128 v11, v[28:31] offset:10240
    ds_write_b128 v12, v[32:35] offset:10240
    v_add_u32 v8, 20480, v8
    v_add_u32 v11, 20480, v11
    v_add_u32 v12, 20480, v12
    v_add_u32 v1, 64, v16
    v_mov_b32 v17, 4294966144
    v_mov_b32 v2, 1152
    v_cmp_le_u32 vcc, 144, v1
    s_nop 1
    v_cndmask_b32 v17, v17, v2, vcc
    v_mov_b32 v2, 4294964992
    v_cmp_le_u32 vcc, 288, v1
    s_nop 1
    v_cndmask_b32 v17, v17, v2, vcc
    v_mov_b32 v2, 2304
    v_cmp_le_u32 vcc, 432, v1
    s_nop 1
    v_cndmask_b32 v17, v17, v2, vcc
    v_add_u32 v2, v6, v17
    buffer_load_dwordx4 v[20:23], v2, s[8:11], s34 offen
    v_add_u32 v2, v7, v17
    buffer_load_dwordx4 v[24:27], v2, s[8:11], s34 offen
    buffer_load_dwordx4 v[28:31], v9, s[12:15], s35 offen
    buffer_load_dwordx4 v[32:35], v10, s[12:15], s35 offen
    s_add_u32 s34, s34, 128
    s_add_u32 s35, s35, 73728
    s_waitcnt lgkmcnt(0)
    s_barrier
    ds_read_b128 v[36:39], v13 offset:0
    ds_read_b128 v[40:43], v13 offset:2560
    ds_read_b64_tr_b16 v[52:53], v14 offset:10240
    ds_read_b64_tr_b16 v[54:55], v14 offset:10880
    ds_read_b64_tr_b16 v[56:57], v14 offset:10272
    ds_read_b64_tr_b16 v[58:59], v14 offset:10912
    s_waitcnt lgkmcnt(0)
    v_mfma_f32_16x16x32_bf16 v[68:71], v[52:55], v[36:39], v[68:71]
    ds_read_b128 v[44:47], v13 offset:64
    ds_read_b128 v[48:51], v13 offset:2624
    v_mfma_f32_16x16x32_bf16 v[72:75], v[56:59], v[36:39], v[72:75]
    ds_read_b64_tr_b16 v[60:61], v14 offset:15360
    ds_read_b64_tr_b16 v[62:63], v14 offset:16000
    v_mfma_f32_16x16x32_bf16 v[76:79], v[52:55], v[40:43], v[76:79]
    ds_read_b64_tr_b16 v[64:65], v14 offset:15392
    ds_read_b64_tr_b16 v[66:67], v14 offset:16032
    v_mfma_f32_16x16x32_bf16 v[80:83], v[56:59], v[40:43], v[80:83]
    s_waitcnt lgkmcnt(0)
    v_mfma_f32_16x16x32_bf16 v[68:71], v[60:63], v[44:47], v[68:71]
    s_waitcnt vmcnt(0)
    ds_write_b128 v8, v[20:23] offset:0
    ds_write_b128 v8, v[24:27] offset:5120
    ds_write_b128 v11, v[28:31] offset:10240
    ds_write_b128 v12, v[32:35] offset:10240
    v_add_u32 v8, 4294946816, v8
    v_add_u32 v11, 4294946816, v11
    v_add_u32 v12, 4294946816, v12
    v_mfma_f32_16x16x32_bf16 v[72:75], v[64:67], v[44:47], v[72:75]
    v_add_u32 v1, 128, v16
    v_mov_b32 v17, 4294966144
    v_mov_b32 v2, 1152
    v_cmp_le_u32 vcc, 144, v1
    s_nop 1
    v_cndmask_b32 v17, v17, v2, vcc
    v_mov_b32 v2, 4294964992
    v_cmp_le_u32 vcc, 288, v1
    v_mfma_f32_16x16x32_bf16 v[76:79], v[60:63], v[48:51], v[76:79]
    s_nop 1
    v_cndmask_b32 v17, v17, v2, vcc
    v_mov_b32 v2, 2304
    v_cmp_le_u32 vcc, 432, v1
    s_nop 1
    v_cndmask_b32 v17, v17, v2, vcc
    v_add_u32 v2, v6, v17
    buffer_load_dwordx4 v[20:23], v2, s[8:11], s34 offen
    v_mfma_f32_16x16x32_bf16 v[80:83], v[64:67], v[48:51], v[80:83]
    v_add_u32 v2, v7, v17
    buffer_load_dwordx4 v[24:27], v2, s[8:11], s34 offen
    buffer_load_dwordx4 v[28:31], v9, s[12:15], s35 offen
    buffer_load_dwordx4 v[32:35], v10, s[12:15], s35 offen
    s_add_u32 s34, s34, 128
    s_add_u32 s35, s35, 73728
    v_add_u32 v13, 20480, v13
    v_add_u32 v14, 20480, v14
    s_waitcnt lgkmcnt(0)
    s_barrier
    ds_read_b128 v[36:39], v13 offset:0
    ds_read_b128 v[40:43], v13 offset:2560
    ds_read_b64_tr_b16 v[52:53], v14 offset:10240
    ds_read_b64_tr_b16 v[54:55], v14 offset:10880
    ds_read_b64_tr_b16 v[56:57], v14 offset:10272
    ds_read_b64_tr_b16 v[58:59], v14 offset:10912
    s_waitcnt lgkmcnt(0)
    v_mfma_f32_16x16x32_bf16 v[68:71], v[52:55], v[36:39], v[68:71]
    ds_read_b128 v[44:47], v13 offset:64
    ds_read_b128 v[48:51], v13 offset:2624
    v_mfma_f32_16x16x32_bf16 v[72:75], v[56:59], v[36:39], v[72:75]
    ds_read_b64_tr_b16 v[60:61], v14 offset:15360
    ds_read_b64_tr_b16 v[62:63], v14 offset:16000
    v_mfma_f32_16x16x32_bf16 v[76:79], v[52:55], v[40:43], v[76:79]
    ds_read_b64_tr_b16 v[64:65], v14 offset:15392
    ds_read_b64_tr_b16 v[66:67], v14 offset:16032
    v_mfma_f32_16x16x32_bf16 v[80:83], v[56:59], v[40:43], v[80:83]
    s_waitcnt lgkmcnt(0)
    v_mfma_f32_16x16x32_bf16 v[68:71], v[60:63], v[44:47], v[68:71]
    s_waitcnt vmcnt(0)
    ds_write_b128 v8, v[20:23] offset:0
    ds_write_b128 v8, v[24:27] offset:5120
    ds_write_b128 v11, v[28:31] offset:10240
    ds_write_b128 v12, v[32:35] offset:10240
    v_add_u32 v8, 20480, v8
    v_add_u32 v11, 20480, v11
    v_add_u32 v12, 20480, v12
    v_mfma_f32_16x16x32_bf16 v[72:75], v[64:67], v[44:47], v[72:75]
    v_add_u32 v1, 192, v16
    v_mov_b32 v17, 4294966144
    v_mov_b32 v2, 1152
    v_cmp_le_u32 vcc, 144, v1
    s_nop 1
    v_cndmask_b32 v17, v17, v2, vcc
    v_mov_b32 v2, 4294964992
    v_cmp_le_u32 vcc, 288, v1
    v_mfma_f32_16x16x32_bf16 v[76:79], v[60:63], v[48:51], v[76:79]
    s_nop 1
    v_cndmask_b32 v17, v17, v2, vcc
    v_mov_b32 v2, 2304
    v_cmp_le_u32 vcc, 432, v1
    s_nop 1
    v_cndmask_b32 v17, v17, v2, vcc
    v_add_u32 v2, v6, v17
    buffer_load_dwordx4 v[20:23], v2, s[8:11], s34 offen
    v_mfma_f32_16x16x32_bf16 v[80:83], v[64:67], v[48:51], v[80:83]
    v_add_u32 v2, v7, v17
    buffer_load_dwordx4 v[24:27], v2, s[8:11], s34 offen
    buffer_load_dwordx4 v[28:31], v9, s[12:15], s35 offen
    buffer_load_dwordx4 v[32:35], v10, s[12:15], s35 offen
    s_add_u32 s34, s34, 128
    s_add_u32 s35, s35, 73728
    v_add_u32 v13, 4294946816, v13
    v_add_u32 v14, 4294946816, v14
    s_waitcnt lgkmcnt(0)
    s_barrier
    ds_read_b128 v[36:39], v13 offset:0
    ds_read_b128 v[40:43], v13 offset:2560
    ds_read_b64_tr_b16 v[52:53], v14 offset:10240
    ds_read_b64_tr_b16 v[54:55], v14 offset:10880
    ds_read_b64_tr_b16 v[56:57], v14 offset:10272
    ds_read_b64_tr_b16 v[58:59], v14 offset:10912
    s_waitcnt lgkmcnt(0)
    v_mfma_f32_16x16x32_bf16 v[68:71], v[52:55], v[36:39], v[68:71]
    ds_read_b128 v[44:47], v13 offset:64
    ds_read_b128 v[48:51], v13 offset:2624
    v_mfma_f32_16x16x32_bf16 v[72:75], v[56:59], v[36:39], v[72:75]
    ds_read_b64_tr_b16 v[60:61], v14 offset:15360
    ds_read_b64_tr_b16 v[62:63], v14 offset:16000
    v_mfma_f32_16x16x32_bf16 v[76:79], v[52:55], v[40:43], v[76:79]
    ds_read_b64_tr_b16 v[64:65], v14 offset:15392
    ds_read_b64_tr_b16 v[66:67], v14 offset:16032
    v_mfma_f32_16x16x32_bf16 v[80:83], v[56:59], v[40:43], v[80:83]
    s_waitcnt lgkmcnt(0)
    v_mfma_f32_16x16x32_bf16 v[68:71], v[60:63], v[44:47], v[68:71]
    s_waitcnt vmcnt(0)
    ds_write_b128 v8, v[20:23] offset:0
    ds_write_b128 v8, v[24:27] offset:5120
    ds_write_b128 v11, v[28:31] offset:10240
    ds_write_b128 v12, v[32:35] offset:10240
    v_add_u32 v8, 4294946816, v8
    v_add_u32 v11, 4294946816, v11
    v_add_u32 v12, 4294946816, v12
    v_mfma_f32_16x16x32_bf16 v[72:75], v[64:67], v[44:47], v[72:75]
    v_add_u32 v1, 256, v16
    v_mov_b32 v17, 4294966144
    v_mov_b32 v2, 1152
    v_cmp_le_u32 vcc, 144, v1
    s_nop 1
    v_cndmask_b32 v17, v17, v2, vcc
    v_mov_b32 v2, 4294964992
    v_cmp_le_u32 vcc, 288, v1
    v_mfma_f32_16x16x32_bf16 v[76:79], v[60:63], v[48:51], v[76:79]
    s_nop 1
    v_cndmask_b32 v17, v17, v2, vcc
    v_mov_b32 v2, 2304
    v_cmp_le_u32 vcc, 432, v1
    s_nop 1
    v_cndmask_b32 v17, v17, v2, vcc
    v_add_u32 v2, v6, v17
    buffer_load_dwordx4 v[20:23], v2, s[8:11], s34 offen
    v_mfma_f32_16x16x32_bf16 v[80:83], v[64:67], v[48:51], v[80:83]
    v_add_u32 v2, v7, v17
    buffer_load_dwordx4 v[24:27], v2, s[8:11], s34 offen
    buffer_load_dwordx4 v[28:31], v9, s[12:15], s35 offen
    buffer_load_dwordx4 v[32:35], v10, s[12:15], s35 offen
    s_add_u32 s34, s34, 128
    s_add_u32 s35, s35, 73728
    v_add_u32 v13, 20480, v13
    v_add_u32 v14, 20480, v14
    s_waitcnt lgkmcnt(0)
    s_barrier
    ds_read_b128 v[36:39], v13 offset:0
    ds_read_b128 v[40:43], v13 offset:2560
    ds_read_b64_tr_b16 v[52:53], v14 offset:10240
    ds_read_b64_tr_b16 v[54:55], v14 offset:10880
    ds_read_b64_tr_b16 v[56:57], v14 offset:10272
    ds_read_b64_tr_b16 v[58:59], v14 offset:10912
    s_waitcnt lgkmcnt(0)
    v_mfma_f32_16x16x32_bf16 v[68:71], v[52:55], v[36:39], v[68:71]
    ds_read_b128 v[44:47], v13 offset:64
    ds_read_b128 v[48:51], v13 offset:2624
    v_mfma_f32_16x16x32_bf16 v[72:75], v[56:59], v[36:39], v[72:75]
    ds_read_b64_tr_b16 v[60:61], v14 offset:15360
    ds_read_b64_tr_b16 v[62:63], v14 offset:16000
    v_mfma_f32_16x16x32_bf16 v[76:79], v[52:55], v[40:43], v[76:79]
    ds_read_b64_tr_b16 v[64:65], v14 offset:15392
    ds_read_b64_tr_b16 v[66:67], v14 offset:16032
    v_mfma_f32_16x16x32_bf16 v[80:83], v[56:59], v[40:43], v[80:83]
    s_waitcnt lgkmcnt(0)
    v_mfma_f32_16x16x32_bf16 v[68:71], v[60:63], v[44:47], v[68:71]
    s_waitcnt vmcnt(0)
    ds_write_b128 v8, v[20:23] offset:0
    ds_write_b128 v8, v[24:27] offset:5120
    ds_write_b128 v11, v[28:31] offset:10240
    ds_write_b128 v12, v[32:35] offset:10240
    v_add_u32 v8, 20480, v8
    v_add_u32 v11, 20480, v11
    v_add_u32 v12, 20480, v12
    v_mfma_f32_16x16x32_bf16 v[72:75], v[64:67], v[44:47], v[72:75]
    v_add_u32 v1, 320, v16
    v_mov_b32 v17, 4294966144
    v_mov_b32 v2, 1152
    v_cmp_le_u32 vcc, 144, v1
    s_nop 1
    v_cndmask_b32 v17, v17, v2, vcc
    v_mov_b32 v2, 4294964992
    v_cmp_le_u32 vcc, 288, v1
    v_mfma_f32_16x16x32_bf16 v[76:79], v[60:63], v[48:51], v[76:79]
    s_nop 1
    v_cndmask_b32 v17, v17, v2, vcc
    v_mov_b32 v2, 2304
    v_cmp_le_u32 vcc, 432, v1
    s_nop 1
    v_cndmask_b32 v17, v17, v2, vcc
    v_add_u32 v2, v6, v17
    buffer_load_dwordx4 v[20:23], v2, s[8:11], s34 offen
    v_mfma_f32_16x16x32_bf16 v[80:83], v[64:67], v[48:51], v[80:83]
    v_add_u32 v2, v7, v17
    buffer_load_dwordx4 v[24:27], v2, s[8:11], s34 offen
    buffer_load_dwordx4 v[28:31], v9, s[12:15], s35 offen
    buffer_load_dwordx4 v[32:35], v10, s[12:15], s35 offen
    s_add_u32 s34, s34, 128
    s_add_u32 s35, s35, 73728
    v_add_u32 v13, 4294946816, v13
    v_add_u32 v14, 4294946816, v14
    s_waitcnt lgkmcnt(0)
    s_barrier
    ds_read_b128 v[36:39], v13 offset:0
    ds_read_b128 v[40:43], v13 offset:2560
    ds_read_b64_tr_b16 v[52:53], v14 offset:10240
    ds_read_b64_tr_b16 v[54:55], v14 offset:10880
    ds_read_b64_tr_b16 v[56:57], v14 offset:10272
    ds_read_b64_tr_b16 v[58:59], v14 offset:10912
    s_waitcnt lgkmcnt(0)
    v_mfma_f32_16x16x32_bf16 v[68:71], v[52:55], v[36:39], v[68:71]
    ds_read_b128 v[44:47], v13 offset:64
    ds_read_b128 v[48:51], v13 offset:2624
    v_mfma_f32_16x16x32_bf16 v[72:75], v[56:59], v[36:39], v[72:75]
    ds_read_b64_tr_b16 v[60:61], v14 offset:15360
    ds_read_b64_tr_b16 v[62:63], v14 offset:16000
    v_mfma_f32_16x16x32_bf16 v[76:79], v[52:55], v[40:43], v[76:79]
    ds_read_b64_tr_b16 v[64:65], v14 offset:15392
    ds_read_b64_tr_b16 v[66:67], v14 offset:16032
    v_mfma_f32_16x16x32_bf16 v[80:83], v[56:59], v[40:43], v[80:83]
    s_waitcnt lgkmcnt(0)
    v_mfma_f32_16x16x32_bf16 v[68:71], v[60:63], v[44:47], v[68:71]
    s_waitcnt vmcnt(0)
    ds_write_b128 v8, v[20:23] offset:0
    ds_write_b128 v8, v[24:27] offset:5120
    ds_write_b128 v11, v[28:31] offset:10240
    ds_write_b128 v12, v[32:35] offset:10240
    v_add_u32 v8, 4294946816, v8
    v_add_u32 v11, 4294946816, v11
    v_add_u32 v12, 4294946816, v12
    v_mfma_f32_16x16x32_bf16 v[72:75], v[64:67], v[44:47], v[72:75]
    v_add_u32 v1, 384, v16
    v_mov_b32 v17, 4294966144
    v_mov_b32 v2, 1152
    v_cmp_le_u32 vcc, 144, v1
    s_nop 1
    v_cndmask_b32 v17, v17, v2, vcc
    v_mov_b32 v2, 4294964992
    v_cmp_le_u32 vcc, 288, v1
    v_mfma_f32_16x16x32_bf16 v[76:79], v[60:63], v[48:51], v[76:79]
    s_nop 1
    v_cndmask_b32 v17, v17, v2, vcc
    v_mov_b32 v2, 2304
    v_cmp_le_u32 vcc, 432, v1
    s_nop 1
    v_cndmask_b32 v17, v17, v2, vcc
    v_add_u32 v2, v6, v17
    buffer_load_dwordx4 v[20:23], v2, s[8:11], s34 offen
    v_mfma_f32_16x16x32_bf16 v[80:83], v[64:67], v[48:51], v[80:83]
    v_add_u32 v2, v7, v17
    buffer_load_dwordx4 v[24:27], v2, s[8:11], s34 offen
    buffer_load_dwordx4 v[28:31], v9, s[12:15], s35 offen
    buffer_load_dwordx4 v[32:35], v10, s[12:15], s35 offen
    s_add_u32 s34, s34, 128
    s_add_u32 s35, s35, 73728
    v_add_u32 v13, 20480, v13
    v_add_u32 v14, 20480, v14
    s_waitcnt lgkmcnt(0)
    s_barrier
    ds_read_b128 v[36:39], v13 offset:0
    ds_read_b128 v[40:43], v13 offset:2560
    ds_read_b64_tr_b16 v[52:53], v14 offset:10240
    ds_read_b64_tr_b16 v[54:55], v14 offset:10880
    ds_read_b64_tr_b16 v[56:57], v14 offset:10272
    ds_read_b64_tr_b16 v[58:59], v14 offset:10912
    s_waitcnt lgkmcnt(0)
    v_mfma_f32_16x16x32_bf16 v[68:71], v[52:55], v[36:39], v[68:71]
    ds_read_b128 v[44:47], v13 offset:64
    ds_read_b128 v[48:51], v13 offset:2624
    v_mfma_f32_16x16x32_bf16 v[72:75], v[56:59], v[36:39], v[72:75]
    ds_read_b64_tr_b16 v[60:61], v14 offset:15360
    ds_read_b64_tr_b16 v[62:63], v14 offset:16000
    v_mfma_f32_16x16x32_bf16 v[76:79], v[52:55], v[40:43], v[76:79]
    ds_read_b64_tr_b16 v[64:65], v14 offset:15392
    ds_read_b64_tr_b16 v[66:67], v14 offset:16032
    v_mfma_f32_16x16x32_bf16 v[80:83], v[56:59], v[40:43], v[80:83]
    s_waitcnt lgkmcnt(0)
    v_mfma_f32_16x16x32_bf16 v[68:71], v[60:63], v[44:47], v[68:71]
    s_waitcnt vmcnt(0)
    ds_write_b128 v8, v[20:23] offset:0
    ds_write_b128 v8, v[24:27] offset:5120
    ds_write_b128 v11, v[28:31] offset:10240
    ds_write_b128 v12, v[32:35] offset:10240
    v_add_u32 v8, 20480, v8
    v_add_u32 v11, 20480, v11
    v_add_u32 v12, 20480, v12
    v_mfma_f32_16x16x32_bf16 v[72:75], v[64:67], v[44:47], v[72:75]
    v_add_u32 v1, 448, v16
    v_mov_b32 v17, 4294966144
    v_mov_b32 v2, 1152
    v_cmp_le_u32 vcc, 144, v1
    s_nop 1
    v_cndmask_b32 v17, v17, v2, vcc
    v_mov_b32 v2, 4294964992
    v_cmp_le_u32 vcc, 288, v1
    v_mfma_f32_16x16x32_bf16 v[76:79], v[60:63], v[48:51], v[76:79]
    s_nop 1
    v_cndmask_b32 v17, v17, v2, vcc
    v_mov_b32 v2, 2304
    v_cmp_le_u32 vcc, 432, v1
    s_nop 1
    v_cndmask_b32 v17, v17, v2, vcc
    v_add_u32 v2, v6, v17
    buffer_load_dwordx4 v[20:23], v2, s[8:11], s34 offen
    v_mfma_f32_16x16x32_bf16 v[80:83], v[64:67], v[48:51], v[80:83]
    v_add_u32 v2, v7, v17
    buffer_load_dwordx4 v[24:27], v2, s[8:11], s34 offen
    buffer_load_dwordx4 v[28:31], v9, s[12:15], s35 offen
    buffer_load_dwordx4 v[32:35], v10, s[12:15], s35 offen
    s_add_u32 s34, s34, 128
    s_add_u32 s35, s35, 73728
    v_add_u32 v13, 4294946816, v13
    v_add_u32 v14, 4294946816, v14
    s_waitcnt lgkmcnt(0)
    s_barrier
    ds_read_b128 v[36:39], v13 offset:0
    ds_read_b128 v[40:43], v13 offset:2560
    ds_read_b64_tr_b16 v[52:53], v14 offset:10240
    ds_read_b64_tr_b16 v[54:55], v14 offset:10880
    ds_read_b64_tr_b16 v[56:57], v14 offset:10272
    ds_read_b64_tr_b16 v[58:59], v14 offset:10912
    s_waitcnt lgkmcnt(0)
    v_mfma_f32_16x16x32_bf16 v[68:71], v[52:55], v[36:39], v[68:71]
    ds_read_b128 v[44:47], v13 offset:64
    ds_read_b128 v[48:51], v13 offset:2624
    v_mfma_f32_16x16x32_bf16 v[72:75], v[56:59], v[36:39], v[72:75]
    ds_read_b64_tr_b16 v[60:61], v14 offset:15360
    ds_read_b64_tr_b16 v[62:63], v14 offset:16000
    v_mfma_f32_16x16x32_bf16 v[76:79], v[52:55], v[40:43], v[76:79]
    ds_read_b64_tr_b16 v[64:65], v14 offset:15392
    ds_read_b64_tr_b16 v[66:67], v14 offset:16032
    v_mfma_f32_16x16x32_bf16 v[80:83], v[56:59], v[40:43], v[80:83]
    s_waitcnt lgkmcnt(0)
    v_mfma_f32_16x16x32_bf16 v[68:71], v[60:63], v[44:47], v[68:71]
    s_waitcnt vmcnt(0)
    ds_write_b128 v8, v[20:23] offset:0
    ds_write_b128 v8, v[24:27] offset:5120
    ds_write_b128 v11, v[28:31] offset:10240
    ds_write_b128 v12, v[32:35] offset:10240
    v_add_u32 v8, 4294946816, v8
    v_add_u32 v11, 4294946816, v11
    v_add_u32 v12, 4294946816, v12
    v_mfma_f32_16x16x32_bf16 v[72:75], v[64:67], v[44:47], v[72:75]
    v_add_u32 v1, 512, v16
    v_mov_b32 v17, 4294966144
    v_mov_b32 v2, 1152
    v_cmp_le_u32 vcc, 144, v1
    s_nop 1
    v_cndmask_b32 v17, v17, v2, vcc
    v_mov_b32 v2, 4294964992
    v_cmp_le_u32 vcc, 288, v1
    v_mfma_f32_16x16x32_bf16 v[76:79], v[60:63], v[48:51], v[76:79]
    s_nop 1
    v_cndmask_b32 v17, v17, v2, vcc
    v_mov_b32 v2, 2304
    v_cmp_le_u32 vcc, 432, v1
    s_nop 1
    v_cndmask_b32 v17, v17, v2, vcc
    v_add_u32 v2, v6, v17
    buffer_load_dwordx4 v[20:23], v2, s[8:11], s34 offen
    v_mfma_f32_16x16x32_bf16 v[80:83], v[64:67], v[48:51], v[80:83]
    v_add_u32 v2, v7, v17
    buffer_load_dwordx4 v[24:27], v2, s[8:11], s34 offen
    buffer_load_dwordx4 v[28:31], v9, s[12:15], s35 offen
    buffer_load_dwordx4 v[32:35], v10, s[12:15], s35 offen
    s_add_u32 s34, s34, 128
    s_add_u32 s35, s35, 73728
    v_add_u32 v13, 20480, v13
    v_add_u32 v14, 20480, v14
    s_waitcnt lgkmcnt(0)
    s_barrier
    ds_read_b128 v[36:39], v13 offset:0
    ds_read_b128 v[40:43], v13 offset:2560
    ds_read_b64_tr_b16 v[52:53], v14 offset:10240
    ds_read_b64_tr_b16 v[54:55], v14 offset:10880
    ds_read_b64_tr_b16 v[56:57], v14 offset:10272
    ds_read_b64_tr_b16 v[58:59], v14 offset:10912
    s_waitcnt lgkmcnt(0)
    v_mfma_f32_16x16x32_bf16 v[68:71], v[52:55], v[36:39], v[68:71]
    ds_read_b128 v[44:47], v13 offset:64
    ds_read_b128 v[48:51], v13 offset:2624
    v_mfma_f32_16x16x32_bf16 v[72:75], v[56:59], v[36:39], v[72:75]
    ds_read_b64_tr_b16 v[60:61], v14 offset:15360
    ds_read_b64_tr_b16 v[62:63], v14 offset:16000
    v_mfma_f32_16x16x32_bf16 v[76:79], v[52:55], v[40:43], v[76:79]
    ds_read_b64_tr_b16 v[64:65], v14 offset:15392
    ds_read_b64_tr_b16 v[66:67], v14 offset:16032
    v_mfma_f32_16x16x32_bf16 v[80:83], v[56:59], v[40:43], v[80:83]
    s_waitcnt lgkmcnt(0)
    v_mfma_f32_16x16x32_bf16 v[68:71], v[60:63], v[44:47], v[68:71]
    s_waitcnt vmcnt(0)
    ds_write_b128 v8, v[20:23] offset:0
    v_mfma_f32_16x16x32_bf16 v[72:75], v[64:67], v[44:47], v[72:75]
    ds_write_b128 v8, v[24:27] offset:5120
    ds_write_b128 v11, v[28:31] offset:10240
    v_mfma_f32_16x16x32_bf16 v[76:79], v[60:63], v[48:51], v[76:79]
    ds_write_b128 v12, v[32:35] offset:10240
    v_add_u32 v8, 20480, v8
    v_mfma_f32_16x16x32_bf16 v[80:83], v[64:67], v[48:51], v[80:83]
    v_add_u32 v11, 20480, v11
    v_add_u32 v12, 20480, v12
    v_add_u32 v13, 4294946816, v13
    v_add_u32 v14, 4294946816, v14
    s_waitcnt lgkmcnt(0)
    s_barrier
    ds_read_b128 v[36:39], v13 offset:0
    ds_read_b128 v[40:43], v13 offset:2560
    ds_read_b64_tr_b16 v[52:53], v14 offset:10240
    ds_read_b64_tr_b16 v[54:55], v14 offset:10880
    ds_read_b64_tr_b16 v[56:57], v14 offset:10272
    ds_read_b64_tr_b16 v[58:59], v14 offset:10912
    s_waitcnt lgkmcnt(0)
    v_mfma_f32_16x16x32_bf16 v[68:71], v[52:55], v[36:39], v[68:71]
    ds_read_b128 v[44:47], v13 offset:64
    ds_read_b128 v[48:51], v13 offset:2624
    v_mfma_f32_16x16x32_bf16 v[72:75], v[56:59], v[36:39], v[72:75]
    ds_read_b64_tr_b16 v[60:61], v14 offset:15360
    ds_read_b64_tr_b16 v[62:63], v14 offset:16000
    v_mfma_f32_16x16x32_bf16 v[76:79], v[52:55], v[40:43], v[76:79]
    ds_read_b64_tr_b16 v[64:65], v14 offset:15392
    ds_read_b64_tr_b16 v[66:67], v14 offset:16032
    v_mfma_f32_16x16x32_bf16 v[80:83], v[56:59], v[40:43], v[80:83]
    s_waitcnt lgkmcnt(0)
    v_mfma_f32_16x16x32_bf16 v[68:71], v[60:63], v[44:47], v[68:71]
    v_mfma_f32_16x16x32_bf16 v[72:75], v[64:67], v[44:47], v[72:75]
    v_mfma_f32_16x16x32_bf16 v[76:79], v[60:63], v[48:51], v[76:79]
    v_mfma_f32_16x16x32_bf16 v[80:83], v[64:67], v[48:51], v[80:83]
    s_nop 7
    s_nop 7
    buffer_load_dwordx2 v[22:23], v15, s[20:23], 0 offen offset:0
    v_cvt_pk_bf16_f32 v20, v68, v69
    v_cvt_pk_bf16_f32 v21, v70, v71
    s_waitcnt vmcnt(0)
    v_lshlrev_b32 v24, 16, v20
    v_and_b32 v25, 0xffff0000, v20
    v_lshlrev_b32 v26, 16, v22
    v_and_b32 v27, 0xffff0000, v22
    v_add_f32 v24, v24, v26
    v_add_f32 v25, v25, v27
    v_cvt_pk_bf16_f32 v20, v24, v25
    v_lshlrev_b32 v24, 16, v21
    v_and_b32 v25, 0xffff0000, v21
    v_lshlrev_b32 v26, 16, v23
    v_and_b32 v27, 0xffff0000, v23
    v_add_f32 v24, v24, v26
    v_add_f32 v25, v25, v27
    v_cvt_pk_bf16_f32 v21, v24, v25
    buffer_store_dwordx2 v[20:21], v15, s[16:19], 0 offen offset:0
    s_nop 1
    buffer_load_dwordx2 v[22:23], v15, s[20:23], 0 offen offset:32
    v_cvt_pk_bf16_f32 v20, v72, v73
    v_cvt_pk_bf16_f32 v21, v74, v75
    s_waitcnt vmcnt(0)
    v_lshlrev_b32 v24, 16, v20
    v_and_b32 v25, 0xffff0000, v20
    v_lshlrev_b32 v26, 16, v22
    v_and_b32 v27, 0xffff0000, v22
    v_add_f32 v24, v24, v26
    v_add_f32 v25, v25, v27
    v_cvt_pk_bf16_f32 v20, v24, v25
    v_lshlrev_b32 v24, 16, v21
    v_and_b32 v25, 0xffff0000, v21
    v_lshlrev_b32 v26, 16, v23
    v_and_b32 v27, 0xffff0000, v23
    v_add_f32 v24, v24, v26
    v_add_f32 v25, v25, v27
    v_cvt_pk_bf16_f32 v21, v24, v25
    buffer_store_dwordx2 v[20:21], v15, s[16:19], 0 offen offset:32
    s_nop 1
    v_add_u32 v15, 18432, v15
    buffer_load_dwordx2 v[22:23], v15, s[20:23], 0 offen offset:0
    v_cvt_pk_bf16_f32 v20, v76, v77
    v_cvt_pk_bf16_f32 v21, v78, v79
    s_waitcnt vmcnt(0)
    v_lshlrev_b32 v24, 16, v20
    v_and_b32 v25, 0xffff0000, v20
    v_lshlrev_b32 v26, 16, v22
    v_and_b32 v27, 0xffff0000, v22
    v_add_f32 v24, v24, v26
    v_add_f32 v25, v25, v27
    v_cvt_pk_bf16_f32 v20, v24, v25
    v_lshlrev_b32 v24, 16, v21
    v_and_b32 v25, 0xffff0000, v21
    v_lshlrev_b32 v26, 16, v23
    v_and_b32 v27, 0xffff0000, v23
    v_add_f32 v24, v24, v26
    v_add_f32 v25, v25, v27
    v_cvt_pk_bf16_f32 v21, v24, v25
    buffer_store_dwordx2 v[20:21], v15, s[16:19], 0 offen offset:0
    s_nop 1
    buffer_load_dwordx2 v[22:23], v15, s[20:23], 0 offen offset:32
    v_cvt_pk_bf16_f32 v20, v80, v81
    v_cvt_pk_bf16_f32 v21, v82, v83
    s_waitcnt vmcnt(0)
    v_lshlrev_b32 v24, 16, v20
    v_and_b32 v25, 0xffff0000, v20
    v_lshlrev_b32 v26, 16, v22
    v_and_b32 v27, 0xffff0000, v22
    v_add_f32 v24, v24, v26
    v_add_f32 v25, v25, v27
    v_cvt_pk_bf16_f32 v20, v24, v25
    v_lshlrev_b32 v24, 16, v21
    v_and_b32 v25, 0xffff0000, v21
    v_lshlrev_b32 v26, 16, v23
    v_and_b32 v27, 0xffff0000, v23
    v_add_f32 v24, v24, v26
    v_add_f32 v25, v25, v27
    v_cvt_pk_bf16_f32 v21, v24, v25
    buffer_store_dwordx2 v[20:21], v15, s[16:19], 0 offen offset:32
    s_nop 1
    s_waitcnt vmcnt(0)
k_w2_kernel_end:
    s_endpgm
.section .rodata,"a"
.p2align 6
.amdhsa_kernel k_w2_kernel
  .amdhsa_next_free_vgpr 84
  .amdhsa_next_free_sgpr 80
  .amdhsa_accum_offset 84
  .amdhsa_group_segment_fixed_size 0
  .amdhsa_kernarg_size 88
  .amdhsa_user_sgpr_count 2
  .amdhsa_user_sgpr_kernarg_segment_ptr 1
  .amdhsa_system_sgpr_workgroup_id_x 1
.end_amdhsa_kernel
.text
.globl k_ln3_kernel
.p2align 8
.type k_ln3_kernel,@function
k_ln3_kernel:
    s_cmp_ge_u32 s2, 64
    s_cbranch_scc1 k_ln3_kernel_end
    s_load_dwordx2 s[4:5], s[0:1], 80
    s_load_dwordx2 s[6:7], s[0:1], 80
    s_waitcnt lgkmcnt(0)
    s_add_u32 s8, s4, 16515072
    s_addc_u32 s9, s5, 0
    s_mov_b32 s10, 2359296
    s_mov_b32 s11, 0x00020000
    s_add_u32 s12, s6, 56623104
    s_addc_u32 s13, s7, 0
    s_mov_b32 s14, 2359296
    s_mov_b32 s15, 0x00020000
    s_lshl_b32 s20, s2, 5
    v_lshrrev_b32 v5, 3, v0
    v_add_u32 v5, s20, v5
    v_mul_u32_u24 v5, 1152, v5
    v_and_b32 v4, 7, v0
    v_lshlrev_b32 v4, 4, v4
    v_add_u32 v5, v5, v4
    buffer_load_dwordx4 v[8:11], v5, s[8:11], 0 offen offset:0
    buffer_load_dwordx4 v[12:15], v5, s[8:11], 0 offen offset:128
    buffer_load_dwordx4 v[16:19], v5, s[8:11], 0 offen offset:256
    buffer_load_dwordx4 v[20:23], v5, s[8:11], 0 offen offset:384
    buffer_load_dwordx4 v[24:27], v5, s[8:11], 0 offen offset:512
    buffer_load_dwordx4 v[28:31], v5, s[8:11], 0 offen offset:640
    buffer_load_dwordx4 v[32:35], v5, s[8:11], 0 offen offset:768
    buffer_load_dwordx4 v[36:39], v5, s[8:11], 0 offen offset:896
    buffer_load_dwordx4 v[40:43], v5, s[8:11], 0 offen offset:1024
    v_mov_b32 v6, 0x3f803f80
    s_waitcnt vmcnt(0)
    v_mov_b32 v1, 0
    v_lshlrev_b32 v3, 16, v8
    v_and_b32 v4, 0xffff0000, v8
    v_add_f32 v1, v1, v3
    v_add_f32 v1, v1, v4
    v_lshlrev_b32 v3, 16, v9
    v_and_b32 v4, 0xffff0000, v9
    v_add_f32 v1, v1, v3
    v_add_f32 v1, v1, v4
    v_lshlrev_b32 v3, 16, v10
    v_and_b32 v4, 0xffff0000, v10
    v_add_f32 v1, v1, v3
    v_add_f32 v1, v1, v4
    v_lshlrev_b32 v3, 16, v11
    v_and_b32 v4, 0xffff0000, v11
    v_add_f32 v1, v1, v3
    v_add_f32 v1, v1, v4
    v_lshlrev_b32 v3, 16, v12
    v_and_b32 v4, 0xffff0000, v12
    v_add_f32 v1, v1, v3
    v_add_f32 v1, v1, v4
    v_lshlrev_b32 v3, 16, v13
    v_and_b32 v4, 0xffff0000, v13
    v_add_f32 v1, v1, v3
    v_add_f32 v1, v1, v4
    v_lshlrev_b32 v3, 16, v14
    v_and_b32 v4, 0xffff0000, v14
    v_add_f32 v1, v1, v3
    v_add_f32 v1, v1, v4
    v_lshlrev_b32 v3, 16, v15
    v_and_b32 v4, 0xffff0000, v15
    v_add_f32 v1, v1, v3
    v_add_f32 v1, v1, v4
    v_lshlrev_b32 v3, 16, v16
    v_and_b32 v4, 0xffff0000, v16
    v_add_f32 v1, v1, v3
    v_add_f32 v1, v1, v4
    v_lshlrev_b32 v3, 16, v17
    v_and_b32 v4, 0xffff0000, v17
    v_add_f32 v1, v1, v3
    v_add_f32 v1, v1, v4
    v_lshlrev_b32 v3, 16, v18
    v_and_b32 v4, 0xffff0000, v18
    v_add_f32 v1, v1, v3
    v_add_f32 v1, v1, v4
    v_lshlrev_b32 v3, 16, v19
    v_and_b32 v4, 0xffff0000, v19
    v_add_f32 v1, v1, v3
    v_add_f32 v1, v1, v4
    v_lshlrev_b32 v3, 16, v20
    v_and_b32 v4, 0xffff0000, v20
    v_add_f32 v1, v1, v3
    v_add_f32 v1, v1, v4
    v_lshlrev_b32 v3, 16, v21
    v_and_b32 v4, 0xffff0000, v21
    v_add_f32 v1, v1, v3
    v_add_f32 v1, v1, v4
    v_lshlrev_b32 v3, 16, v22
    v_and_b32 v4, 0xffff0000, v22
    v_add_f32 v1, v1, v3
    v_add_f32 v1, v1, v4
    v_lshlrev_b32 v3, 16, v23
    v_and_b32 v4, 0xffff0000, v23
    v_add_f32 v1, v1, v3
    v_add_f32 v1, v1, v4
    v_lshlrev_b32 v3, 16, v24
    v_and_b32 v4, 0xffff0000, v24
    v_add_f32 v1, v1, v3
    v_add_f32 v1, v1, v4
    v_lshlrev_b32 v3, 16, v25
    v_and_b32 v4, 0xffff0000, v25
    v_add_f32 v1, v1, v3
    v_add_f32 v1, v1, v4
    v_lshlrev_b32 v3, 16, v26
    v_and_b32 v4, 0xffff0000, v26
    v_add_f32 v1, v1, v3
    v_add_f32 v1, v1, v4
    v_lshlrev_b32 v3, 16, v27
    v_and_b32 v4, 0xffff0000, v27
    v_add_f32 v1, v1, v3
    v_add_f32 v1, v1, v4
    v_lshlrev_b32 v3, 16, v28
    v_and_b32 v4, 0xffff0000, v28
    v_add_f32 v1, v1, v3
    v_add_f32 v1, v1, v4
    v_lshlrev_b32 v3, 16, v29
    v_and_b32 v4, 0xffff0000, v29
    v_add_f32 v1, v1, v3
    v_add_f32 v1, v1, v4
    v_lshlrev_b32 v3, 16, v30
    v_and_b32 v4, 0xffff0000, v30
    v_add_f32 v1, v1, v3
    v_add_f32 v1, v1, v4
    v_lshlrev_b32 v3, 16, v31
    v_and_b32 v4, 0xffff0000, v31
    v_add_f32 v1, v1, v3
    v_add_f32 v1, v1, v4
    v_lshlrev_b32 v3, 16, v32
    v_and_b32 v4, 0xffff0000, v32
    v_add_f32 v1, v1, v3
    v_add_f32 v1, v1, v4
    v_lshlrev_b32 v3, 16, v33
    v_and_b32 v4, 0xffff0000, v33
    v_add_f32 v1, v1, v3
    v_add_f32 v1, v1, v4
    v_lshlrev_b32 v3, 16, v34
    v_and_b32 v4, 0xffff0000, v34
    v_add_f32 v1, v1, v3
    v_add_f32 v1, v1, v4
    v_lshlrev_b32 v3, 16, v35
    v_and_b32 v4, 0xffff0000, v35
    v_add_f32 v1, v1, v3
    v_add_f32 v1, v1, v4
    v_lshlrev_b32 v3, 16, v36
    v_and_b32 v4, 0xffff0000, v36
    v_add_f32 v1, v1, v3
    v_add_f32 v1, v1, v4
    v_lshlrev_b32 v3, 16, v37
    v_and_b32 v4, 0xffff0000, v37
    v_add_f32 v1, v1, v3
    v_add_f32 v1, v1, v4
    v_lshlrev_b32 v3, 16, v38
    v_and_b32 v4, 0xffff0000, v38
    v_add_f32 v1, v1, v3
    v_add_f32 v1, v1, v4
    v_lshlrev_b32 v3, 16, v39
    v_and_b32 v4, 0xffff0000, v39
    v_add_f32 v1, v1, v3
    v_add_f32 v1, v1, v4
    v_lshlrev_b32 v3, 16, v40
    v_and_b32 v4, 0xffff0000, v40
    v_add_f32 v1, v1, v3
    v_add_f32 v1, v1, v4
    v_lshlrev_b32 v3, 16, v41
    v_and_b32 v4, 0xffff0000, v41
    v_add_f32 v1, v1, v3
    v_add_f32 v1, v1, v4
    v_lshlrev_b32 v3, 16, v42
    v_and_b32 v4, 0xffff0000, v42
    v_add_f32 v1, v1, v3
    v_add_f32 v1, v1, v4
    v_lshlrev_b32 v3, 16, v43
    v_and_b32 v4, 0xffff0000, v43
    v_add_f32 v1, v1, v3
    v_add_f32 v1, v1, v4
    s_nop 1
    v_add_f32_dpp v1, v1, v1 quad_perm:[1,0,3,2] row_mask:0xf bank_mask:0xf
    s_nop 1
    v_add_f32_dpp v1, v1, v1 quad_perm:[2,3,0,1] row_mask:0xf bank_mask:0xf
    s_nop 1
    v_add_f32_dpp v1, v1, v1 row_half_mirror row_mask:0xf bank_mask:0xf
    v_mul_f32 v1, 0x3ae38e39, v1
    v_mov_b32 v2, 0
    v_lshlrev_b32 v3, 16, v8
    v_and_b32 v4, 0xffff0000, v8
    v_sub_f32 v3, v3, v1
    v_sub_f32 v4, v4, v1
    v_fmac_f32 v2, v3, v3
    v_fmac_f32 v2, v4, v4
    v_lshlrev_b32 v3, 16, v9
    v_and_b32 v4, 0xffff0000, v9
    v_sub_f32 v3, v3, v1
    v_sub_f32 v4, v4, v1
    v_fmac_f32 v2, v3, v3
    v_fmac_f32 v2, v4, v4
    v_lshlrev_b32 v3, 16, v10
    v_and_b32 v4, 0xffff0000, v10
    v_sub_f32 v3, v3, v1
    v_sub_f32 v4, v4, v1
    v_fmac_f32 v2, v3, v3
    v_fmac_f32 v2, v4, v4
    v_lshlrev_b32 v3, 16, v11
    v_and_b32 v4, 0xffff0000, v11
    v_sub_f32 v3, v3, v1
    v_sub_f32 v4, v4, v1
    v_fmac_f32 v2, v3, v3
    v_fmac_f32 v2, v4, v4
    v_lshlrev_b32 v3, 16, v12
    v_and_b32 v4, 0xffff0000, v12
    v_sub_f32 v3, v3, v1
    v_sub_f32 v4, v4, v1
    v_fmac_f32 v2, v3, v3
    v_fmac_f32 v2, v4, v4
    v_lshlrev_b32 v3, 16, v13
    v_and_b32 v4, 0xffff0000, v13
    v_sub_f32 v3, v3, v1
    v_sub_f32 v4, v4, v1
    v_fmac_f32 v2, v3, v3
    v_fmac_f32 v2, v4, v4
    v_lshlrev_b32 v3, 16, v14
    v_and_b32 v4, 0xffff0000, v14
    v_sub_f32 v3, v3, v1
    v_sub_f32 v4, v4, v1
    v_fmac_f32 v2, v3, v3
    v_fmac_f32 v2, v4, v4
    v_lshlrev_b32 v3, 16, v15
    v_and_b32 v4, 0xffff0000, v15
    v_sub_f32 v3, v3, v1
    v_sub_f32 v4, v4, v1
    v_fmac_f32 v2, v3, v3
    v_fmac_f32 v2, v4, v4
    v_lshlrev_b32 v3, 16, v16
    v_and_b32 v4, 0xffff0000, v16
    v_sub_f32 v3, v3, v1
    v_sub_f32 v4, v4, v1
    v_fmac_f32 v2, v3, v3
    v_fmac_f32 v2, v4, v4
    v_lshlrev_b32 v3, 16, v17
    v_and_b32 v4, 0xffff0000, v17
    v_sub_f32 v3, v3, v1
    v_sub_f32 v4, v4, v1
    v_fmac_f32 v2, v3, v3
    v_fmac_f32 v2, v4, v4
    v_lshlrev_b32 v3, 16, v18
    v_and_b32 v4, 0xffff0000, v18
    v_sub_f32 v3, v3, v1
    v_sub_f32 v4, v4, v1
    v_fmac_f32 v2, v3, v3
    v_fmac_f32 v2, v4, v4
    v_lshlrev_b32 v3, 16, v19
    v_and_b32 v4, 0xffff0000, v19
    v_sub_f32 v3, v3, v1
    v_sub_f32 v4, v4, v1
    v_fmac_f32 v2, v3, v3
    v_fmac_f32 v2, v4, v4
    v_lshlrev_b32 v3, 16, v20
    v_and_b32 v4, 0xffff0000, v20
    v_sub_f32 v3, v3, v1
    v_sub_f32 v4, v4, v1
    v_fmac_f32 v2, v3, v3
    v_fmac_f32 v2, v4, v4
    v_lshlrev_b32 v3, 16, v21
    v_and_b32 v4, 0xffff0000, v21
    v_sub_f32 v3, v3, v1
    v_sub_f32 v4, v4, v1
    v_fmac_f32 v2, v3, v3
    v_fmac_f32 v2, v4, v4
    v_lshlrev_b32 v3, 16, v22
    v_and_b32 v4, 0xffff0000, v22
    v_sub_f32 v3, v3, v1
    v_sub_f32 v4, v4, v1
    v_fmac_f32 v2, v3, v3
    v_fmac_f32 v2, v4, v4
    v_lshlrev_b32 v3, 16, v23
    v_and_b32 v4, 0xffff0000, v23
    v_sub_f32 v3, v3, v1
    v_sub_f32 v4, v4, v1
    v_fmac_f32 v2, v3, v3
    v_fmac_f32 v2, v4, v4
    v_lshlrev_b32 v3, 16, v24
    v_and_b32 v4, 0xffff0000, v24
    v_sub_f32 v3, v3, v1
    v_sub_f32 v4, v4, v1
    v_fmac_f32 v2, v3, v3
    v_fmac_f32 v2, v4, v4
    v_lshlrev_b32 v3, 16, v25
    v_and_b32 v4, 0xffff0000, v25
    v_sub_f32 v3, v3, v1
    v_sub_f32 v4, v4, v1
    v_fmac_f32 v2, v3, v3
    v_fmac_f32 v2, v4, v4
    v_lshlrev_b32 v3, 16, v26
    v_and_b32 v4, 0xffff0000, v26
    v_sub_f32 v3, v3, v1
    v_sub_f32 v4, v4, v1
    v_fmac_f32 v2, v3, v3
    v_fmac_f32 v2, v4, v4
    v_lshlrev_b32 v3, 16, v27
    v_and_b32 v4, 0xffff0000, v27
    v_sub_f32 v3, v3, v1
    v_sub_f32 v4, v4, v1
    v_fmac_f32 v2, v3, v3
    v_fmac_f32 v2, v4, v4
    v_lshlrev_b32 v3, 16, v28
    v_and_b32 v4, 0xffff0000, v28
    v_sub_f32 v3, v3, v1
    v_sub_f32 v4, v4, v1
    v_fmac_f32 v2, v3, v3
    v_fmac_f32 v2, v4, v4
    v_lshlrev_b32 v3, 16, v29
    v_and_b32 v4, 0xffff0000, v29
    v_sub_f32 v3, v3, v1
    v_sub_f32 v4, v4, v1
    v_fmac_f32 v2, v3, v3
    v_fmac_f32 v2, v4, v4
    v_lshlrev_b32 v3, 16, v30
    v_and_b32 v4, 0xffff0000, v30
    v_sub_f32 v3, v3, v1
    v_sub_f32 v4, v4, v1
    v_fmac_f32 v2, v3, v3
    v_fmac_f32 v2, v4, v4
    v_lshlrev_b32 v3, 16, v31
    v_and_b32 v4, 0xffff0000, v31
    v_sub_f32 v3, v3, v1
    v_sub_f32 v4, v4, v1
    v_fmac_f32 v2, v3, v3
    v_fmac_f32 v2, v4, v4
    v_lshlrev_b32 v3, 16, v32
    v_and_b32 v4, 0xffff0000, v32
    v_sub_f32 v3, v3, v1
    v_sub_f32 v4, v4, v1
    v_fmac_f32 v2, v3, v3
    v_fmac_f32 v2, v4, v4
    v_lshlrev_b32 v3, 16, v33
    v_and_b32 v4, 0xffff0000, v33
    v_sub_f32 v3, v3, v1
    v_sub_f32 v4, v4, v1
    v_fmac_f32 v2, v3, v3
    v_fmac_f32 v2, v4, v4
    v_lshlrev_b32 v3, 16, v34
    v_and_b32 v4, 0xffff0000, v34
    v_sub_f32 v3, v3, v1
    v_sub_f32 v4, v4, v1
    v_fmac_f32 v2, v3, v3
    v_fmac_f32 v2, v4, v4
    v_lshlrev_b32 v3, 16, v35
    v_and_b32 v4, 0xffff0000, v35
    v_sub_f32 v3, v3, v1
    v_sub_f32 v4, v4, v1
    v_fmac_f32 v2, v3, v3
    v_fmac_f32 v2, v4, v4
    v_lshlrev_b32 v3, 16, v36
    v_and_b32 v4, 0xffff0000, v36
    v_sub_f32 v3, v3, v1
    v_sub_f32 v4, v4, v1
    v_fmac_f32 v2, v3, v3
    v_fmac_f32 v2, v4, v4
    v_lshlrev_b32 v3, 16, v37
    v_and_b32 v4, 0xffff0000, v37
    v_sub_f32 v3, v3, v1
    v_sub_f32 v4, v4, v1
    v_fmac_f32 v2, v3, v3
    v_fmac_f32 v2, v4, v4
    v_lshlrev_b32 v3, 16, v38
    v_and_b32 v4, 0xffff0000, v38
    v_sub_f32 v3, v3, v1
    v_sub_f32 v4, v4, v1
    v_fmac_f32 v2, v3, v3
    v_fmac_f32 v2, v4, v4
    v_lshlrev_b32 v3, 16, v39
    v_and_b32 v4, 0xffff0000, v39
    v_sub_f32 v3, v3, v1
    v_sub_f32 v4, v4, v1
    v_fmac_f32 v2, v3, v3
    v_fmac_f32 v2, v4, v4
    v_lshlrev_b32 v3, 16, v40
    v_and_b32 v4, 0xffff0000, v40
    v_sub_f32 v3, v3, v1
    v_sub_f32 v4, v4, v1
    v_fmac_f32 v2, v3, v3
    v_fmac_f32 v2, v4, v4
    v_lshlrev_b32 v3, 16, v41
    v_and_b32 v4, 0xffff0000, v41
    v_sub_f32 v3, v3, v1
    v_sub_f32 v4, v4, v1
    v_fmac_f32 v2, v3, v3
    v_fmac_f32 v2, v4, v4
    v_lshlrev_b32 v3, 16, v42
    v_and_b32 v4, 0xffff0000, v42
    v_sub_f32 v3, v3, v1
    v_sub_f32 v4, v4, v1
    v_fmac_f32 v2, v3, v3
    v_fmac_f32 v2, v4, v4
    v_lshlrev_b32 v3, 16, v43
    v_and_b32 v4, 0xffff0000, v43
    v_sub_f32 v3, v3, v1
    v_sub_f32 v4, v4, v1
    v_fmac_f32 v2, v3, v3
    v_fmac_f32 v2, v4, v4
    s_nop 1
    v_add_f32_dpp v2, v2, v2 quad_perm:[1,0,3,2] row_mask:0xf bank_mask:0xf
    s_nop 1
    v_add_f32_dpp v2, v2, v2 quad_perm:[2,3,0,1] row_mask:0xf bank_mask:0xf
    s_nop 1
    v_add_f32_dpp v2, v2, v2 row_half_mirror row_mask:0xf bank_mask:0xf
    v_mul_f32 v2, 0x3ae38e39, v2
    v_add_f32 v2, 0x3727c5ac, v2
    v_rsq_f32 v2, v2
    s_nop 1
    v_mul_f32 v1, v1, v2
    v_sub_f32 v1, 0, v1
    v_lshlrev_b32 v3, 16, v8
    v_and_b32 v4, 0xffff0000, v8
    v_fma_f32 v3, v3, v2, v1
    v_fma_f32 v4, v4, v2, v1
    v_cvt_pk_bf16_f32 v8, v3, v4
    v_lshlrev_b32 v3, 16, v9
    v_and_b32 v4, 0xffff0000, v9
    v_fma_f32 v3, v3, v2, v1
    v_fma_f32 v4, v4, v2, v1
    v_cvt_pk_bf16_f32 v9, v3, v4
    v_lshlrev_b32 v3, 16, v10
    v_and_b32 v4, 0xffff0000, v10
    v_fma_f32 v3, v3, v2, v1
    v_fma_f32 v4, v4, v2, v1
    v_cvt_pk_bf16_f32 v10, v3, v4
    v_lshlrev_b32 v3, 16, v11
    v_and_b32 v4, 0xffff0000, v11
    v_fma_f32 v3, v3, v2, v1
    v_fma_f32 v4, v4, v2, v1
    v_cvt_pk_bf16_f32 v11, v3, v4
    v_lshlrev_b32 v3, 16, v12
    v_and_b32 v4, 0xffff0000, v12
    v_fma_f32 v3, v3, v2, v1
    v_fma_f32 v4, v4, v2, v1
    v_cvt_pk_bf16_f32 v12, v3, v4
    v_lshlrev_b32 v3, 16, v13
    v_and_b32 v4, 0xffff0000, v13
    v_fma_f32 v3, v3, v2, v1
    v_fma_f32 v4, v4, v2, v1
    v_cvt_pk_bf16_f32 v13, v3, v4
    v_lshlrev_b32 v3, 16, v14
    v_and_b32 v4, 0xffff0000, v14
    v_fma_f32 v3, v3, v2, v1
    v_fma_f32 v4, v4, v2, v1
    v_cvt_pk_bf16_f32 v14, v3, v4
    v_lshlrev_b32 v3, 16, v15
    v_and_b32 v4, 0xffff0000, v15
    v_fma_f32 v3, v3, v2, v1
    v_fma_f32 v4, v4, v2, v1
    v_cvt_pk_bf16_f32 v15, v3, v4
    v_lshlrev_b32 v3, 16, v16
    v_and_b32 v4, 0xffff0000, v16
    v_fma_f32 v3, v3, v2, v1
    v_fma_f32 v4, v4, v2, v1
    v_cvt_pk_bf16_f32 v16, v3, v4
    v_lshlrev_b32 v3, 16, v17
    v_and_b32 v4, 0xffff0000, v17
    v_fma_f32 v3, v3, v2, v1
    v_fma_f32 v4, v4, v2, v1
    v_cvt_pk_bf16_f32 v17, v3, v4
    v_lshlrev_b32 v3, 16, v18
    v_and_b32 v4, 0xffff0000, v18
    v_fma_f32 v3, v3, v2, v1
    v_fma_f32 v4, v4, v2, v1
    v_cvt_pk_bf16_f32 v18, v3, v4
    v_lshlrev_b32 v3, 16, v19
    v_and_b32 v4, 0xffff0000, v19
    v_fma_f32 v3, v3, v2, v1
    v_fma_f32 v4, v4, v2, v1
    v_cvt_pk_bf16_f32 v19, v3, v4
    v_lshlrev_b32 v3, 16, v20
    v_and_b32 v4, 0xffff0000, v20
    v_fma_f32 v3, v3, v2, v1
    v_fma_f32 v4, v4, v2, v1
    v_cvt_pk_bf16_f32 v20, v3, v4
    v_lshlrev_b32 v3, 16, v21
    v_and_b32 v4, 0xffff0000, v21
    v_fma_f32 v3, v3, v2, v1
    v_fma_f32 v4, v4, v2, v1
    v_cvt_pk_bf16_f32 v21, v3, v4
    v_lshlrev_b32 v3, 16, v22
    v_and_b32 v4, 0xffff0000, v22
    v_fma_f32 v3, v3, v2, v1
    v_fma_f32 v4, v4, v2, v1
    v_cvt_pk_bf16_f32 v22, v3, v4
    v_lshlrev_b32 v3, 16, v23
    v_and_b32 v4, 0xffff0000, v23
    v_fma_f32 v3, v3, v2, v1
    v_fma_f32 v4, v4, v2, v1
    v_cvt_pk_bf16_f32 v23, v3, v4
    v_lshlrev_b32 v3, 16, v24
    v_and_b32 v4, 0xffff0000, v24
    v_fma_f32 v3, v3, v2, v1
    v_fma_f32 v4, v4, v2, v1
    v_cvt_pk_bf16_f32 v24, v3, v4
    v_lshlrev_b32 v3, 16, v25
    v_and_b32 v4, 0xffff0000, v25
    v_fma_f32 v3, v3, v2, v1
    v_fma_f32 v4, v4, v2, v1
    v_cvt_pk_bf16_f32 v25, v3, v4
    v_lshlrev_b32 v3, 16, v26
    v_and_b32 v4, 0xffff0000, v26
    v_fma_f32 v3, v3, v2, v1
    v_fma_f32 v4, v4, v2, v1
    v_cvt_pk_bf16_f32 v26, v3, v4
    v_lshlrev_b32 v3, 16, v27
    v_and_b32 v4, 0xffff0000, v27
    v_fma_f32 v3, v3, v2, v1
    v_fma_f32 v4, v4, v2, v1
    v_cvt_pk_bf16_f32 v27, v3, v4
    v_lshlrev_b32 v3, 16, v28
    v_and_b32 v4, 0xffff0000, v28
    v_fma_f32 v3, v3, v2, v1
    v_fma_f32 v4, v4, v2, v1
    v_cvt_pk_bf16_f32 v28, v3, v4
    v_lshlrev_b32 v3, 16, v29
    v_and_b32 v4, 0xffff0000, v29
    v_fma_f32 v3, v3, v2, v1
    v_fma_f32 v4, v4, v2, v1
    v_cvt_pk_bf16_f32 v29, v3, v4
    v_lshlrev_b32 v3, 16, v30
    v_and_b32 v4, 0xffff0000, v30
    v_fma_f32 v3, v3, v2, v1
    v_fma_f32 v4, v4, v2, v1
    v_cvt_pk_bf16_f32 v30, v3, v4
    v_lshlrev_b32 v3, 16, v31
    v_and_b32 v4, 0xffff0000, v31
    v_fma_f32 v3, v3, v2, v1
    v_fma_f32 v4, v4, v2, v1
    v_cvt_pk_bf16_f32 v31, v3, v4
    v_lshlrev_b32 v3, 16, v32
    v_and_b32 v4, 0xffff0000, v32
    v_fma_f32 v3, v3, v2, v1
    v_fma_f32 v4, v4, v2, v1
    v_cvt_pk_bf16_f32 v32, v3, v4
    v_lshlrev_b32 v3, 16, v33
    v_and_b32 v4, 0xffff0000, v33
    v_fma_f32 v3, v3, v2, v1
    v_fma_f32 v4, v4, v2, v1
    v_cvt_pk_bf16_f32 v33, v3, v4
    v_lshlrev_b32 v3, 16, v34
    v_and_b32 v4, 0xffff0000, v34
    v_fma_f32 v3, v3, v2, v1
    v_fma_f32 v4, v4, v2, v1
    v_cvt_pk_bf16_f32 v34, v3, v4
    v_lshlrev_b32 v3, 16, v35
    v_and_b32 v4, 0xffff0000, v35
    v_fma_f32 v3, v3, v2, v1
    v_fma_f32 v4, v4, v2, v1
    v_cvt_pk_bf16_f32 v35, v3, v4
    v_lshlrev_b32 v3, 16, v36
    v_and_b32 v4, 0xffff0000, v36
    v_fma_f32 v3, v3, v2, v1
    v_fma_f32 v4, v4, v2, v1
    v_cvt_pk_bf16_f32 v36, v3, v4
    v_lshlrev_b32 v3, 16, v37
    v_and_b32 v4, 0xffff0000, v37
    v_fma_f32 v3, v3, v2, v1
    v_fma_f32 v4, v4, v2, v1
    v_cvt_pk_bf16_f32 v37, v3, v4
    v_lshlrev_b32 v3, 16, v38
    v_and_b32 v4, 0xffff0000, v38
    v_fma_f32 v3, v3, v2, v1
    v_fma_f32 v4, v4, v2, v1
    v_cvt_pk_bf16_f32 v38, v3, v4
    v_lshlrev_b32 v3, 16, v39
    v_and_b32 v4, 0xffff0000, v39
    v_fma_f32 v3, v3, v2, v1
    v_fma_f32 v4, v4, v2, v1
    v_cvt_pk_bf16_f32 v39, v3, v4
    v_lshlrev_b32 v3, 16, v40
    v_and_b32 v4, 0xffff0000, v40
    v_fma_f32 v3, v3, v2, v1
    v_fma_f32 v4, v4, v2, v1
    v_cvt_pk_bf16_f32 v40, v3, v4
    v_lshlrev_b32 v3, 16, v41
    v_and_b32 v4, 0xffff0000, v41
    v_fma_f32 v3, v3, v2, v1
    v_fma_f32 v4, v4, v2, v1
    v_cvt_pk_bf16_f32 v41, v3, v4
    v_lshlrev_b32 v3, 16, v42
    v_and_b32 v4, 0xffff0000, v42
    v_fma_f32 v3, v3, v2, v1
    v_fma_f32 v4, v4, v2, v1
    v_cvt_pk_bf16_f32 v42, v3, v4
    v_lshlrev_b32 v3, 16, v43
    v_and_b32 v4, 0xffff0000, v43
    v_fma_f32 v3, v3, v2, v1
    v_fma_f32 v4, v4, v2, v1
    v_cvt_pk_bf16_f32 v43, v3, v4
    buffer_store_dwordx4 v[8:11], v5, s[12:15], 0 offen offset:0
    buffer_store_dwordx4 v[12:15], v5, s[12:15], 0 offen offset:128
    buffer_store_dwordx4 v[16:19], v5, s[12:15], 0 offen offset:256
    buffer_store_dwordx4 v[20:23], v5, s[12:15], 0 offen offset:384
    buffer_store_dwordx4 v[24:27], v5, s[12:15], 0 offen offset:512
    buffer_store_dwordx4 v[28:31], v5, s[12:15], 0 offen offset:640
    buffer_store_dwordx4 v[32:35], v5, s[12:15], 0 offen offset:768
    buffer_store_dwordx4 v[36:39], v5, s[12:15], 0 offen offset:896
    buffer_store_dwordx4 v[40:43], v5, s[12:15], 0 offen offset:1024
    s_waitcnt vmcnt(0)
k_ln3_kernel_end:
    s_endpgm
.section .rodata,"a"
.p2align 6
.amdhsa_kernel k_ln3_kernel
  .amdhsa_next_free_vgpr 48
  .amdhsa_next_free_sgpr 32
  .amdhsa_accum_offset 48
  .amdhsa_group_segment_fixed_size 0
  .amdhsa_kernarg_size 88
  .amdhsa_user_sgpr_count 2
  .amdhsa_user_sgpr_kernarg_segment_ptr 1
  .amdhsa_system_sgpr_workgroup_id_x 1
.end_amdhsa_kernel
.text
.globl k_w3_kernel
.p2align 8
.type k_w3_kernel,@function
k_w3_kernel:
    s_cmp_ge_u32 s2, 768
    s_cbranch_scc1 k_w3_kernel_end
    s_load_dwordx2 s[36:37], s[0:1], 80
    s_load_dwordx2 s[38:39], s[0:1], 48
    s_mov_b32 s3, 0
    s_mov_b32 s6, s2
    s_mul_i32 s4, s6, 683
    s_lshr_b32 s4, s4, 15
    s_mul_i32 s5, s4, 48
    s_sub_u32 s5, s6, s5
    s_waitcnt lgkmcnt(0)
    s_add_u32 s8, s36, 56623104
    s_addc_u32 s9, s37, 0
    s_mov_b32 s10, 2359296
    s_mov_b32 s11, 0x00020000
    s_mov_b32 s12, s38
    s_mov_b32 s13, s39
    s_mov_b32 s14, 5308416
    s_mov_b32 s15, 0x00020000
    s_add_u32 s16, s36, 18874368
    s_addc_u32 s17, s37, 0
    s_mov_b32 s18, 18874368
    s_mov_b32 s19, 0x00020000
    s_mul_i32 s32, s4, 128
    s_mul_i32 s33, s5, 96
    s_mul_i32 s34, s3, 1152
    s_mul_i32 s35, s3, 5308416
    v_and_b32 v5, 63, v0
    v_lshrrev_b32 v1, 3, v0
    v_and_b32 v2, 7, v0
    v_lshlrev_b32 v2, 4, v2
    v_mul_u32_u24 v10, 160, v1
    v_add_u32 v10, v10, v2
    v_add_u32 v3, s32, v1
    v_mul_u32_u24 v3, 1152, v3
    v_add_u32 v6, v3, v2
    v_add_u32 v7, 36864, v6
    v_add_u32 v8, 73728, v6
    v_add_u32 v9, 110592, v6
    v_add_u32 v1, 0, v0
    v_mul_u32_u24 v2, 683, v1
    v_lshrrev_b32 v2, 13, v2
    v_mul_u32_u24 v3, 12, v2
    v_sub_u32 v3, v1, v3
    v_lshlrev_b32 v3, 4, v3
    v_mul_u32_u24 v14, 224, v2
    v_add_u32 v14, v14, v3
    v_mul_u32_u24 v11, 9216, v2
    v_add_u32 v11, v11, v3
    v_mov_b32 v4, s33
    v_lshlrev_b32 v4, 1, v4
    v_add_u32 v11, v11, v4
    v_add_u32 v1, 256, v0
    v_mul_u32_u24 v2, 683, v1
    v_lshrrev_b32 v2, 13, v2
    v_mul_u32_u24 v3, 12, v2
    v_sub_u32 v3, v1, v3
    v_lshlrev_b32 v3, 4, v3
    v_mul_u32_u24 v15, 224, v2
    v_add_u32 v15, v15, v3
    v_mul_u32_u24 v12, 9216, v2
    v_add_u32 v12, v12, v3
    v_mov_b32 v4, s33
    v_lshlrev_b32 v4, 1, v4
    v_add_u32 v12, v12, v4
    v_add_u32 v1, 512, v0
    v_mul_u32_u24 v2, 683, v1
    v_lshrrev_b32 v2, 13, v2
    v_mul_u32_u24 v3, 12, v2
    v_sub_u32 v3, v1, v3
    v_lshlrev_b32 v3, 4, v3
    v_mul_u32_u24 v16, 224, v2
    v_add_u32 v16, v16, v3
    v_mul_u32_u24 v13, 9216, v2
    v_add_u32 v13, v13, v3
    v_mov_b32 v4, s33
    v_lshlrev_b32 v4, 1, v4
    v_add_u32 v13, v13, v4
    v_lshrrev_b32 v1, 7, v0
    v_mul_u32_u24 v1, 64, v1
    v_and_b32 v2, 15, v0
    v_add_u32 v1, v1, v2
    v_mul_u32_u24 v17, 160, v1
    v_lshrrev_b32 v2, 4, v5
    v_lshlrev_b32 v3, 4, v2
    v_add_u32 v17, v17, v3
    v_add_u32 v1, s32, v1
    v_mul_u32_u24 v19, 9216, v1
    v_lshrrev_b32 v4, 6, v0
    v_and_b32 v4, 1, v4
    v_mul_u32_u24 v4, 48, v4
    v_lshlrev_b32 v3, 2, v2
    v_add_u32 v3, v3, v4
    v_add_u32 v3, s33, v3
    v_mul_u32_u24 v3, 2, v3
    v_add_u32 v19, v19, v3
    v_and_b32 v1, 15, v0
    v_lshrrev_b32 v1, 2, v1
    v_lshlrev_b32 v3, 3, v2
    v_add_u32 v1, v1, v3
    v_mul_u32_u24 v18, 224, v1
    v_and_b32 v1, 3, v0
    v_lshlrev_b32 v1, 3, v1
    v_add_u32 v18, v18, v1
    v_lshlrev_b32 v4, 1, v4
    v_add_u32 v18, v18, v4
    v_mov_b32 v104, 0
    v_mov_b32 v105, 0
    v_mov_b32 v106, 0
    v_mov_b32 v107, 0
    v_mov_b32 v108, 0
    v_mov_b32 v109, 0
    v_mov_b32 v110, 0
    v_mov_b32 v111, 0
    v_mov_b32 v112, 0
    v_mov_b32 v113, 0
    v_mov_b32 v114, 0
    v_mov_b32 v115, 0
    v_mov_b32 v116, 0
    v_mov_b32 v117, 0
    v_mov_b32 v118, 0
    v_mov_b32 v119, 0
    v_mov_b32 v120, 0
    v_mov_b32 v121, 0
    v_mov_b32 v122, 0
    v_mov_b32 v123, 0
    v_mov_b32 v124, 0
    v_mov_b32 v125, 0
    v_mov_b32 v126, 0
    v_mov_b32 v127, 0
    v_mov_b32 v128, 0
    v_mov_b32 v129, 0
    v_mov_b32 v130, 0
    v_mov_b32 v131, 0
    v_mov_b32 v132, 0
    v_mov_b32 v133, 0
    v_mov_b32 v134, 0
    v_mov_b32 v135, 0
    v_mov_b32 v136, 0
    v_mov_b32 v137, 0
    v_mov_b32 v138, 0
    v_mov_b32 v139, 0
    v_mov_b32 v140, 0
    v_mov_b32 v141, 0
    v_mov_b32 v142, 0
    v_mov_b32 v143, 0
    v_mov_b32 v144, 0
    v_mov_b32 v145, 0
    v_mov_b32 v146, 0
    v_mov_b32 v147, 0
    v_mov_b32 v148, 0
    v_mov_b32 v149, 0
    v_mov_b32 v150, 0
    v_mov_b32 v151, 0
    buffer_load_dwordx4 v[20:23], v6, s[8:11], s34 offen
    buffer_load_dwordx4 v[24:27], v7, s[8:11], s34 offen
    buffer_load_dwordx4 v[28:31], v8, s[8:11], s34 offen
    buffer_load_dwordx4 v[32:35], v9, s[8:11], s34 offen
    buffer_load_dwordx4 v[36:39], v11, s[12:15], s35 offen
    buffer_load_dwordx4 v[40:43], v12, s[12:15], s35 offen
    buffer_load_dwordx4 v[44:47], v13, s[12:15], s35 offen
    s_add_u32 s34, s34, 128
    s_add_u32 s35, s35, 589824
    s_waitcnt vmcnt(0)
    ds_write_b128 v10, v[20:23] offset:0
    ds_write_b128 v10, v[24:27] offset:5120
    ds_write_b128 v10, v[28:31] offset:10240
    ds_write_b128 v10, v[32:35] offset:15360
    ds_write_b128 v14, v[36:39] offset:20480
    ds_write_b128 v15, v[40:43] offset:20480
    ds_write_b128 v16, v[44:47] offset:20480
    v_add_u32 v10, 34816, v10
    v_add_u32 v14, 34816, v14
    v_add_u32 v15, 34816, v15
    v_add_u32 v16, 34816, v16
    buffer_load_dwordx4 v[20:23], v6, s[8:11], s34 offen
    buffer_load_dwordx4 v[24:27], v7, s[8:11], s34 offen
    buffer_load_dwordx4 v[28:31], v8, s[8:11], s34 offen
    buffer_load_dwordx4 v[32:35], v9, s[8:11], s34 offen
    buffer_load_dwordx4 v[36:39], v11, s[12:15], s35 offen
    buffer_load_dwordx4 v[40:43], v12, s[12:15], s35 offen
    buffer_load_dwordx4 v[44:47], v13, s[12:15], s35 offen
    s_add_u32 s34, s34, 128
    s_add_u32 s35, s35, 589824
    s_waitcnt lgkmcnt(0)
    s_barrier
    ds_read_b128 v[48:51], v17 offset:0
    ds_read_b128 v[52:55], v17 offset:2560
    ds_read_b128 v[56:59], v17 offset:5120
    ds_read_b128 v[60:63], v17 offset:7680
    ds_read_b64_tr_b16 v[80:81], v18 offset:20480
    ds_read_b64_tr_b16 v[82:83], v18 offset:21376
    ds_read_b64_tr_b16 v[84:85], v18 offset:20512
    ds_read_b64_tr_b16 v[86:87], v18 offset:21408
    ds_read_b64_tr_b16 v[88:89], v18 offset:20544
    ds_read_b64_tr_b16 v[90:91], v18 offset:21440
    s_waitcnt lgkmcnt(0)
    v_mfma_f32_16x16x32_bf16 v[104:107], v[80:83], v[48:51], v[104:107]
    ds_read_b128 v[64:67], v17 offset:64
    v_mfma_f32_16x16x32_bf16 v[108:111], v[84:87], v[48:51], v[108:111]
    ds_read_b128 v[68:71], v17 offset:2624
    v_mfma_f32_16x16x32_bf16 v[112:115], v[88:91], v[48:51], v[112:115]
    ds_read_b128 v[72:75], v17 offset:5184
    v_mfma_f32_16x16x32_bf16 v[116:119], v[80:83], v[52:55], v[116:119]
    ds_read_b128 v[76:79], v17 offset:7744
    v_mfma_f32_16x16x32_bf16 v[120:123], v[84:87], v[52:55], v[120:123]
    ds_read_b64_tr_b16 v[92:93], v18 offset:27648
    v_mfma_f32_16x16x32_bf16 v[124:127], v[88:91], v[52:55], v[124:127]
    ds_read_b64_tr_b16 v[94:95], v18 offset:28544
    v_mfma_f32_16x16x32_bf16 v[128:131], v[80:83], v[56:59], v[128:131]
    ds_read_b64_tr_b16 v[96:97], v18 offset:27680
    v_mfma_f32_16x16x32_bf16 v[132:135], v[84:87], v[56:59], v[132:135]
    ds_read_b64_tr_b16 v[98:99], v18 offset:28576
    v_mfma_f32_16x16x32_bf16 v[136:139], v[88:91], v[56:59], v[136:139]
    ds_read_b64_tr_b16 v[100:101], v18 offset:27712
    v_mfma_f32_16x16x32_bf16 v[140:143], v[80:83], v[60:63], v[140:143]
    ds_read_b64_tr_b16 v[102:103], v18 offset:28608
    v_mfma_f32_16x16x32_bf16 v[144:147], v[84:87], v[60:63], v[144:147]
    v_mfma_f32_16x16x32_bf16 v[148:151], v[88:91], v[60:63], v[148:151]
    s_waitcnt lgkmcnt(0)
    v_mfma_f32_16x16x32_bf16 v[104:107], v[92:95], v[64:67], v[104:107]
    s_waitcnt vmcnt(0)
    ds_write_b128 v10, v[20:23] offset:0
    v_mfma_f32_16x16x32_bf16 v[108:111], v[96:99], v[64:67], v[108:111]
    ds_write_b128 v10, v[24:27] offset:5120
    ds_write_b128 v10, v[28:31] offset:10240
    v_mfma_f32_16x16x32_bf16 v[112:115], v[100:103], v[64:67], v[112:115]
    ds_write_b128 v10, v[32:35] offset:15360
    ds_write_b128 v14, v[36:39] offset:20480
    v_mfma_f32_16x16x32_bf16 v[116:119], v[92:95], v[68:71], v[116:119]
    ds_write_b128 v15, v[40:43] offset:20480
    ds_write_b128 v16, v[44:47] offset:20480
    v_mfma_f32_16x16x32_bf16 v[120:123], v[96:99], v[68:71], v[120:123]
    v_add_u32 v10, 4294932480, v10
    v_add_u32 v14, 4294932480, v14
    v_mfma_f32_16x16x32_bf16 v[124:127], v[100:103], v[68:71], v[124:127]
    v_add_u32 v15, 4294932480, v15
    v_add_u32 v16, 4294932480, v16
    v_mfma_f32_16x16x32_bf16 v[128:131], v[92:95], v[72:75], v[128:131]
    buffer_load_dwordx4 v[20:23], v6, s[8:11], s34 offen
    buffer_load_dwordx4 v[24:27], v7, s[8:11], s34 offen
    v_mfma_f32_16x16x32_bf16 v[132:135], v[96:99], v[72:75], v[132:135]
    buffer_load_dwordx4 v[28:31], v8, s[8:11], s34 offen
    buffer_load_dwordx4 v[32:35], v9, s[8:11], s34 offen
    v_mfma_f32_16x16x32_bf16 v[136:139], v[100:103], v[72:75], v[136:139]
    buffer_load_dwordx4 v[36:39], v11, s[12:15], s35 offen
    buffer_load_dwordx4 v[40:43], v12, s[12:15], s35 offen
    v_mfma_f32_16x16x32_bf16 v[140:143], v[92:95], v[76:79], v[140:143]
    buffer_load_dwordx4 v[44:47], v13, s[12:15], s35 offen
    s_add_u32 s34, s34, 128
    v_mfma_f32_16x16x32_bf16 v[144:147], v[96:99], v[76:79], v[144:147]
    s_add_u32 s35, s35, 589824
    v_mfma_f32_16x16x32_bf16 v[148:151], v[100:103], v[76:79], v[148:151]
    v_add_u32 v17, 34816, v17
    v_add_u32 v18, 34816, v18
    s_waitcnt lgkmcnt(0)
    s_barrier
    ds_read_b128 v[48:51], v17 offset:0
    ds_read_b128 v[52:55], v17 offset:2560
    ds_read_b128 v[56:59], v17 offset:5120
    ds_read_b128 v[60:63], v17 offset:7680
    ds_read_b64_tr_b16 v[80:81], v18 offset:20480
    ds_read_b64_tr_b16 v[82:83], v18 offset:21376
    ds_read_b64_tr_b16 v[84:85], v18 offset:20512
    ds_read_b64_tr_b16 v[86:87], v18 offset:21408
    ds_read_b64_tr_b16 v[88:89], v18 offset:20544
    ds_read_b64_tr_b16 v[90:91], v18 offset:21440
    s_waitcnt lgkmcnt(0)
    v_mfma_f32_16x16x32_bf16 v[104:107], v[80:83], v[48:51], v[104:107]
    ds_read_b128 v[64:67], v17 offset:64
    v_mfma_f32_16x16x32_bf16 v[108:111], v[84:87], v[48:51], v[108:111]
    ds_read_b128 v[68:71], v17 offset:2624
    v_mfma_f32_16x16x32_bf16 v[112:115], v[88:91], v[48:51], v[112:115]
    ds_read_b128 v[72:75], v17 offset:5184
    v_mfma_f32_16x16x32_bf16 v[116:119], v[80:83], v[52:55], v[116:119]
    ds_read_b128 v[76:79], v17 offset:7744
    v_mfma_f32_16x16x32_bf16 v[120:123], v[84:87], v[52:55], v[120:123]
    ds_read_b64_tr_b16 v[92:93], v18 offset:27648
    v_mfma_f32_16x16x32_bf16 v[124:127], v[88:91], v[52:55], v[124:127]
    ds_read_b64_tr_b16 v[94:95], v18 offset:28544
    v_mfma_f32_16x16x32_bf16 v[128:131], v[80:83], v[56:59], v[128:131]
    ds_read_b64_tr_b16 v[96:97], v18 offset:27680
    v_mfma_f32_16x16x32_bf16 v[132:135], v[84:87], v[56:59], v[132:135]
    ds_read_b64_tr_b16 v[98:99], v18 offset:28576
    v_mfma_f32_16x16x32_bf16 v[136:139], v[88:91], v[56:59], v[136:139]
    ds_read_b64_tr_b16 v[100:101], v18 offset:27712
    v_mfma_f32_16x16x32_bf16 v[140:143], v[80:83], v[60:63], v[140:143]
    ds_read_b64_tr_b16 v[102:103], v18 offset:28608
    v_mfma_f32_16x16x32_bf16 v[144:147], v[84:87], v[60:63], v[144:147]
    v_mfma_f32_16x16x32_bf16 v[148:151], v[88:91], v[60:63], v[148:151]
    s_waitcnt lgkmcnt(0)
    v_mfma_f32_16x16x32_bf16 v[104:107], v[92:95], v[64:67], v[104:107]
    s_waitcnt vmcnt(0)
    ds_write_b128 v10, v[20:23] offset:0
    v_mfma_f32_16x16x32_bf16 v[108:111], v[96:99], v[64:67], v[108:111]
    ds_write_b128 v10, v[24:27] offset:5120
    ds_write_b128 v10, v[28:31] offset:10240
    v_mfma_f32_16x16x32_bf16 v[112:115], v[100:103], v[64:67], v[112:115]
    ds_write_b128 v10, v[32:35] offset:15360
    ds_write_b128 v14, v[36:39] offset:20480
    v_mfma_f32_16x16x32_bf16 v[116:119], v[92:95], v[68:71], v[116:119]
    ds_write_b128 v15, v[40:43] offset:20480
    ds_write_b128 v16, v[44:47] offset:20480
    v_mfma_f32_16x16x32_bf16 v[120:123], v[96:99], v[68:71], v[120:123]
    v_add_u32 v10, 34816, v10
    v_add_u32 v14, 34816, v14
    v_mfma_f32_16x16x32_bf16 v[124:127], v[100:103], v[68:71], v[124:127]
    v_add_u32 v15, 34816, v15
    v_add_u32 v16, 34816, v16
    v_mfma_f32_16x16x32_bf16 v[128:131], v[92:95], v[72:75], v[128:131]
    buffer_load_dwordx4 v[20:23], v6, s[8:11], s34 offen
    buffer_load_dwordx4 v[24:27], v7, s[8:11], s34 offen
    v_mfma_f32_16x16x32_bf16 v[132:135], v[96:99], v[72:75], v[132:135]
    buffer_load_dwordx4 v[28:31], v8, s[8:11], s34 offen
    buffer_load_dwordx4 v[32:35], v9, s[8:11], s34 offen
    v_mfma_f32_16x16x32_bf16 v[136:139], v[100:103], v[72:75], v[136:139]
    buffer_load_dwordx4 v[36:39], v11, s[12:15], s35 offen
    buffer_load_dwordx4 v[40:43], v12, s[12:15], s35 offen
    v_mfma_f32_16x16x32_bf16 v[140:143], v[92:95], v[76:79], v[140:143]
    buffer_load_dwordx4 v[44:47], v13, s[12:15], s35 offen
    s_add_u32 s34, s34, 128
    v_mfma_f32_16x16x32_bf16 v[144:147], v[96:99], v[76:79], v[144:147]
    s_add_u32 s35, s35, 589824
    v_mfma_f32_16x16x32_bf16 v[148:151], v[100:103], v[76:79], v[148:151]
    v_add_u32 v17, 4294932480, v17
    v_add_u32 v18, 4294932480, v18
    s_waitcnt lgkmcnt(0)
    s_barrier
    ds_read_b128 v[48:51], v17 offset:0
    ds_read_b128 v[52:55], v17 offset:2560
    ds_read_b128 v[56:59], v17 offset:5120
    ds_read_b128 v[60:63], v17 offset:7680
    ds_read_b64_tr_b16 v[80:81], v18 offset:20480
    ds_read_b64_tr_b16 v[82:83], v18 offset:21376
    ds_read_b64_tr_b16 v[84:85], v18 offset:20512
    ds_read_b64_tr_b16 v[86:87], v18 offset:21408
    ds_read_b64_tr_b16 v[88:89], v18 offset:20544
    ds_read_b64_tr_b16 v[90:91], v18 offset:21440
    s_waitcnt lgkmcnt(0)
    v_mfma_f32_16x16x32_bf16 v[104:107], v[80:83], v[48:51], v[104:107]
    ds_read_b128 v[64:67], v17 offset:64
    v_mfma_f32_16x16x32_bf16 v[108:111], v[84:87], v[48:51], v[108:111]
    ds_read_b128 v[68:71], v17 offset:2624
    v_mfma_f32_16x16x32_bf16 v[112:115], v[88:91], v[48:51], v[112:115]
    ds_read_b128 v[72:75], v17 offset:5184
    v_mfma_f32_16x16x32_bf16 v[116:119], v[80:83], v[52:55], v[116:119]
    ds_read_b128 v[76:79], v17 offset:7744
    v_mfma_f32_16x16x32_bf16 v[120:123], v[84:87], v[52:55], v[120:123]
    ds_read_b64_tr_b16 v[92:93], v18 offset:27648
    v_mfma_f32_16x16x32_bf16 v[124:127], v[88:91], v[52:55], v[124:127]
    ds_read_b64_tr_b16 v[94:95], v18 offset:28544
    v_mfma_f32_16x16x32_bf16 v[128:131], v[80:83], v[56:59], v[128:131]
    ds_read_b64_tr_b16 v[96:97], v18 offset:27680
    v_mfma_f32_16x16x32_bf16 v[132:135], v[84:87], v[56:59], v[132:135]
    ds_read_b64_tr_b16 v[98:99], v18 offset:28576
    v_mfma_f32_16x16x32_bf16 v[136:139], v[88:91], v[56:59], v[136:139]
    ds_read_b64_tr_b16 v[100:101], v18 offset:27712
    v_mfma_f32_16x16x32_bf16 v[140:143], v[80:83], v[60:63], v[140:143]
    ds_read_b64_tr_b16 v[102:103], v18 offset:28608
    v_mfma_f32_16x16x32_bf16 v[144:147], v[84:87], v[60:63], v[144:147]
    v_mfma_f32_16x16x32_bf16 v[148:151], v[88:91], v[60:63], v[148:151]
    s_waitcnt lgkmcnt(0)
    v_mfma_f32_16x16x32_bf16 v[104:107], v[92:95], v[64:67], v[104:107]
    s_waitcnt vmcnt(0)
    ds_write_b128 v10, v[20:23] offset:0
    v_mfma_f32_16x16x32_bf16 v[108:111], v[96:99], v[64:67], v[108:111]
    ds_write_b128 v10, v[24:27] offset:5120
    ds_write_b128 v10, v[28:31] offset:10240
    v_mfma_f32_16x16x32_bf16 v[112:115], v[100:103], v[64:67], v[112:115]
    ds_write_b128 v10, v[32:35] offset:15360
    ds_write_b128 v14, v[36:39] offset:20480
    v_mfma_f32_16x16x32_bf16 v[116:119], v[92:95], v[68:71], v[116:119]
    ds_write_b128 v15, v[40:43] offset:20480
    ds_write_b128 v16, v[44:47] offset:20480
    v_mfma_f32_16x16x32_bf16 v[120:123], v[96:99], v[68:71], v[120:123]
    v_add_u32 v10, 4294932480, v10
    v_add_u32 v14, 4294932480, v14
    v_mfma_f32_16x16x32_bf16 v[124:127], v[100:103], v[68:71], v[124:127]
    v_add_u32 v15, 4294932480, v15
    v_add_u32 v16, 4294932480, v16
    v_mfma_f32_16x16x32_bf16 v[128:131], v[92:95], v[72:75], v[128:131]
    buffer_load_dwordx4 v[20:23], v6, s[8:11], s34 offen
    buffer_load_dwordx4 v[24:27], v7, s[8:11], s34 offen
    v_mfma_f32_16x16x32_bf16 v[132:135], v[96:99], v[72:75], v[132:135]
    buffer_load_dwordx4 v[28:31], v8, s[8:11], s34 offen
    buffer_load_dwordx4 v[32:35], v9, s[8:11], s34 offen
    v_mfma_f32_16x16x32_bf16 v[136:139], v[100:103], v[72:75], v[136:139]
    buffer_load_dwordx4 v[36:39], v11, s[12:15], s35 offen
    buffer_load_dwordx4 v[40:43], v12, s[12:15], s35 offen
    v_mfma_f32_16x16x32_bf16 v[140:143], v[92:95], v[76:79], v[140:143]
    buffer_load_dwordx4 v[44:47], v13, s[12:15], s35 offen
    s_add_u32 s34, s34, 128
    v_mfma_f32_16x16x32_bf16 v[144:147], v[96:99], v[76:79], v[144:147]
    s_add_u32 s35, s35, 589824
    v_mfma_f32_16x16x32_bf16 v[148:151], v[100:103], v[76:79], v[148:151]
    v_add_u32 v17, 34816, v17
    v_add_u32 v18, 34816, v18
    s_waitcnt lgkmcnt(0)
    s_barrier
    ds_read_b128 v[48:51], v17 offset:0
    ds_read_b128 v[52:55], v17 offset:2560
    ds_read_b128 v[56:59], v17 offset:5120
    ds_read_b128 v[60:63], v17 offset:7680
    ds_read_b64_tr_b16 v[80:81], v18 offset:20480
    ds_read_b64_tr_b16 v[82:83], v18 offset:21376
    ds_read_b64_tr_b16 v[84:85], v18 offset:20512
    ds_read_b64_tr_b16 v[86:87], v18 offset:21408
    ds_read_b64_tr_b16 v[88:89], v18 offset:20544
    ds_read_b64_tr_b16 v[90:91], v18 offset:21440
    s_waitcnt lgkmcnt(0)
    v_mfma_f32_16x16x32_bf16 v[104:107], v[80:83], v[48:51], v[104:107]
    ds_read_b128 v[64:67], v17 offset:64
    v_mfma_f32_16x16x32_bf16 v[108:111], v[84:87], v[48:51], v[108:111]
    ds_read_b128 v[68:71], v17 offset:2624
    v_mfma_f32_16x16x32_bf16 v[112:115], v[88:91], v[48:51], v[112:115]
    ds_read_b128 v[72:75], v17 offset:5184
    v_mfma_f32_16x16x32_bf16 v[116:119], v[80:83], v[52:55], v[116:119]
    ds_read_b128 v[76:79], v17 offset:7744
    v_mfma_f32_16x16x32_bf16 v[120:123], v[84:87], v[52:55], v[120:123]
    ds_read_b64_tr_b16 v[92:93], v18 offset:27648
    v_mfma_f32_16x16x32_bf16 v[124:127], v[88:91], v[52:55], v[124:127]
    ds_read_b64_tr_b16 v[94:95], v18 offset:28544
    v_mfma_f32_16x16x32_bf16 v[128:131], v[80:83], v[56:59], v[128:131]
    ds_read_b64_tr_b16 v[96:97], v18 offset:27680
    v_mfma_f32_16x16x32_bf16 v[132:135], v[84:87], v[56:59], v[132:135]
    ds_read_b64_tr_b16 v[98:99], v18 offset:28576
    v_mfma_f32_16x16x32_bf16 v[136:139], v[88:91], v[56:59], v[136:139]
    ds_read_b64_tr_b16 v[100:101], v18 offset:27712
    v_mfma_f32_16x16x32_bf16 v[140:143], v[80:83], v[60:63], v[140:143]
    ds_read_b64_tr_b16 v[102:103], v18 offset:28608
    v_mfma_f32_16x16x32_bf16 v[144:147], v[84:87], v[60:63], v[144:147]
    v_mfma_f32_16x16x32_bf16 v[148:151], v[88:91], v[60:63], v[148:151]
    s_waitcnt lgkmcnt(0)
    v_mfma_f32_16x16x32_bf16 v[104:107], v[92:95], v[64:67], v[104:107]
    s_waitcnt vmcnt(0)
    ds_write_b128 v10, v[20:23] offset:0
    v_mfma_f32_16x16x32_bf16 v[108:111], v[96:99], v[64:67], v[108:111]
    ds_write_b128 v10, v[24:27] offset:5120
    ds_write_b128 v10, v[28:31] offset:10240
    v_mfma_f32_16x16x32_bf16 v[112:115], v[100:103], v[64:67], v[112:115]
    ds_write_b128 v10, v[32:35] offset:15360
    ds_write_b128 v14, v[36:39] offset:20480
    v_mfma_f32_16x16x32_bf16 v[116:119], v[92:95], v[68:71], v[116:119]
    ds_write_b128 v15, v[40:43] offset:20480
    ds_write_b128 v16, v[44:47] offset:20480
    v_mfma_f32_16x16x32_bf16 v[120:123], v[96:99], v[68:71], v[120:123]
    v_add_u32 v10, 34816, v10
    v_add_u32 v14, 34816, v14
    v_mfma_f32_16x16x32_bf16 v[124:127], v[100:103], v[68:71], v[124:127]
    v_add_u32 v15, 34816, v15
    v_add_u32 v16, 34816, v16
    v_mfma_f32_16x16x32_bf16 v[128:131], v[92:95], v[72:75], v[128:131]
    buffer_load_dwordx4 v[20:23], v6, s[8:11], s34 offen
    buffer_load_dwordx4 v[24:27], v7, s[8:11], s34 offen
    v_mfma_f32_16x16x32_bf16 v[132:135], v[96:99], v[72:75], v[132:135]
    buffer_load_dwordx4 v[28:31], v8, s[8:11], s34 offen
    buffer_load_dwordx4 v[32:35], v9, s[8:11], s34 offen
    v_mfma_f32_16x16x32_bf16 v[136:139], v[100:103], v[72:75], v[136:139]
    buffer_load_dwordx4 v[36:39], v11, s[12:15], s35 offen
    buffer_load_dwordx4 v[40:43], v12, s[12:15], s35 offen
    v_mfma_f32_16x16x32_bf16 v[140:143], v[92:95], v[76:79], v[140:143]
    buffer_load_dwordx4 v[44:47], v13, s[12:15], s35 offen
    s_add_u32 s34, s34, 128
    v_mfma_f32_16x16x32_bf16 v[144:147], v[96:99], v[76:79], v[144:147]
    s_add_u32 s35, s35, 589824
    v_mfma_f32_16x16x32_bf16 v[148:151], v[100:103], v[76:79], v[148:151]
    v_add_u32 v17, 4294932480, v17
    v_add_u32 v18, 4294932480, v18
    s_waitcnt lgkmcnt(0)
    s_barrier
    ds_read_b128 v[48:51], v17 offset:0
    ds_read_b128 v[52:55], v17 offset:2560
    ds_read_b128 v[56:59], v17 offset:5120
    ds_read_b128 v[60:63], v17 offset:7680
    ds_read_b64_tr_b16 v[80:81], v18 offset:20480
    ds_read_b64_tr_b16 v[82:83], v18 offset:21376
    ds_read_b64_tr_b16 v[84:85], v18 offset:20512
    ds_read_b64_tr_b16 v[86:87], v18 offset:21408
    ds_read_b64_tr_b16 v[88:89], v18 offset:20544
    ds_read_b64_tr_b16 v[90:91], v18 offset:21440
    s_waitcnt lgkmcnt(0)
    v_mfma_f32_16x16x32_bf16 v[104:107], v[80:83], v[48:51], v[104:107]
    ds_read_b128 v[64:67], v17 offset:64
    v_mfma_f32_16x16x32_bf16 v[108:111], v[84:87], v[48:51], v[108:111]
    ds_read_b128 v[68:71], v17 offset:2624
    v_mfma_f32_16x16x32_bf16 v[112:115], v[88:91], v[48:51], v[112:115]
    ds_read_b128 v[72:75], v17 offset:5184
    v_mfma_f32_16x16x32_bf16 v[116:119], v[80:83], v[52:55], v[116:119]
    ds_read_b128 v[76:79], v17 offset:7744
    v_mfma_f32_16x16x32_bf16 v[120:123], v[84:87], v[52:55], v[120:123]
    ds_read_b64_tr_b16 v[92:93], v18 offset:27648
    v_mfma_f32_16x16x32_bf16 v[124:127], v[88:91], v[52:55], v[124:127]
    ds_read_b64_tr_b16 v[94:95], v18 offset:28544
    v_mfma_f32_16x16x32_bf16 v[128:131], v[80:83], v[56:59], v[128:131]
    ds_read_b64_tr_b16 v[96:97], v18 offset:27680
    v_mfma_f32_16x16x32_bf16 v[132:135], v[84:87], v[56:59], v[132:135]
    ds_read_b64_tr_b16 v[98:99], v18 offset:28576
    v_mfma_f32_16x16x32_bf16 v[136:139], v[88:91], v[56:59], v[136:139]
    ds_read_b64_tr_b16 v[100:101], v18 offset:27712
    v_mfma_f32_16x16x32_bf16 v[140:143], v[80:83], v[60:63], v[140:143]
    ds_read_b64_tr_b16 v[102:103], v18 offset:28608
    v_mfma_f32_16x16x32_bf16 v[144:147], v[84:87], v[60:63], v[144:147]
    v_mfma_f32_16x16x32_bf16 v[148:151], v[88:91], v[60:63], v[148:151]
    s_waitcnt lgkmcnt(0)
    v_mfma_f32_16x16x32_bf16 v[104:107], v[92:95], v[64:67], v[104:107]
    s_waitcnt vmcnt(0)
    ds_write_b128 v10, v[20:23] offset:0
    v_mfma_f32_16x16x32_bf16 v[108:111], v[96:99], v[64:67], v[108:111]
    ds_write_b128 v10, v[24:27] offset:5120
    ds_write_b128 v10, v[28:31] offset:10240
    v_mfma_f32_16x16x32_bf16 v[112:115], v[100:103], v[64:67], v[112:115]
    ds_write_b128 v10, v[32:35] offset:15360
    ds_write_b128 v14, v[36:39] offset:20480
    v_mfma_f32_16x16x32_bf16 v[116:119], v[92:95], v[68:71], v[116:119]
    ds_write_b128 v15, v[40:43] offset:20480
    ds_write_b128 v16, v[44:47] offset:20480
    v_mfma_f32_16x16x32_bf16 v[120:123], v[96:99], v[68:71], v[120:123]
    v_add_u32 v10, 4294932480, v10
    v_add_u32 v14, 4294932480, v14
    v_mfma_f32_16x16x32_bf16 v[124:127], v[100:103], v[68:71], v[124:127]
    v_add_u32 v15, 4294932480, v15
    v_add_u32 v16, 4294932480, v16
    v_mfma_f32_16x16x32_bf16 v[128:131], v[92:95], v[72:75], v[128:131]
    buffer_load_dwordx4 v[20:23], v6, s[8:11], s34 offen
    buffer_load_dwordx4 v[24:27], v7, s[8:11], s34 offen
    v_mfma_f32_16x16x32_bf16 v[132:135], v[96:99], v[72:75], v[132:135]
    buffer_load_dwordx4 v[28:31], v8, s[8:11], s34 offen
    buffer_load_dwordx4 v[32:35], v9, s[8:11], s34 offen
    v_mfma_f32_16x16x32_bf16 v[136:139], v[100:103], v[72:75], v[136:139]
    buffer_load_dwordx4 v[36:39], v11, s[12:15], s35 offen
    buffer_load_dwordx4 v[40:43], v12, s[12:15], s35 offen
    v_mfma_f32_16x16x32_bf16 v[140:143], v[92:95], v[76:79], v[140:143]
    buffer_load_dwordx4 v[44:47], v13, s[12:15], s35 offen
    s_add_u32 s34, s34, 128
    v_mfma_f32_16x16x32_bf16 v[144:147], v[96:99], v[76:79], v[144:147]
    s_add_u32 s35, s35, 589824
    v_mfma_f32_16x16x32_bf16 v[148:151], v[100:103], v[76:79], v[148:151]
    v_add_u32 v17, 34816, v17
    v_add_u32 v18, 34816, v18
    s_waitcnt lgkmcnt(0)
    s_barrier
    ds_read_b128 v[48:51], v17 offset:0
    ds_read_b128 v[52:55], v17 offset:2560
    ds_read_b128 v[56:59], v17 offset:5120
    ds_read_b128 v[60:63], v17 offset:7680
    ds_read_b64_tr_b16 v[80:81], v18 offset:20480
    ds_read_b64_tr_b16 v[82:83], v18 offset:21376
    ds_read_b64_tr_b16 v[84:85], v18 offset:20512
    ds_read_b64_tr_b16 v[86:87], v18 offset:21408
    ds_read_b64_tr_b16 v[88:89], v18 offset:20544
    ds_read_b64_tr_b16 v[90:91], v18 offset:21440
    s_waitcnt lgkmcnt(0)
    v_mfma_f32_16x16x32_bf16 v[104:107], v[80:83], v[48:51], v[104:107]
    ds_read_b128 v[64:67], v17 offset:64
    v_mfma_f32_16x16x32_bf16 v[108:111], v[84:87], v[48:51], v[108:111]
    ds_read_b128 v[68:71], v17 offset:2624
    v_mfma_f32_16x16x32_bf16 v[112:115], v[88:91], v[48:51], v[112:115]
    ds_read_b128 v[72:75], v17 offset:5184
    v_mfma_f32_16x16x32_bf16 v[116:119], v[80:83], v[52:55], v[116:119]
    ds_read_b128 v[76:79], v17 offset:7744
    v_mfma_f32_16x16x32_bf16 v[120:123], v[84:87], v[52:55], v[120:123]
    ds_read_b64_tr_b16 v[92:93], v18 offset:27648
    v_mfma_f32_16x16x32_bf16 v[124:127], v[88:91], v[52:55], v[124:127]
    ds_read_b64_tr_b16 v[94:95], v18 offset:28544
    v_mfma_f32_16x16x32_bf16 v[128:131], v[80:83], v[56:59], v[128:131]
    ds_read_b64_tr_b16 v[96:97], v18 offset:27680
    v_mfma_f32_16x16x32_bf16 v[132:135], v[84:87], v[56:59], v[132:135]
    ds_read_b64_tr_b16 v[98:99], v18 offset:28576
    v_mfma_f32_16x16x32_bf16 v[136:139], v[88:91], v[56:59], v[136:139]
    ds_read_b64_tr_b16 v[100:101], v18 offset:27712
    v_mfma_f32_16x16x32_bf16 v[140:143], v[80:83], v[60:63], v[140:143]
    ds_read_b64_tr_b16 v[102:103], v18 offset:28608
    v_mfma_f32_16x16x32_bf16 v[144:147], v[84:87], v[60:63], v[144:147]
    v_mfma_f32_16x16x32_bf16 v[148:151], v[88:91], v[60:63], v[148:151]
    s_waitcnt lgkmcnt(0)
    v_mfma_f32_16x16x32_bf16 v[104:107], v[92:95], v[64:67], v[104:107]
    s_waitcnt vmcnt(0)
    ds_write_b128 v10, v[20:23] offset:0
    v_mfma_f32_16x16x32_bf16 v[108:111], v[96:99], v[64:67], v[108:111]
    ds_write_b128 v10, v[24:27] offset:5120
    ds_write_b128 v10, v[28:31] offset:10240
    v_mfma_f32_16x16x32_bf16 v[112:115], v[100:103], v[64:67], v[112:115]
    ds_write_b128 v10, v[32:35] offset:15360
    ds_write_b128 v14, v[36:39] offset:20480
    v_mfma_f32_16x16x32_bf16 v[116:119], v[92:95], v[68:71], v[116:119]
    ds_write_b128 v15, v[40:43] offset:20480
    ds_write_b128 v16, v[44:47] offset:20480
    v_mfma_f32_16x16x32_bf16 v[120:123], v[96:99], v[68:71], v[120:123]
    v_add_u32 v10, 34816, v10
    v_add_u32 v14, 34816, v14
    v_mfma_f32_16x16x32_bf16 v[124:127], v[100:103], v[68:71], v[124:127]
    v_add_u32 v15, 34816, v15
    v_add_u32 v16, 34816, v16
    v_mfma_f32_16x16x32_bf16 v[128:131], v[92:95], v[72:75], v[128:131]
    buffer_load_dwordx4 v[20:23], v6, s[8:11], s34 offen
    buffer_load_dwordx4 v[24:27], v7, s[8:11], s34 offen
    v_mfma_f32_16x16x32_bf16 v[132:135], v[96:99], v[72:75], v[132:135]
    buffer_load_dwordx4 v[28:31], v8, s[8:11], s34 offen
    buffer_load_dwordx4 v[32:35], v9, s[8:11], s34 offen
    v_mfma_f32_16x16x32_bf16 v[136:139], v[100:103], v[72:75], v[136:139]
    buffer_load_dwordx4 v[36:39], v11, s[12:15], s35 offen
    buffer_load_dwordx4 v[40:43], v12, s[12:15], s35 offen
    v_mfma_f32_16x16x32_bf16 v[140:143], v[92:95], v[76:79], v[140:143]
    buffer_load_dwordx4 v[44:47], v13, s[12:15], s35 offen
    s_add_u32 s34, s34, 128
    v_mfma_f32_16x16x32_bf16 v[144:147], v[96:99], v[76:79], v[144:147]
    s_add_u32 s35, s35, 589824
    v_mfma_f32_16x16x32_bf16 v[148:151], v[100:103], v[76:79], v[148:151]
    v_add_u32 v17, 4294932480, v17
    v_add_u32 v18, 4294932480, v18
    s_waitcnt lgkmcnt(0)
    s_barrier
    ds_read_b128 v[48:51], v17 offset:0
    ds_read_b128 v[52:55], v17 offset:2560
    ds_read_b128 v[56:59], v17 offset:5120
    ds_read_b128 v[60:63], v17 offset:7680
    ds_read_b64_tr_b16 v[80:81], v18 offset:20480
    ds_read_b64_tr_b16 v[82:83], v18 offset:21376
    ds_read_b64_tr_b16 v[84:85], v18 offset:20512
    ds_read_b64_tr_b16 v[86:87], v18 offset:21408
    ds_read_b64_tr_b16 v[88:89], v18 offset:20544
    ds_read_b64_tr_b16 v[90:91], v18 offset:21440
    s_waitcnt lgkmcnt(0)
    v_mfma_f32_16x16x32_bf16 v[104:107], v[80:83], v[48:51], v[104:107]
    ds_read_b128 v[64:67], v17 offset:64
    v_mfma_f32_16x16x32_bf16 v[108:111], v[84:87], v[48:51], v[108:111]
    ds_read_b128 v[68:71], v17 offset:2624
    v_mfma_f32_16x16x32_bf16 v[112:115], v[88:91], v[48:51], v[112:115]
    ds_read_b128 v[72:75], v17 offset:5184
    v_mfma_f32_16x16x32_bf16 v[116:119], v[80:83], v[52:55], v[116:119]
    ds_read_b128 v[76:79], v17 offset:7744
    v_mfma_f32_16x16x32_bf16 v[120:123], v[84:87], v[52:55], v[120:123]
    ds_read_b64_tr_b16 v[92:93], v18 offset:27648
    v_mfma_f32_16x16x32_bf16 v[124:127], v[88:91], v[52:55], v[124:127]
    ds_read_b64_tr_b16 v[94:95], v18 offset:28544
    v_mfma_f32_16x16x32_bf16 v[128:131], v[80:83], v[56:59], v[128:131]
    ds_read_b64_tr_b16 v[96:97], v18 offset:27680
    v_mfma_f32_16x16x32_bf16 v[132:135], v[84:87], v[56:59], v[132:135]
    ds_read_b64_tr_b16 v[98:99], v18 offset:28576
    v_mfma_f32_16x16x32_bf16 v[136:139], v[88:91], v[56:59], v[136:139]
    ds_read_b64_tr_b16 v[100:101], v18 offset:27712
    v_mfma_f32_16x16x32_bf16 v[140:143], v[80:83], v[60:63], v[140:143]
    ds_read_b64_tr_b16 v[102:103], v18 offset:28608
    v_mfma_f32_16x16x32_bf16 v[144:147], v[84:87], v[60:63], v[144:147]
    v_mfma_f32_16x16x32_bf16 v[148:151], v[88:91], v[60:63], v[148:151]
    s_waitcnt lgkmcnt(0)
    v_mfma_f32_16x16x32_bf16 v[104:107], v[92:95], v[64:67], v[104:107]
    s_waitcnt vmcnt(0)
    ds_write_b128 v10, v[20:23] offset:0
    v_mfma_f32_16x16x32_bf16 v[108:111], v[96:99], v[64:67], v[108:111]
    ds_write_b128 v10, v[24:27] offset:5120
    ds_write_b128 v10, v[28:31] offset:10240
    v_mfma_f32_16x16x32_bf16 v[112:115], v[100:103], v[64:67], v[112:115]
    ds_write_b128 v10, v[32:35] offset:15360
    ds_write_b128 v14, v[36:39] offset:20480
    v_mfma_f32_16x16x32_bf16 v[116:119], v[92:95], v[68:71], v[116:119]
    ds_write_b128 v15, v[40:43] offset:20480
    ds_write_b128 v16, v[44:47] offset:20480
    v_mfma_f32_16x16x32_bf16 v[120:123], v[96:99], v[68:71], v[120:123]
    v_add_u32 v10, 4294932480, v10
    v_add_u32 v14, 4294932480, v14
    v_mfma_f32_16x16x32_bf16 v[124:127], v[100:103], v[68:71], v[124:127]
    v_add_u32 v15, 4294932480, v15
    v_add_u32 v16, 4294932480, v16
    v_mfma_f32_16x16x32_bf16 v[128:131], v[92:95], v[72:75], v[128:131]
    buffer_load_dwordx4 v[20:23], v6, s[8:11], s34 offen
    buffer_load_dwordx4 v[24:27], v7, s[8:11], s34 offen
    v_mfma_f32_16x16x32_bf16 v[132:135], v[96:99], v[72:75], v[132:135]
    buffer_load_dwordx4 v[28:31], v8, s[8:11], s34 offen
    buffer_load_dwordx4 v[32:35], v9, s[8:11], s34 offen
    v_mfma_f32_16x16x32_bf16 v[136:139], v[100:103], v[72:75], v[136:139]
    buffer_load_dwordx4 v[36:39], v11, s[12:15], s35 offen
    buffer_load_dwordx4 v[40:43], v12, s[12:15], s35 offen
    v_mfma_f32_16x16x32_bf16 v[140:143], v[92:95], v[76:79], v[140:143]
    buffer_load_dwordx4 v[44:47], v13, s[12:15], s35 offen
    s_add_u32 s34, s34, 128
    v_mfma_f32_16x16x32_bf16 v[144:147], v[96:99], v[76:79], v[144:147]
    s_add_u32 s35, s35, 589824
    v_mfma_f32_16x16x32_bf16 v[148:151], v[100:103], v[76:79], v[148:151]
    v_add_u32 v17, 34816, v17
    v_add_u32 v18, 34816, v18
    s_waitcnt lgkmcnt(0)
    s_barrier
    ds_read_b128 v[48:51], v17 offset:0
    ds_read_b128 v[52:55], v17 offset:2560
    ds_read_b128 v[56:59], v17 offset:5120
    ds_read_b128 v[60:63], v17 offset:7680
    ds_read_b64_tr_b16 v[80:81], v18 offset:20480
    ds_read_b64_tr_b16 v[82:83], v18 offset:21376
    ds_read_b64_tr_b16 v[84:85], v18 offset:20512
    ds_read_b64_tr_b16 v[86:87], v18 offset:21408
    ds_read_b64_tr_b16 v[88:89], v18 offset:20544
    ds_read_b64_tr_b16 v[90:91], v18 offset:21440
    s_waitcnt lgkmcnt(0)
    v_mfma_f32_16x16x32_bf16 v[104:107], v[80:83], v[48:51], v[104:107]
    ds_read_b128 v[64:67], v17 offset:64
    v_mfma_f32_16x16x32_bf16 v[108:111], v[84:87], v[48:51], v[108:111]
    ds_read_b128 v[68:71], v17 offset:2624
    v_mfma_f32_16x16x32_bf16 v[112:115], v[88:91], v[48:51], v[112:115]
    ds_read_b128 v[72:75], v17 offset:5184
    v_mfma_f32_16x16x32_bf16 v[116:119], v[80:83], v[52:55], v[116:119]
    ds_read_b128 v[76:79], v17 offset:7744
    v_mfma_f32_16x16x32_bf16 v[120:123], v[84:87], v[52:55], v[120:123]
    ds_read_b64_tr_b16 v[92:93], v18 offset:27648
    v_mfma_f32_16x16x32_bf16 v[124:127], v[88:91], v[52:55], v[124:127]
    ds_read_b64_tr_b16 v[94:95], v18 offset:28544
    v_mfma_f32_16x16x32_bf16 v[128:131], v[80:83], v[56:59], v[128:131]
    ds_read_b64_tr_b16 v[96:97], v18 offset:27680
    v_mfma_f32_16x16x32_bf16 v[132:135], v[84:87], v[56:59], v[132:135]
    ds_read_b64_tr_b16 v[98:99], v18 offset:28576
    v_mfma_f32_16x16x32_bf16 v[136:139], v[88:91], v[56:59], v[136:139]
    ds_read_b64_tr_b16 v[100:101], v18 offset:27712
    v_mfma_f32_16x16x32_bf16 v[140:143], v[80:83], v[60:63], v[140:143]
    ds_read_b64_tr_b16 v[102:103], v18 offset:28608
    v_mfma_f32_16x16x32_bf16 v[144:147], v[84:87], v[60:63], v[144:147]
    v_mfma_f32_16x16x32_bf16 v[148:151], v[88:91], v[60:63], v[148:151]
    s_waitcnt lgkmcnt(0)
    v_mfma_f32_16x16x32_bf16 v[104:107], v[92:95], v[64:67], v[104:107]
    s_waitcnt vmcnt(0)
    v_mfma_f32_16x16x32_bf16 v[108:111], v[96:99], v[64:67], v[108:111]
    ds_write_b128 v10, v[20:23] offset:0
    v_mfma_f32_16x16x32_bf16 v[112:115], v[100:103], v[64:67], v[112:115]
    ds_write_b128 v10, v[24:27] offset:5120
    v_mfma_f32_16x16x32_bf16 v[116:119], v[92:95], v[68:71], v[116:119]
    ds_write_b128 v10, v[28:31] offset:10240
    v_mfma_f32_16x16x32_bf16 v[120:123], v[96:99], v[68:71], v[120:123]
    ds_write_b128 v10, v[32:35] offset:15360
    v_mfma_f32_16x16x32_bf16 v[124:127], v[100:103], v[68:71], v[124:127]
    ds_write_b128 v14, v[36:39] offset:20480
    v_mfma_f32_16x16x32_bf16 v[128:131], v[92:95], v[72:75], v[128:131]
    ds_write_b128 v15, v[40:43] offset:20480
    v_mfma_f32_16x16x32_bf16 v[132:135], v[96:99], v[72:75], v[132:135]
    ds_write_b128 v16, v[44:47] offset:20480
    v_mfma_f32_16x16x32_bf16 v[136:139], v[100:103], v[72:75], v[136:139]
    v_add_u32 v10, 34816, v10
    v_mfma_f32_16x16x32_bf16 v[140:143], v[92:95], v[76:79], v[140:143]
    v_add_u32 v14, 34816, v14
    v_mfma_f32_16x16x32_bf16 v[144:147], v[96:99], v[76:79], v[144:147]
    v_add_u32 v15, 34816, v15
    v_mfma_f32_16x16x32_bf16 v[148:151], v[100:103], v[76:79], v[148:151]
    v_add_u32 v16, 34816, v16
    v_add_u32 v17, 4294932480, v17
    v_add_u32 v18, 4294932480, v18
    s_waitcnt lgkmcnt(0)
    s_barrier
    ds_read_b128 v[48:51], v17 offset:0
    ds_read_b128 v[52:55], v17 offset:2560
    ds_read_b128 v[56:59], v17 offset:5120
    ds_read_b128 v[60:63], v17 offset:7680
    ds_read_b64_tr_b16 v[80:81], v18 offset:20480
    ds_read_b64_tr_b16 v[82:83], v18 offset:21376
    ds_read_b64_tr_b16 v[84:85], v18 offset:20512
    ds_read_b64_tr_b16 v[86:87], v18 offset:21408
    ds_read_b64_tr_b16 v[88:89], v18 offset:20544
    ds_read_b64_tr_b16 v[90:91], v18 offset:21440
    s_waitcnt lgkmcnt(0)
    v_mfma_f32_16x16x32_bf16 v[104:107], v[80:83], v[48:51], v[104:107]
    ds_read_b128 v[64:67], v17 offset:64
    v_mfma_f32_16x16x32_bf16 v[108:111], v[84:87], v[48:51], v[108:111]
    ds_read_b128 v[68:71], v17 offset:2624
    v_mfma_f32_16x16x32_bf16 v[112:115], v[88:91], v[48:51], v[112:115]
    ds_read_b128 v[72:75], v17 offset:5184
    v_mfma_f32_16x16x32_bf16 v[116:119], v[80:83], v[52:55], v[116:119]
    ds_read_b128 v[76:79], v17 offset:7744
    v_mfma_f32_16x16x32_bf16 v[120:123], v[84:87], v[52:55], v[120:123]
    ds_read_b64_tr_b16 v[92:93], v18 offset:27648
    v_mfma_f32_16x16x32_bf16 v[124:127], v[88:91], v[52:55], v[124:127]
    ds_read_b64_tr_b16 v[94:95], v18 offset:28544
    v_mfma_f32_16x16x32_bf16 v[128:131], v[80:83], v[56:59], v[128:131]
    ds_read_b64_tr_b16 v[96:97], v18 offset:27680
    v_mfma_f32_16x16x32_bf16 v[132:135], v[84:87], v[56:59], v[132:135]
    ds_read_b64_tr_b16 v[98:99], v18 offset:28576
    v_mfma_f32_16x16x32_bf16 v[136:139], v[88:91], v[56:59], v[136:139]
    ds_read_b64_tr_b16 v[100:101], v18 offset:27712
    v_mfma_f32_16x16x32_bf16 v[140:143], v[80:83], v[60:63], v[140:143]
    ds_read_b64_tr_b16 v[102:103], v18 offset:28608
    v_mfma_f32_16x16x32_bf16 v[144:147], v[84:87], v[60:63], v[144:147]
    v_mfma_f32_16x16x32_bf16 v[148:151], v[88:91], v[60:63], v[148:151]
    s_waitcnt lgkmcnt(0)
    v_mfma_f32_16x16x32_bf16 v[104:107], v[92:95], v[64:67], v[104:107]
    v_mfma_f32_16x16x32_bf16 v[108:111], v[96:99], v[64:67], v[108:111]
    v_mfma_f32_16x16x32_bf16 v[112:115], v[100:103], v[64:67], v[112:115]
    v_mfma_f32_16x16x32_bf16 v[116:119], v[92:95], v[68:71], v[116:119]
    v_mfma_f32_16x16x32_bf16 v[120:123], v[96:99], v[68:71], v[120:123]
    v_mfma_f32_16x16x32_bf16 v[124:127], v[100:103], v[68:71], v[124:127]
    v_mfma_f32_16x16x32_bf16 v[128:131], v[92:95], v[72:75], v[128:131]
    v_mfma_f32_16x16x32_bf16 v[132:135], v[96:99], v[72:75], v[132:135]
    v_mfma_f32_16x16x32_bf16 v[136:139], v[100:103], v[72:75], v[136:139]
    v_mfma_f32_16x16x32_bf16 v[140:143], v[92:95], v[76:79], v[140:143]
    v_mfma_f32_16x16x32_bf16 v[144:147], v[96:99], v[76:79], v[144:147]
    v_mfma_f32_16x16x32_bf16 v[148:151], v[100:103], v[76:79], v[148:151]
    s_nop 7
    s_nop 7
    v_cvt_pk_bf16_f32 v20, v104, v105
    v_cvt_pk_bf16_f32 v21, v106, v107
    v_lshlrev_b32 v22, 16, v20
    v_and_b32 v23, 0xffff0000, v20
    v_lshlrev_b32 v24, 16, v21
    v_and_b32 v25, 0xffff0000, v21
    s_mov_b32 s6, 0xbdd2d3e8
    s_mov_b32 s7, 0xc0135761
    v_mul_f32 v32, v22, v22
    v_mul_f32 v33, v23, v23
    v_mul_f32 v34, v24, v24
    v_mul_f32 v35, v25, v25
    v_mov_b32 v26, s7
    v_fma_f32 v32, v32, s6, v26
    v_mov_b32 v26, s7
    v_fma_f32 v33, v33, s6, v26
    v_mov_b32 v26, s7
    v_fma_f32 v34, v34, s6, v26
    v_mov_b32 v26, s7
    v_fma_f32 v35, v35, s6, v26
    v_mul_f32 v32, v32, v22
    v_mul_f32 v33, v33, v23
    v_mul_f32 v34, v34, v24
    v_mul_f32 v35, v35, v25
    v_exp_f32 v32, v32
    v_exp_f32 v33, v33
    v_exp_f32 v34, v34
    v_exp_f32 v35, v35
    s_nop 0
    v_add_f32 v32, 1.0, v32
    v_add_f32 v33, 1.0, v33
    v_add_f32 v34, 1.0, v34
    v_add_f32 v35, 1.0, v35
    v_rcp_f32 v32, v32
    v_rcp_f32 v33, v33
    v_rcp_f32 v34, v34
    v_rcp_f32 v35, v35
    s_nop 0
    v_mul_f32 v32, v32, v22
    v_mul_f32 v33, v33, v23
    v_mul_f32 v34, v34, v24
    v_mul_f32 v35, v35, v25
    v_cvt_pk_bf16_f32 v20, v32, v33
    v_cvt_pk_bf16_f32 v21, v34, v35
    buffer_store_dwordx2 v[20:21], v19, s[16:19], 0 offen offset:0
    s_nop 1
    v_cvt_pk_bf16_f32 v20, v108, v109
    v_cvt_pk_bf16_f32 v21, v110, v111
    v_lshlrev_b32 v22, 16, v20
    v_and_b32 v23, 0xffff0000, v20
    v_lshlrev_b32 v24, 16, v21
    v_and_b32 v25, 0xffff0000, v21
    s_mov_b32 s6, 0xbdd2d3e8
    s_mov_b32 s7, 0xc0135761
    v_mul_f32 v32, v22, v22
    v_mul_f32 v33, v23, v23
    v_mul_f32 v34, v24, v24
    v_mul_f32 v35, v25, v25
    v_mov_b32 v26, s7
    v_fma_f32 v32, v32, s6, v26
    v_mov_b32 v26, s7
    v_fma_f32 v33, v33, s6, v26
    v_mov_b32 v26, s7
    v_fma_f32 v34, v34, s6, v26
    v_mov_b32 v26, s7
    v_fma_f32 v35, v35, s6, v26
    v_mul_f32 v32, v32, v22
    v_mul_f32 v33, v33, v23
    v_mul_f32 v34, v34, v24
    v_mul_f32 v35, v35, v25
    v_exp_f32 v32, v32
    v_exp_f32 v33, v33
    v_exp_f32 v34, v34
    v_exp_f32 v35, v35
    s_nop 0
    v_add_f32 v32, 1.0, v32
    v_add_f32 v33, 1.0, v33
    v_add_f32 v34, 1.0, v34
    v_add_f32 v35, 1.0, v35
    v_rcp_f32 v32, v32
    v_rcp_f32 v33, v33
    v_rcp_f32 v34, v34
    v_rcp_f32 v35, v35
    s_nop 0
    v_mul_f32 v32, v32, v22
    v_mul_f32 v33, v33, v23
    v_mul_f32 v34, v34, v24
    v_mul_f32 v35, v35, v25
    v_cvt_pk_bf16_f32 v20, v32, v33
    v_cvt_pk_bf16_f32 v21, v34, v35
    buffer_store_dwordx2 v[20:21], v19, s[16:19], 0 offen offset:32
    s_nop 1
    v_cvt_pk_bf16_f32 v20, v112, v113
    v_cvt_pk_bf16_f32 v21, v114, v115
    v_lshlrev_b32 v22, 16, v20
    v_and_b32 v23, 0xffff0000, v20
    v_lshlrev_b32 v24, 16, v21
    v_and_b32 v25, 0xffff0000, v21
    s_mov_b32 s6, 0xbdd2d3e8
    s_mov_b32 s7, 0xc0135761
    v_mul_f32 v32, v22, v22
    v_mul_f32 v33, v23, v23
    v_mul_f32 v34, v24, v24
    v_mul_f32 v35, v25, v25
    v_mov_b32 v26, s7
    v_fma_f32 v32, v32, s6, v26
    v_mov_b32 v26, s7
    v_fma_f32 v33, v33, s6, v26
    v_mov_b32 v26, s7
    v_fma_f32 v34, v34, s6, v26
    v_mov_b32 v26, s7
    v_fma_f32 v35, v35, s6, v26
    v_mul_f32 v32, v32, v22
    v_mul_f32 v33, v33, v23
    v_mul_f32 v34, v34, v24
    v_mul_f32 v35, v35, v25
    v_exp_f32 v32, v32
    v_exp_f32 v33, v33
    v_exp_f32 v34, v34
    v_exp_f32 v35, v35
    s_nop 0
    v_add_f32 v32, 1.0, v32
    v_add_f32 v33, 1.0, v33
    v_add_f32 v34, 1.0, v34
    v_add_f32 v35, 1.0, v35
    v_rcp_f32 v32, v32
    v_rcp_f32 v33, v33
    v_rcp_f32 v34, v34
    v_rcp_f32 v35, v35
    s_nop 0
    v_mul_f32 v32, v32, v22
    v_mul_f32 v33, v33, v23
    v_mul_f32 v34, v34, v24
    v_mul_f32 v35, v35, v25
    v_cvt_pk_bf16_f32 v20, v32, v33
    v_cvt_pk_bf16_f32 v21, v34, v35
    buffer_store_dwordx2 v[20:21], v19, s[16:19], 0 offen offset:64
    s_nop 1
    v_add_u32 v19, 147456, v19
    v_cvt_pk_bf16_f32 v20, v116, v117
    v_cvt_pk_bf16_f32 v21, v118, v119
    v_lshlrev_b32 v22, 16, v20
    v_and_b32 v23, 0xffff0000, v20
    v_lshlrev_b32 v24, 16, v21
    v_and_b32 v25, 0xffff0000, v21
    s_mov_b32 s6, 0xbdd2d3e8
    s_mov_b32 s7, 0xc0135761
    v_mul_f32 v32, v22, v22
    v_mul_f32 v33, v23, v23
    v_mul_f32 v34, v24, v24
    v_mul_f32 v35, v25, v25
    v_mov_b32 v26, s7
    v_fma_f32 v32, v32, s6, v26
    v_mov_b32 v26, s7
    v_fma_f32 v33, v33, s6, v26
    v_mov_b32 v26, s7
    v_fma_f32 v34, v34, s6, v26
    v_mov_b32 v26, s7
    v_fma_f32 v35, v35, s6, v26
    v_mul_f32 v32, v32, v22
    v_mul_f32 v33, v33, v23
    v_mul_f32 v34, v34, v24
    v_mul_f32 v35, v35, v25
    v_exp_f32 v32, v32
    v_exp_f32 v33, v33
    v_exp_f32 v34, v34
    v_exp_f32 v35, v35
    s_nop 0
    v_add_f32 v32, 1.0, v32
    v_add_f32 v33, 1.0, v33
    v_add_f32 v34, 1.0, v34
    v_add_f32 v35, 1.0, v35
    v_rcp_f32 v32, v32
    v_rcp_f32 v33, v33
    v_rcp_f32 v34, v34
    v_rcp_f32 v35, v35
    s_nop 0
    v_mul_f32 v32, v32, v22
    v_mul_f32 v33, v33, v23
    v_mul_f32 v34, v34, v24
    v_mul_f32 v35, v35, v25
    v_cvt_pk_bf16_f32 v20, v32, v33
    v_cvt_pk_bf16_f32 v21, v34, v35
    buffer_store_dwordx2 v[20:21], v19, s[16:19], 0 offen offset:0
    s_nop 1
    v_cvt_pk_bf16_f32 v20, v120, v121
    v_cvt_pk_bf16_f32 v21, v122, v123
    v_lshlrev_b32 v22, 16, v20
    v_and_b32 v23, 0xffff0000, v20
    v_lshlrev_b32 v24, 16, v21
    v_and_b32 v25, 0xffff0000, v21
    s_mov_b32 s6, 0xbdd2d3e8
    s_mov_b32 s7, 0xc0135761
    v_mul_f32 v32, v22, v22
    v_mul_f32 v33, v23, v23
    v_mul_f32 v34, v24, v24
    v_mul_f32 v35, v25, v25
    v_mov_b32 v26, s7
    v_fma_f32 v32, v32, s6, v26
    v_mov_b32 v26, s7
    v_fma_f32 v33, v33, s6, v26
    v_mov_b32 v26, s7
    v_fma_f32 v34, v34, s6, v26
    v_mov_b32 v26, s7
    v_fma_f32 v35, v35, s6, v26
    v_mul_f32 v32, v32, v22
    v_mul_f32 v33, v33, v23
    v_mul_f32 v34, v34, v24
    v_mul_f32 v35, v35, v25
    v_exp_f32 v32, v32
    v_exp_f32 v33, v33
    v_exp_f32 v34, v34
    v_exp_f32 v35, v35
    s_nop 0
    v_add_f32 v32, 1.0, v32
    v_add_f32 v33, 1.0, v33
    v_add_f32 v34, 1.0, v34
    v_add_f32 v35, 1.0, v35
    v_rcp_f32 v32, v32
    v_rcp_f32 v33, v33
    v_rcp_f32 v34, v34
    v_rcp_f32 v35, v35
    s_nop 0
    v_mul_f32 v32, v32, v22
    v_mul_f32 v33, v33, v23
    v_mul_f32 v34, v34, v24
    v_mul_f32 v35, v35, v25
    v_cvt_pk_bf16_f32 v20, v32, v33
    v_cvt_pk_bf16_f32 v21, v34, v35
    buffer_store_dwordx2 v[20:21], v19, s[16:19], 0 offen offset:32
    s_nop 1
    v_cvt_pk_bf16_f32 v20, v124, v125
    v_cvt_pk_bf16_f32 v21, v126, v127
    v_lshlrev_b32 v22, 16, v20
    v_and_b32 v23, 0xffff0000, v20
    v_lshlrev_b32 v24, 16, v21
    v_and_b32 v25, 0xffff0000, v21
    s_mov_b32 s6, 0xbdd2d3e8
    s_mov_b32 s7, 0xc0135761
    v_mul_f32 v32, v22, v22
    v_mul_f32 v33, v23, v23
    v_mul_f32 v34, v24, v24
    v_mul_f32 v35, v25, v25
    v_mov_b32 v26, s7
    v_fma_f32 v32, v32, s6, v26
    v_mov_b32 v26, s7
    v_fma_f32 v33, v33, s6, v26
    v_mov_b32 v26, s7
    v_fma_f32 v34, v34, s6, v26
    v_mov_b32 v26, s7
    v_fma_f32 v35, v35, s6, v26
    v_mul_f32 v32, v32, v22
    v_mul_f32 v33, v33, v23
    v_mul_f32 v34, v34, v24
    v_mul_f32 v35, v35, v25
    v_exp_f32 v32, v32
    v_exp_f32 v33, v33
    v_exp_f32 v34, v34
    v_exp_f32 v35, v35
    s_nop 0
    v_add_f32 v32, 1.0, v32
    v_add_f32 v33, 1.0, v33
    v_add_f32 v34, 1.0, v34
    v_add_f32 v35, 1.0, v35
    v_rcp_f32 v32, v32
    v_rcp_f32 v33, v33
    v_rcp_f32 v34, v34
    v_rcp_f32 v35, v35
    s_nop 0
    v_mul_f32 v32, v32, v22
    v_mul_f32 v33, v33, v23
    v_mul_f32 v34, v34, v24
    v_mul_f32 v35, v35, v25
    v_cvt_pk_bf16_f32 v20, v32, v33
    v_cvt_pk_bf16_f32 v21, v34, v35
    buffer_store_dwordx2 v[20:21], v19, s[16:19], 0 offen offset:64
    s_nop 1
    v_add_u32 v19, 147456, v19
    v_cvt_pk_bf16_f32 v20, v128, v129
    v_cvt_pk_bf16_f32 v21, v130, v131
    v_lshlrev_b32 v22, 16, v20
    v_and_b32 v23, 0xffff0000, v20
    v_lshlrev_b32 v24, 16, v21
    v_and_b32 v25, 0xffff0000, v21
    s_mov_b32 s6, 0xbdd2d3e8
    s_mov_b32 s7, 0xc0135761
    v_mul_f32 v32, v22, v22
    v_mul_f32 v33, v23, v23
    v_mul_f32 v34, v24, v24
    v_mul_f32 v35, v25, v25
    v_mov_b32 v26, s7
    v_fma_f32 v32, v32, s6, v26
    v_mov_b32 v26, s7
    v_fma_f32 v33, v33, s6, v26
    v_mov_b32 v26, s7
    v_fma_f32 v34, v34, s6, v26
    v_mov_b32 v26, s7
    v_fma_f32 v35, v35, s6, v26
    v_mul_f32 v32, v32, v22
    v_mul_f32 v33, v33, v23
    v_mul_f32 v34, v34, v24
    v_mul_f32 v35, v35, v25
    v_exp_f32 v32, v32
    v_exp_f32 v33, v33
    v_exp_f32 v34, v34
    v_exp_f32 v35, v35
    s_nop 0
    v_add_f32 v32, 1.0, v32
    v_add_f32 v33, 1.0, v33
    v_add_f32 v34, 1.0, v34
    v_add_f32 v35, 1.0, v35
    v_rcp_f32 v32, v32
    v_rcp_f32 v33, v33
    v_rcp_f32 v34, v34
    v_rcp_f32 v35, v35
    s_nop 0
    v_mul_f32 v32, v32, v22
    v_mul_f32 v33, v33, v23
    v_mul_f32 v34, v34, v24
    v_mul_f32 v35, v35, v25
    v_cvt_pk_bf16_f32 v20, v32, v33
    v_cvt_pk_bf16_f32 v21, v34, v35
    buffer_store_dwordx2 v[20:21], v19, s[16:19], 0 offen offset:0
    s_nop 1
    v_cvt_pk_bf16_f32 v20, v132, v133
    v_cvt_pk_bf16_f32 v21, v134, v135
    v_lshlrev_b32 v22, 16, v20
    v_and_b32 v23, 0xffff0000, v20
    v_lshlrev_b32 v24, 16, v21
    v_and_b32 v25, 0xffff0000, v21
    s_mov_b32 s6, 0xbdd2d3e8
    s_mov_b32 s7, 0xc0135761
    v_mul_f32 v32, v22, v22
    v_mul_f32 v33, v23, v23
    v_mul_f32 v34, v24, v24
    v_mul_f32 v35, v25, v25
    v_mov_b32 v26, s7
    v_fma_f32 v32, v32, s6, v26
    v_mov_b32 v26, s7
    v_fma_f32 v33, v33, s6, v26
    v_mov_b32 v26, s7
    v_fma_f32 v34, v34, s6, v26
    v_mov_b32 v26, s7
    v_fma_f32 v35, v35, s6, v26
    v_mul_f32 v32, v32, v22
    v_mul_f32 v33, v33, v23
    v_mul_f32 v34, v34, v24
    v_mul_f32 v35, v35, v25
    v_exp_f32 v32, v32
    v_exp_f32 v33, v33
    v_exp_f32 v34, v34
    v_exp_f32 v35, v35
    s_nop 0
    v_add_f32 v32, 1.0, v32
    v_add_f32 v33, 1.0, v33
    v_add_f32 v34, 1.0, v34
    v_add_f32 v35, 1.0, v35
    v_rcp_f32 v32, v32
    v_rcp_f32 v33, v33
    v_rcp_f32 v34, v34
    v_rcp_f32 v35, v35
    s_nop 0
    v_mul_f32 v32, v32, v22
    v_mul_f32 v33, v33, v23
    v_mul_f32 v34, v34, v24
    v_mul_f32 v35, v35, v25
    v_cvt_pk_bf16_f32 v20, v32, v33
    v_cvt_pk_bf16_f32 v21, v34, v35
    buffer_store_dwordx2 v[20:21], v19, s[16:19], 0 offen offset:32
    s_nop 1
    v_cvt_pk_bf16_f32 v20, v136, v137
    v_cvt_pk_bf16_f32 v21, v138, v139
    v_lshlrev_b32 v22, 16, v20
    v_and_b32 v23, 0xffff0000, v20
    v_lshlrev_b32 v24, 16, v21
    v_and_b32 v25, 0xffff0000, v21
    s_mov_b32 s6, 0xbdd2d3e8
    s_mov_b32 s7, 0xc0135761
    v_mul_f32 v32, v22, v22
    v_mul_f32 v33, v23, v23
    v_mul_f32 v34, v24, v24
    v_mul_f32 v35, v25, v25
    v_mov_b32 v26, s7
    v_fma_f32 v32, v32, s6, v26
    v_mov_b32 v26, s7
    v_fma_f32 v33, v33, s6, v26
    v_mov_b32 v26, s7
    v_fma_f32 v34, v34, s6, v26
    v_mov_b32 v26, s7
    v_fma_f32 v35, v35, s6, v26
    v_mul_f32 v32, v32, v22
    v_mul_f32 v33, v33, v23
    v_mul_f32 v34, v34, v24
    v_mul_f32 v35, v35, v25
    v_exp_f32 v32, v32
    v_exp_f32 v33, v33
    v_exp_f32 v34, v34
    v_exp_f32 v35, v35
    s_nop 0
    v_add_f32 v32, 1.0, v32
    v_add_f32 v33, 1.0, v33
    v_add_f32 v34, 1.0, v34
    v_add_f32 v35, 1.0, v35
    v_rcp_f32 v32, v32
    v_rcp_f32 v33, v33
    v_rcp_f32 v34, v34
    v_rcp_f32 v35, v35
    s_nop 0
    v_mul_f32 v32, v32, v22
    v_mul_f32 v33, v33, v23
    v_mul_f32 v34, v34, v24
    v_mul_f32 v35, v35, v25
    v_cvt_pk_bf16_f32 v20, v32, v33
    v_cvt_pk_bf16_f32 v21, v34, v35
    buffer_store_dwordx2 v[20:21], v19, s[16:19], 0 offen offset:64
    s_nop 1
    v_add_u32 v19, 147456, v19
    v_cvt_pk_bf16_f32 v20, v140, v141
    v_cvt_pk_bf16_f32 v21, v142, v143
    v_lshlrev_b32 v22, 16, v20
    v_and_b32 v23, 0xffff0000, v20
    v_lshlrev_b32 v24, 16, v21
    v_and_b32 v25, 0xffff0000, v21
    s_mov_b32 s6, 0xbdd2d3e8
    s_mov_b32 s7, 0xc0135761
    v_mul_f32 v32, v22, v22
    v_mul_f32 v33, v23, v23
    v_mul_f32 v34, v24, v24
    v_mul_f32 v35, v25, v25
    v_mov_b32 v26, s7
    v_fma_f32 v32, v32, s6, v26
    v_mov_b32 v26, s7
    v_fma_f32 v33, v33, s6, v26
    v_mov_b32 v26, s7
    v_fma_f32 v34, v34, s6, v26
    v_mov_b32 v26, s7
    v_fma_f32 v35, v35, s6, v26
    v_mul_f32 v32, v32, v22
    v_mul_f32 v33, v33, v23
    v_mul_f32 v34, v34, v24
    v_mul_f32 v35, v35, v25
    v_exp_f32 v32, v32
    v_exp_f32 v33, v33
    v_exp_f32 v34, v34
    v_exp_f32 v35, v35
    s_nop 0
    v_add_f32 v32, 1.0, v32
    v_add_f32 v33, 1.0, v33
    v_add_f32 v34, 1.0, v34
    v_add_f32 v35, 1.0, v35
    v_rcp_f32 v32, v32
    v_rcp_f32 v33, v33
    v_rcp_f32 v34, v34
    v_rcp_f32 v35, v35
    s_nop 0
    v_mul_f32 v32, v32, v22
    v_mul_f32 v33, v33, v23
    v_mul_f32 v34, v34, v24
    v_mul_f32 v35, v35, v25
    v_cvt_pk_bf16_f32 v20, v32, v33
    v_cvt_pk_bf16_f32 v21, v34, v35
    buffer_store_dwordx2 v[20:21], v19, s[16:19], 0 offen offset:0
    s_nop 1
    v_cvt_pk_bf16_f32 v20, v144, v145
    v_cvt_pk_bf16_f32 v21, v146, v147
    v_lshlrev_b32 v22, 16, v20
    v_and_b32 v23, 0xffff0000, v20
    v_lshlrev_b32 v24, 16, v21
    v_and_b32 v25, 0xffff0000, v21
    s_mov_b32 s6, 0xbdd2d3e8
    s_mov_b32 s7, 0xc0135761
    v_mul_f32 v32, v22, v22
    v_mul_f32 v33, v23, v23
    v_mul_f32 v34, v24, v24
    v_mul_f32 v35, v25, v25
    v_mov_b32 v26, s7
    v_fma_f32 v32, v32, s6, v26
    v_mov_b32 v26, s7
    v_fma_f32 v33, v33, s6, v26
    v_mov_b32 v26, s7
    v_fma_f32 v34, v34, s6, v26
    v_mov_b32 v26, s7
    v_fma_f32 v35, v35, s6, v26
    v_mul_f32 v32, v32, v22
    v_mul_f32 v33, v33, v23
    v_mul_f32 v34, v34, v24
    v_mul_f32 v35, v35, v25
    v_exp_f32 v32, v32
    v_exp_f32 v33, v33
    v_exp_f32 v34, v34
    v_exp_f32 v35, v35
    s_nop 0
    v_add_f32 v32, 1.0, v32
    v_add_f32 v33, 1.0, v33
    v_add_f32 v34, 1.0, v34
    v_add_f32 v35, 1.0, v35
    v_rcp_f32 v32, v32
    v_rcp_f32 v33, v33
    v_rcp_f32 v34, v34
    v_rcp_f32 v35, v35
    s_nop 0
    v_mul_f32 v32, v32, v22
    v_mul_f32 v33, v33, v23
    v_mul_f32 v34, v34, v24
    v_mul_f32 v35, v35, v25
    v_cvt_pk_bf16_f32 v20, v32, v33
    v_cvt_pk_bf16_f32 v21, v34, v35
    buffer_store_dwordx2 v[20:21], v19, s[16:19], 0 offen offset:32
    s_nop 1
    v_cvt_pk_bf16_f32 v20, v148, v149
    v_cvt_pk_bf16_f32 v21, v150, v151
    v_lshlrev_b32 v22, 16, v20
    v_and_b32 v23, 0xffff0000, v20
    v_lshlrev_b32 v24, 16, v21
    v_and_b32 v25, 0xffff0000, v21
    s_mov_b32 s6, 0xbdd2d3e8
    s_mov_b32 s7, 0xc0135761
    v_mul_f32 v32, v22, v22
    v_mul_f32 v33, v23, v23
    v_mul_f32 v34, v24, v24
    v_mul_f32 v35, v25, v25
    v_mov_b32 v26, s7
    v_fma_f32 v32, v32, s6, v26
    v_mov_b32 v26, s7
    v_fma_f32 v33, v33, s6, v26
    v_mov_b32 v26, s7
    v_fma_f32 v34, v34, s6, v26
    v_mov_b32 v26, s7
    v_fma_f32 v35, v35, s6, v26
    v_mul_f32 v32, v32, v22
    v_mul_f32 v33, v33, v23
    v_mul_f32 v34, v34, v24
    v_mul_f32 v35, v35, v25
    v_exp_f32 v32, v32
    v_exp_f32 v33, v33
    v_exp_f32 v34, v34
    v_exp_f32 v35, v35
    s_nop 0
    v_add_f32 v32, 1.0, v32
    v_add_f32 v33, 1.0, v33
    v_add_f32 v34, 1.0, v34
    v_add_f32 v35, 1.0, v35
    v_rcp_f32 v32, v32
    v_rcp_f32 v33, v33
    v_rcp_f32 v34, v34
    v_rcp_f32 v35, v35
    s_nop 0
    v_mul_f32 v32, v32, v22
    v_mul_f32 v33, v33, v23
    v_mul_f32 v34, v34, v24
    v_mul_f32 v35, v35, v25
    v_cvt_pk_bf16_f32 v20, v32, v33
    v_cvt_pk_bf16_f32 v21, v34, v35
    buffer_store_dwordx2 v[20:21], v19, s[16:19], 0 offen offset:64
    s_nop 1
    s_waitcnt vmcnt(0)
k_w3_kernel_end:
    s_endpgm
.section .rodata,"a"
.p2align 6
.amdhsa_kernel k_w3_kernel
  .amdhsa_next_free_vgpr 152
  .amdhsa_next_free_sgpr 80
  .amdhsa_accum_offset 152
  .amdhsa_group_segment_fixed_size 0
  .amdhsa_kernarg_size 88
  .amdhsa_user_sgpr_count 2
  .amdhsa_user_sgpr_kernarg_segment_ptr 1
  .amdhsa_system_sgpr_workgroup_id_x 1
.end_amdhsa_kernel
.text
.globl k_w4_kernel
.p2align 8
.type k_w4_kernel,@function
k_w4_kernel:
    s_cmp_ge_u32 s2, 384
    s_cbranch_scc1 k_w4_kernel_end
    s_load_dwordx2 s[36:37], s[0:1], 80
    s_load_dwordx2 s[38:39], s[0:1], 56
    s_and_b32 s3, s2, 3
    s_lshr_b32 s6, s2, 2
    s_mul_i32 s4, s6, 171
    s_lshr_b32 s4, s4, 10
    s_mul_i32 s5, s4, 6
    s_sub_u32 s5, s6, s5
    s_waitcnt lgkmcnt(0)
    s_add_u32 s8, s36, 18874368
    s_addc_u32 s9, s37, 0
    s_mov_b32 s10, 18874368
    s_mov_b32 s11, 0x00020000
    s_mov_b32 s12, s38
    s_mov_b32 s13, s39
    s_mov_b32 s14, 5308416
    s_mov_b32 s15, 0x00020000
    s_add_u32 s16, s36, 37748736
    s_addc_u32 s17, s37, 0
    s_mov_b32 s18, 18874368
    s_mov_b32 s19, 0x00020000
    s_mul_i32 s32, s4, 128
    s_mul_i32 s33, s5, 96
    s_mul_i32 s34, s3, 2304
    s_mul_i32 s35, s3, 1327104
    v_and_b32 v5, 63, v0
    v_lshrrev_b32 v1, 3, v0
    v_and_b32 v2, 7, v0
    v_lshlrev_b32 v2, 4, v2
    v_mul_u32_u24 v10, 160, v1
    v_add_u32 v10, v10, v2
    v_add_u32 v3, s32, v1
    v_mul_u32_u24 v3, 9216, v3
    v_add_u32 v6, v3, v2
    v_add_u32 v7, 294912, v6
    v_add_u32 v8, 589824, v6
    v_add_u32 v9, 884736, v6
    v_add_u32 v1, 0, v0
    v_mul_u32_u24 v2, 683, v1
    v_lshrrev_b32 v2, 13, v2
    v_mul_u32_u24 v3, 12, v2
    v_sub_u32 v3, v1, v3
    v_lshlrev_b32 v3, 4, v3
    v_mul_u32_u24 v14, 224, v2
    v_add_u32 v14, v14, v3
    v_mul_u32_u24 v11, 1152, v2
    v_add_u32 v11, v11, v3
    v_mov_b32 v4, s33
    v_lshlrev_b32 v4, 1, v4
    v_add_u32 v11, v11, v4
    v_add_u32 v1, 256, v0
    v_mul_u32_u24 v2, 683, v1
    v_lshrrev_b32 v2, 13, v2
    v_mul_u32_u24 v3, 12, v2
    v_sub_u32 v3, v1, v3
    v_lshlrev_b32 v3, 4, v3
    v_mul_u32_u24 v15, 224, v2
    v_add_u32 v15, v15, v3
    v_mul_u32_u24 v12, 1152, v2
    v_add_u32 v12, v12, v3
    v_mov_b32 v4, s33
    v_lshlrev_b32 v4, 1, v4
    v_add_u32 v12, v12, v4
    v_add_u32 v1, 512, v0
    v_mul_u32_u24 v2, 683, v1
    v_lshrrev_b32 v2, 13, v2
    v_mul_u32_u24 v3, 12, v2
    v_sub_u32 v3, v1, v3
    v_lshlrev_b32 v3, 4, v3
    v_mul_u32_u24 v16, 224, v2
    v_add_u32 v16, v16, v3
    v_mul_u32_u24 v13, 1152, v2
    v_add_u32 v13, v13, v3
    v_mov_b32 v4, s33
    v_lshlrev_b32 v4, 1, v4
    v_add_u32 v13, v13, v4
    v_lshrrev_b32 v1, 7, v0
    v_mul_u32_u24 v1, 64, v1
    v_and_b32 v2, 15, v0
    v_add_u32 v1, v1, v2
    v_mul_u32_u24 v17, 160, v1
    v_lshrrev_b32 v2, 4, v5
    v_lshlrev_b32 v3, 4, v2
    v_add_u32 v17, v17, v3
    v_add_u32 v1, s32, v1
    v_mul_u32_u24 v19, 2304, v1
    v_lshrrev_b32 v4, 6, v0
    v_and_b32 v4, 1, v4
    v_mul_u32_u24 v4, 48, v4
    v_lshlrev_b32 v3, 2, v2
    v_add_u32 v3, v3, v4
    v_add_u32 v3, s33, v3
    v_mul_u32_u24 v3, 4, v3
    v_add_u32 v19, v19, v3
    s_mul_i32 s6, s3, 4718592
    v_add_u32 v19, s6, v19
    v_and_b32 v1, 15, v0
    v_lshrrev_b32 v1, 2, v1
    v_lshlrev_b32 v3, 3, v2
    v_add_u32 v1, v1, v3
    v_mul_u32_u24 v18, 224, v1
    v_and_b32 v1, 3, v0
    v_lshlrev_b32 v1, 3, v1
    v_add_u32 v18, v18, v1
    v_lshlrev_b32 v4, 1, v4
    v_add_u32 v18, v18, v4
    v_mov_b32 v104, 0
    v_mov_b32 v105, 0
    v_mov_b32 v106, 0
    v_mov_b32 v107, 0
    v_mov_b32 v108, 0
    v_mov_b32 v109, 0
    v_mov_b32 v110, 0
    v_mov_b32 v111, 0
    v_mov_b32 v112, 0
    v_mov_b32 v113, 0
    v_mov_b32 v114, 0
    v_mov_b32 v115, 0
    v_mov_b32 v116, 0
    v_mov_b32 v117, 0
    v_mov_b32 v118, 0
    v_mov_b32 v119, 0
    v_mov_b32 v120, 0
    v_mov_b32 v121, 0
    v_mov_b32 v122, 0
    v_mov_b32 v123, 0
    v_mov_b32 v124, 0
    v_mov_b32 v125, 0
    v_mov_b32 v126, 0
    v_mov_b32 v127, 0
    v_mov_b32 v128, 0
    v_mov_b32 v129, 0
    v_mov_b32 v130, 0
    v_mov_b32 v131, 0
    v_mov_b32 v132, 0
    v_mov_b32 v133, 0
    v_mov_b32 v134, 0
    v_mov_b32 v135, 0
    v_mov_b32 v136, 0
    v_mov_b32 v137, 0
    v_mov_b32 v138, 0
    v_mov_b32 v139, 0
    v_mov_b32 v140, 0
    v_mov_b32 v141, 0
    v_mov_b32 v142, 0
    v_mov_b32 v143, 0
    v_mov_b32 v144, 0
    v_mov_b32 v145, 0
    v_mov_b32 v146, 0
    v_mov_b32 v147, 0
    v_mov_b32 v148, 0
    v_mov_b32 v149, 0
    v_mov_b32 v150, 0
    v_mov_b32 v151, 0
    buffer_load_dwordx4 v[20:23], v6, s[8:11], s34 offen
    buffer_load_dwordx4 v[24:27], v7, s[8:11], s34 offen
    buffer_load_dwordx4 v[28:31], v8, s[8:11], s34 offen
    buffer_load_dwordx4 v[32:35], v9, s[8:11], s34 offen
    buffer_load_dwordx4 v[36:39], v11, s[12:15], s35 offen
    buffer_load_dwordx4 v[40:43], v12, s[12:15], s35 offen
    buffer_load_dwordx4 v[44:47], v13, s[12:15], s35 offen
    s_add_u32 s34, s34, 128
    s_add_u32 s35, s35, 73728
    s_waitcnt vmcnt(0)
    ds_write_b128 v10, v[20:23] offset:0
    ds_write_b128 v10, v[24:27] offset:5120
    ds_write_b128 v10, v[28:31] offset:10240
    ds_write_b128 v10, v[32:35] offset:15360
    ds_write_b128 v14, v[36:39] offset:20480
    ds_write_b128 v15, v[40:43] offset:20480
    ds_write_b128 v16, v[44:47] offset:20480
    v_add_u32 v10, 34816, v10
    v_add_u32 v14, 34816, v14
    v_add_u32 v15, 34816, v15
    v_add_u32 v16, 34816, v16
    buffer_load_dwordx4 v[20:23], v6, s[8:11], s34 offen
    buffer_load_dwordx4 v[24:27], v7, s[8:11], s34 offen
    buffer_load_dwordx4 v[28:31], v8, s[8:11], s34 offen
    buffer_load_dwordx4 v[32:35], v9, s[8:11], s34 offen
    buffer_load_dwordx4 v[36:39], v11, s[12:15], s35 offen
    buffer_load_dwordx4 v[40:43], v12, s[12:15], s35 offen
    buffer_load_dwordx4 v[44:47], v13, s[12:15], s35 offen
    s_add_u32 s34, s34, 128
    s_add_u32 s35, s35, 73728
    s_waitcnt lgkmcnt(0)
    s_barrier
    ds_read_b128 v[48:51], v17 offset:0
    ds_read_b128 v[52:55], v17 offset:2560
    ds_read_b128 v[56:59], v17 offset:5120
    ds_read_b128 v[60:63], v17 offset:7680
    ds_read_b64_tr_b16 v[80:81], v18 offset:20480
    ds_read_b64_tr_b16 v[82:83], v18 offset:21376
    ds_read_b64_tr_b16 v[84:85], v18 offset:20512
    ds_read_b64_tr_b16 v[86:87], v18 offset:21408
    ds_read_b64_tr_b16 v[88:89], v18 offset:20544
    ds_read_b64_tr_b16 v[90:91], v18 offset:21440
    s_waitcnt lgkmcnt(0)
    v_mfma_f32_16x16x32_bf16 v[104:107], v[80:83], v[48:51], v[104:107]
    ds_read_b128 v[64:67], v17 offset:64
    v_mfma_f32_16x16x32_bf16 v[108:111], v[84:87], v[48:51], v[108:111]
    ds_read_b128 v[68:71], v17 offset:2624
    v_mfma_f32_16x16x32_bf16 v[112:115], v[88:91], v[48:51], v[112:115]
    ds_read_b128 v[72:75], v17 offset:5184
    v_mfma_f32_16x16x32_bf16 v[116:119], v[80:83], v[52:55], v[116:119]
    ds_read_b128 v[76:79], v17 offset:7744
    v_mfma_f32_16x16x32_bf16 v[120:123], v[84:87], v[52:55], v[120:123]
    ds_read_b64_tr_b16 v[92:93], v18 offset:27648
    v_mfma_f32_16x16x32_bf16 v[124:127], v[88:91], v[52:55], v[124:127]
    ds_read_b64_tr_b16 v[94:95], v18 offset:28544
    v_mfma_f32_16x16x32_bf16 v[128:131], v[80:83], v[56:59], v[128:131]
    ds_read_b64_tr_b16 v[96:97], v18 offset:27680
    v_mfma_f32_16x16x32_bf16 v[132:135], v[84:87], v[56:59], v[132:135]
    ds_read_b64_tr_b16 v[98:99], v18 offset:28576
    v_mfma_f32_16x16x32_bf16 v[136:139], v[88:91], v[56:59], v[136:139]
    ds_read_b64_tr_b16 v[100:101], v18 offset:27712
    v_mfma_f32_16x16x32_bf16 v[140:143], v[80:83], v[60:63], v[140:143]
    ds_read_b64_tr_b16 v[102:103], v18 offset:28608
    v_mfma_f32_16x16x32_bf16 v[144:147], v[84:87], v[60:63], v[144:147]
    v_mfma_f32_16x16x32_bf16 v[148:151], v[88:91], v[60:63], v[148:151]
    s_waitcnt lgkmcnt(0)
    v_mfma_f32_16x16x32_bf16 v[104:107], v[92:95], v[64:67], v[104:107]
    s_waitcnt vmcnt(0)
    ds_write_b128 v10, v[20:23] offset:0
    v_mfma_f32_16x16x32_bf16 v[108:111], v[96:99], v[64:67], v[108:111]
    ds_write_b128 v10, v[24:27] offset:5120
    ds_write_b128 v10, v[28:31] offset:10240
    v_mfma_f32_16x16x32_bf16 v[112:115], v[100:103], v[64:67], v[112:115]
    ds_write_b128 v10, v[32:35] offset:15360
    ds_write_b128 v14, v[36:39] offset:20480
    v_mfma_f32_16x16x32_bf16 v[116:119], v[92:95], v[68:71], v[116:119]
    ds_write_b128 v15, v[40:43] offset:20480
    ds_write_b128 v16, v[44:47] offset:20480
    v_mfma_f32_16x16x32_bf16 v[120:123], v[96:99], v[68:71], v[120:123]
    v_add_u32 v10, 4294932480, v10
    v_add_u32 v14, 4294932480, v14
    v_mfma_f32_16x16x32_bf16 v[124:127], v[100:103], v[68:71], v[124:127]
    v_add_u32 v15, 4294932480, v15
    v_add_u32 v16, 4294932480, v16
    v_mfma_f32_16x16x32_bf16 v[128:131], v[92:95], v[72:75], v[128:131]
    buffer_load_dwordx4 v[20:23], v6, s[8:11], s34 offen
    buffer_load_dwordx4 v[24:27], v7, s[8:11], s34 offen
    v_mfma_f32_16x16x32_bf16 v[132:135], v[96:99], v[72:75], v[132:135]
    buffer_load_dwordx4 v[28:31], v8, s[8:11], s34 offen
    buffer_load_dwordx4 v[32:35], v9, s[8:11], s34 offen
    v_mfma_f32_16x16x32_bf16 v[136:139], v[100:103], v[72:75], v[136:139]
    buffer_load_dwordx4 v[36:39], v11, s[12:15], s35 offen
    buffer_load_dwordx4 v[40:43], v12, s[12:15], s35 offen
    v_mfma_f32_16x16x32_bf16 v[140:143], v[92:95], v[76:79], v[140:143]
    buffer_load_dwordx4 v[44:47], v13, s[12:15], s35 offen
    s_add_u32 s34, s34, 128
    v_mfma_f32_16x16x32_bf16 v[144:147], v[96:99], v[76:79], v[144:147]
    s_add_u32 s35, s35, 73728
    v_mfma_f32_16x16x32_bf16 v[148:151], v[100:103], v[76:79], v[148:151]
    v_add_u32 v17, 34816, v17
    v_add_u32 v18, 34816, v18
    s_waitcnt lgkmcnt(0)
    s_barrier
    ds_read_b128 v[48:51], v17 offset:0
    ds_read_b128 v[52:55], v17 offset:2560
    ds_read_b128 v[56:59], v17 offset:5120
    ds_read_b128 v[60:63], v17 offset:7680
    ds_read_b64_tr_b16 v[80:81], v18 offset:20480
    ds_read_b64_tr_b16 v[82:83], v18 offset:21376
    ds_read_b64_tr_b16 v[84:85], v18 offset:20512
    ds_read_b64_tr_b16 v[86:87], v18 offset:21408
    ds_read_b64_tr_b16 v[88:89], v18 offset:20544
    ds_read_b64_tr_b16 v[90:91], v18 offset:21440
    s_waitcnt lgkmcnt(0)
    v_mfma_f32_16x16x32_bf16 v[104:107], v[80:83], v[48:51], v[104:107]
    ds_read_b128 v[64:67], v17 offset:64
    v_mfma_f32_16x16x32_bf16 v[108:111], v[84:87], v[48:51], v[108:111]
    ds_read_b128 v[68:71], v17 offset:2624
    v_mfma_f32_16x16x32_bf16 v[112:115], v[88:91], v[48:51], v[112:115]
    ds_read_b128 v[72:75], v17 offset:5184
    v_mfma_f32_16x16x32_bf16 v[116:119], v[80:83], v[52:55], v[116:119]
    ds_read_b128 v[76:79], v17 offset:7744
    v_mfma_f32_16x16x32_bf16 v[120:123], v[84:87], v[52:55], v[120:123]
    ds_read_b64_tr_b16 v[92:93], v18 offset:27648
    v_mfma_f32_16x16x32_bf16 v[124:127], v[88:91], v[52:55], v[124:127]
    ds_read_b64_tr_b16 v[94:95], v18 offset:28544
    v_mfma_f32_16x16x32_bf16 v[128:131], v[80:83], v[56:59], v[128:131]
    ds_read_b64_tr_b16 v[96:97], v18 offset:27680
    v_mfma_f32_16x16x32_bf16 v[132:135], v[84:87], v[56:59], v[132:135]
    ds_read_b64_tr_b16 v[98:99], v18 offset:28576
    v_mfma_f32_16x16x32_bf16 v[136:139], v[88:91], v[56:59], v[136:139]
    ds_read_b64_tr_b16 v[100:101], v18 offset:27712
    v_mfma_f32_16x16x32_bf16 v[140:143], v[80:83], v[60:63], v[140:143]
    ds_read_b64_tr_b16 v[102:103], v18 offset:28608
    v_mfma_f32_16x16x32_bf16 v[144:147], v[84:87], v[60:63], v[144:147]
    v_mfma_f32_16x16x32_bf16 v[148:151], v[88:91], v[60:63], v[148:151]
    s_waitcnt lgkmcnt(0)
    v_mfma_f32_16x16x32_bf16 v[104:107], v[92:95], v[64:67], v[104:107]
    s_waitcnt vmcnt(0)
    ds_write_b128 v10, v[20:23] offset:0
    v_mfma_f32_16x16x32_bf16 v[108:111], v[96:99], v[64:67], v[108:111]
    ds_write_b128 v10, v[24:27] offset:5120
    ds_write_b128 v10, v[28:31] offset:10240
    v_mfma_f32_16x16x32_bf16 v[112:115], v[100:103], v[64:67], v[112:115]
    ds_write_b128 v10, v[32:35] offset:15360
    ds_write_b128 v14, v[36:39] offset:20480
    v_mfma_f32_16x16x32_bf16 v[116:119], v[92:95], v[68:71], v[116:119]
    ds_write_b128 v15, v[40:43] offset:20480
    ds_write_b128 v16, v[44:47] offset:20480
    v_mfma_f32_16x16x32_bf16 v[120:123], v[96:99], v[68:71], v[120:123]
    v_add_u32 v10, 34816, v10
    v_add_u32 v14, 34816, v14
    v_mfma_f32_16x16x32_bf16 v[124:127], v[100:103], v[68:71], v[124:127]
    v_add_u32 v15, 34816, v15
    v_add_u32 v16, 34816, v16
    v_mfma_f32_16x16x32_bf16 v[128:131], v[92:95], v[72:75], v[128:131]
    buffer_load_dwordx4 v[20:23], v6, s[8:11], s34 offen
    buffer_load_dwordx4 v[24:27], v7, s[8:11], s34 offen
    v_mfma_f32_16x16x32_bf16 v[132:135], v[96:99], v[72:75], v[132:135]
    buffer_load_dwordx4 v[28:31], v8, s[8:11], s34 offen
    buffer_load_dwordx4 v[32:35], v9, s[8:11], s34 offen
    v_mfma_f32_16x16x32_bf16 v[136:139], v[100:103], v[72:75], v[136:139]
    buffer_load_dwordx4 v[36:39], v11, s[12:15], s35 offen
    buffer_load_dwordx4 v[40:43], v12, s[12:15], s35 offen
    v_mfma_f32_16x16x32_bf16 v[140:143], v[92:95], v[76:79], v[140:143]
    buffer_load_dwordx4 v[44:47], v13, s[12:15], s35 offen
    s_add_u32 s34, s34, 128
    v_mfma_f32_16x16x32_bf16 v[144:147], v[96:99], v[76:79], v[144:147]
    s_add_u32 s35, s35, 73728
    v_mfma_f32_16x16x32_bf16 v[148:151], v[100:103], v[76:79], v[148:151]
    v_add_u32 v17, 4294932480, v17
    v_add_u32 v18, 4294932480, v18
    s_waitcnt lgkmcnt(0)
    s_barrier
    ds_read_b128 v[48:51], v17 offset:0
    ds_read_b128 v[52:55], v17 offset:2560
    ds_read_b128 v[56:59], v17 offset:5120
    ds_read_b128 v[60:63], v17 offset:7680
    ds_read_b64_tr_b16 v[80:81], v18 offset:20480
    ds_read_b64_tr_b16 v[82:83], v18 offset:21376
    ds_read_b64_tr_b16 v[84:85], v18 offset:20512
    ds_read_b64_tr_b16 v[86:87], v18 offset:21408
    ds_read_b64_tr_b16 v[88:89], v18 offset:20544
    ds_read_b64_tr_b16 v[90:91], v18 offset:21440
    s_waitcnt lgkmcnt(0)
    v_mfma_f32_16x16x32_bf16 v[104:107], v[80:83], v[48:51], v[104:107]
    ds_read_b128 v[64:67], v17 offset:64
    v_mfma_f32_16x16x32_bf16 v[108:111], v[84:87], v[48:51], v[108:111]
    ds_read_b128 v[68:71], v17 offset:2624
    v_mfma_f32_16x16x32_bf16 v[112:115], v[88:91], v[48:51], v[112:115]
    ds_read_b128 v[72:75], v17 offset:5184
    v_mfma_f32_16x16x32_bf16 v[116:119], v[80:83], v[52:55], v[116:119]
    ds_read_b128 v[76:79], v17 offset:7744
    v_mfma_f32_16x16x32_bf16 v[120:123], v[84:87], v[52:55], v[120:123]
    ds_read_b64_tr_b16 v[92:93], v18 offset:27648
    v_mfma_f32_16x16x32_bf16 v[124:127], v[88:91], v[52:55], v[124:127]
    ds_read_b64_tr_b16 v[94:95], v18 offset:28544
    v_mfma_f32_16x16x32_bf16 v[128:131], v[80:83], v[56:59], v[128:131]
    ds_read_b64_tr_b16 v[96:97], v18 offset:27680
    v_mfma_f32_16x16x32_bf16 v[132:135], v[84:87], v[56:59], v[132:135]
    ds_read_b64_tr_b16 v[98:99], v18 offset:28576
    v_mfma_f32_16x16x32_bf16 v[136:139], v[88:91], v[56:59], v[136:139]
    ds_read_b64_tr_b16 v[100:101], v18 offset:27712
    v_mfma_f32_16x16x32_bf16 v[140:143], v[80:83], v[60:63], v[140:143]
    ds_read_b64_tr_b16 v[102:103], v18 offset:28608
    v_mfma_f32_16x16x32_bf16 v[144:147], v[84:87], v[60:63], v[144:147]
    v_mfma_f32_16x16x32_bf16 v[148:151], v[88:91], v[60:63], v[148:151]
    s_waitcnt lgkmcnt(0)
    v_mfma_f32_16x16x32_bf16 v[104:107], v[92:95], v[64:67], v[104:107]
    s_waitcnt vmcnt(0)
    ds_write_b128 v10, v[20:23] offset:0
    v_mfma_f32_16x16x32_bf16 v[108:111], v[96:99], v[64:67], v[108:111]
    ds_write_b128 v10, v[24:27] offset:5120
    ds_write_b128 v10, v[28:31] offset:10240
    v_mfma_f32_16x16x32_bf16 v[112:115], v[100:103], v[64:67], v[112:115]
    ds_write_b128 v10, v[32:35] offset:15360
    ds_write_b128 v14, v[36:39] offset:20480
    v_mfma_f32_16x16x32_bf16 v[116:119], v[92:95], v[68:71], v[116:119]
    ds_write_b128 v15, v[40:43] offset:20480
    ds_write_b128 v16, v[44:47] offset:20480
    v_mfma_f32_16x16x32_bf16 v[120:123], v[96:99], v[68:71], v[120:123]
    v_add_u32 v10, 4294932480, v10
    v_add_u32 v14, 4294932480, v14
    v_mfma_f32_16x16x32_bf16 v[124:127], v[100:103], v[68:71], v[124:127]
    v_add_u32 v15, 4294932480, v15
    v_add_u32 v16, 4294932480, v16
    v_mfma_f32_16x16x32_bf16 v[128:131], v[92:95], v[72:75], v[128:131]
    buffer_load_dwordx4 v[20:23], v6, s[8:11], s34 offen
    buffer_load_dwordx4 v[24:27], v7, s[8:11], s34 offen
    v_mfma_f32_16x16x32_bf16 v[132:135], v[96:99], v[72:75], v[132:135]
    buffer_load_dwordx4 v[28:31], v8, s[8:11], s34 offen
    buffer_load_dwordx4 v[32:35], v9, s[8:11], s34 offen
    v_mfma_f32_16x16x32_bf16 v[136:139], v[100:103], v[72:75], v[136:139]
    buffer_load_dwordx4 v[36:39], v11, s[12:15], s35 offen
    buffer_load_dwordx4 v[40:43], v12, s[12:15], s35 offen
    v_mfma_f32_16x16x32_bf16 v[140:143], v[92:95], v[76:79], v[140:143]
    buffer_load_dwordx4 v[44:47], v13, s[12:15], s35 offen
    s_add_u32 s34, s34, 128
    v_mfma_f32_16x16x32_bf16 v[144:147], v[96:99], v[76:79], v[144:147]
    s_add_u32 s35, s35, 73728
    v_mfma_f32_16x16x32_bf16 v[148:151], v[100:103], v[76:79], v[148:151]
    v_add_u32 v17, 34816, v17
    v_add_u32 v18, 34816, v18
    s_waitcnt lgkmcnt(0)
    s_barrier
    ds_read_b128 v[48:51], v17 offset:0
    ds_read_b128 v[52:55], v17 offset:2560
    ds_read_b128 v[56:59], v17 offset:5120
    ds_read_b128 v[60:63], v17 offset:7680
    ds_read_b64_tr_b16 v[80:81], v18 offset:20480
    ds_read_b64_tr_b16 v[82:83], v18 offset:21376
    ds_read_b64_tr_b16 v[84:85], v18 offset:20512
    ds_read_b64_tr_b16 v[86:87], v18 offset:21408
    ds_read_b64_tr_b16 v[88:89], v18 offset:20544
    ds_read_b64_tr_b16 v[90:91], v18 offset:21440
    s_waitcnt lgkmcnt(0)
    v_mfma_f32_16x16x32_bf16 v[104:107], v[80:83], v[48:51], v[104:107]
    ds_read_b128 v[64:67], v17 offset:64
    v_mfma_f32_16x16x32_bf16 v[108:111], v[84:87], v[48:51], v[108:111]
    ds_read_b128 v[68:71], v17 offset:2624
    v_mfma_f32_16x16x32_bf16 v[112:115], v[88:91], v[48:51], v[112:115]
    ds_read_b128 v[72:75], v17 offset:5184
    v_mfma_f32_16x16x32_bf16 v[116:119], v[80:83], v[52:55], v[116:119]
    ds_read_b128 v[76:79], v17 offset:7744
    v_mfma_f32_16x16x32_bf16 v[120:123], v[84:87], v[52:55], v[120:123]
    ds_read_b64_tr_b16 v[92:93], v18 offset:27648
    v_mfma_f32_16x16x32_bf16 v[124:127], v[88:91], v[52:55], v[124:127]
    ds_read_b64_tr_b16 v[94:95], v18 offset:28544
    v_mfma_f32_16x16x32_bf16 v[128:131], v[80:83], v[56:59], v[128:131]
    ds_read_b64_tr_b16 v[96:97], v18 offset:27680
    v_mfma_f32_16x16x32_bf16 v[132:135], v[84:87], v[56:59], v[132:135]
    ds_read_b64_tr_b16 v[98:99], v18 offset:28576
    v_mfma_f32_16x16x32_bf16 v[136:139], v[88:91], v[56:59], v[136:139]
    ds_read_b64_tr_b16 v[100:101], v18 offset:27712
    v_mfma_f32_16x16x32_bf16 v[140:143], v[80:83], v[60:63], v[140:143]
    ds_read_b64_tr_b16 v[102:103], v18 offset:28608
    v_mfma_f32_16x16x32_bf16 v[144:147], v[84:87], v[60:63], v[144:147]
    v_mfma_f32_16x16x32_bf16 v[148:151], v[88:91], v[60:63], v[148:151]
    s_waitcnt lgkmcnt(0)
    v_mfma_f32_16x16x32_bf16 v[104:107], v[92:95], v[64:67], v[104:107]
    s_waitcnt vmcnt(0)
    ds_write_b128 v10, v[20:23] offset:0
    v_mfma_f32_16x16x32_bf16 v[108:111], v[96:99], v[64:67], v[108:111]
    ds_write_b128 v10, v[24:27] offset:5120
    ds_write_b128 v10, v[28:31] offset:10240
    v_mfma_f32_16x16x32_bf16 v[112:115], v[100:103], v[64:67], v[112:115]
    ds_write_b128 v10, v[32:35] offset:15360
    ds_write_b128 v14, v[36:39] offset:20480
    v_mfma_f32_16x16x32_bf16 v[116:119], v[92:95], v[68:71], v[116:119]
    ds_write_b128 v15, v[40:43] offset:20480
    ds_write_b128 v16, v[44:47] offset:20480
    v_mfma_f32_16x16x32_bf16 v[120:123], v[96:99], v[68:71], v[120:123]
    v_add_u32 v10, 34816, v10
    v_add_u32 v14, 34816, v14
    v_mfma_f32_16x16x32_bf16 v[124:127], v[100:103], v[68:71], v[124:127]
    v_add_u32 v15, 34816, v15
    v_add_u32 v16, 34816, v16
    v_mfma_f32_16x16x32_bf16 v[128:131], v[92:95], v[72:75], v[128:131]
    buffer_load_dwordx4 v[20:23], v6, s[8:11], s34 offen
    buffer_load_dwordx4 v[24:27], v7, s[8:11], s34 offen
    v_mfma_f32_16x16x32_bf16 v[132:135], v[96:99], v[72:75], v[132:135]
    buffer_load_dwordx4 v[28:31], v8, s[8:11], s34 offen
    buffer_load_dwordx4 v[32:35], v9, s[8:11], s34 offen
    v_mfma_f32_16x16x32_bf16 v[136:139], v[100:103], v[72:75], v[136:139]
    buffer_load_dwordx4 v[36:39], v11, s[12:15], s35 offen
    buffer_load_dwordx4 v[40:43], v12, s[12:15], s35 offen
    v_mfma_f32_16x16x32_bf16 v[140:143], v[92:95], v[76:79], v[140:143]
    buffer_load_dwordx4 v[44:47], v13, s[12:15], s35 offen
    s_add_u32 s34, s34, 128
    v_mfma_f32_16x16x32_bf16 v[144:147], v[96:99], v[76:79], v[144:147]
    s_add_u32 s35, s35, 73728
    v_mfma_f32_16x16x32_bf16 v[148:151], v[100:103], v[76:79], v[148:151]
    v_add_u32 v17, 4294932480, v17
    v_add_u32 v18, 4294932480, v18
    s_waitcnt lgkmcnt(0)
    s_barrier
    ds_read_b128 v[48:51], v17 offset:0
    ds_read_b128 v[52:55], v17 offset:2560
    ds_read_b128 v[56:59], v17 offset:5120
    ds_read_b128 v[60:63], v17 offset:7680
    ds_read_b64_tr_b16 v[80:81], v18 offset:20480
    ds_read_b64_tr_b16 v[82:83], v18 offset:21376
    ds_read_b64_tr_b16 v[84:85], v18 offset:20512
    ds_read_b64_tr_b16 v[86:87], v18 offset:21408
    ds_read_b64_tr_b16 v[88:89], v18 offset:20544
    ds_read_b64_tr_b16 v[90:91], v18 offset:21440
    s_waitcnt lgkmcnt(0)
    v_mfma_f32_16x16x32_bf16 v[104:107], v[80:83], v[48:51], v[104:107]
    ds_read_b128 v[64:67], v17 offset:64
    v_mfma_f32_16x16x32_bf16 v[108:111], v[84:87], v[48:51], v[108:111]
    ds_read_b128 v[68:71], v17 offset:2624
    v_mfma_f32_16x16x32_bf16 v[112:115], v[88:91], v[48:51], v[112:115]
    ds_read_b128 v[72:75], v17 offset:5184
    v_mfma_f32_16x16x32_bf16 v[116:119], v[80:83], v[52:55], v[116:119]
    ds_read_b128 v[76:79], v17 offset:7744
    v_mfma_f32_16x16x32_bf16 v[120:123], v[84:87], v[52:55], v[120:123]
    ds_read_b64_tr_b16 v[92:93], v18 offset:27648
    v_mfma_f32_16x16x32_bf16 v[124:127], v[88:91], v[52:55], v[124:127]
    ds_read_b64_tr_b16 v[94:95], v18 offset:28544
    v_mfma_f32_16x16x32_bf16 v[128:131], v[80:83], v[56:59], v[128:131]
    ds_read_b64_tr_b16 v[96:97], v18 offset:27680
    v_mfma_f32_16x16x32_bf16 v[132:135], v[84:87], v[56:59], v[132:135]
    ds_read_b64_tr_b16 v[98:99], v18 offset:28576
    v_mfma_f32_16x16x32_bf16 v[136:139], v[88:91], v[56:59], v[136:139]
    ds_read_b64_tr_b16 v[100:101], v18 offset:27712
    v_mfma_f32_16x16x32_bf16 v[140:143], v[80:83], v[60:63], v[140:143]
    ds_read_b64_tr_b16 v[102:103], v18 offset:28608
    v_mfma_f32_16x16x32_bf16 v[144:147], v[84:87], v[60:63], v[144:147]
    v_mfma_f32_16x16x32_bf16 v[148:151], v[88:91], v[60:63], v[148:151]
    s_waitcnt lgkmcnt(0)
    v_mfma_f32_16x16x32_bf16 v[104:107], v[92:95], v[64:67], v[104:107]
    s_waitcnt vmcnt(0)
    ds_write_b128 v10, v[20:23] offset:0
    v_mfma_f32_16x16x32_bf16 v[108:111], v[96:99], v[64:67], v[108:111]
    ds_write_b128 v10, v[24:27] offset:5120
    ds_write_b128 v10, v[28:31] offset:10240
    v_mfma_f32_16x16x32_bf16 v[112:115], v[100:103], v[64:67], v[112:115]
    ds_write_b128 v10, v[32:35] offset:15360
    ds_write_b128 v14, v[36:39] offset:20480
    v_mfma_f32_16x16x32_bf16 v[116:119], v[92:95], v[68:71], v[116:119]
    ds_write_b128 v15, v[40:43] offset:20480
    ds_write_b128 v16, v[44:47] offset:20480
    v_mfma_f32_16x16x32_bf16 v[120:123], v[96:99], v[68:71], v[120:123]
    v_add_u32 v10, 4294932480, v10
    v_add_u32 v14, 4294932480, v14
    v_mfma_f32_16x16x32_bf16 v[124:127], v[100:103], v[68:71], v[124:127]
    v_add_u32 v15, 4294932480, v15
    v_add_u32 v16, 4294932480, v16
    v_mfma_f32_16x16x32_bf16 v[128:131], v[92:95], v[72:75], v[128:131]
    buffer_load_dwordx4 v[20:23], v6, s[8:11], s34 offen
    buffer_load_dwordx4 v[24:27], v7, s[8:11], s34 offen
    v_mfma_f32_16x16x32_bf16 v[132:135], v[96:99], v[72:75], v[132:135]
    buffer_load_dwordx4 v[28:31], v8, s[8:11], s34 offen
    buffer_load_dwordx4 v[32:35], v9, s[8:11], s34 offen
    v_mfma_f32_16x16x32_bf16 v[136:139], v[100:103], v[72:75], v[136:139]
    buffer_load_dwordx4 v[36:39], v11, s[12:15], s35 offen
    buffer_load_dwordx4 v[40:43], v12, s[12:15], s35 offen
    v_mfma_f32_16x16x32_bf16 v[140:143], v[92:95], v[76:79], v[140:143]
    buffer_load_dwordx4 v[44:47], v13, s[12:15], s35 offen
    s_add_u32 s34, s34, 128
    v_mfma_f32_16x16x32_bf16 v[144:147], v[96:99], v[76:79], v[144:147]
    s_add_u32 s35, s35, 73728
    v_mfma_f32_16x16x32_bf16 v[148:151], v[100:103], v[76:79], v[148:151]
    v_add_u32 v17, 34816, v17
    v_add_u32 v18, 34816, v18
    s_waitcnt lgkmcnt(0)
    s_barrier
    ds_read_b128 v[48:51], v17 offset:0
    ds_read_b128 v[52:55], v17 offset:2560
    ds_read_b128 v[56:59], v17 offset:5120
    ds_read_b128 v[60:63], v17 offset:7680
    ds_read_b64_tr_b16 v[80:81], v18 offset:20480
    ds_read_b64_tr_b16 v[82:83], v18 offset:21376
    ds_read_b64_tr_b16 v[84:85], v18 offset:20512
    ds_read_b64_tr_b16 v[86:87], v18 offset:21408
    ds_read_b64_tr_b16 v[88:89], v18 offset:20544
    ds_read_b64_tr_b16 v[90:91], v18 offset:21440
    s_waitcnt lgkmcnt(0)
    v_mfma_f32_16x16x32_bf16 v[104:107], v[80:83], v[48:51], v[104:107]
    ds_read_b128 v[64:67], v17 offset:64
    v_mfma_f32_16x16x32_bf16 v[108:111], v[84:87], v[48:51], v[108:111]
    ds_read_b128 v[68:71], v17 offset:2624
    v_mfma_f32_16x16x32_bf16 v[112:115], v[88:91], v[48:51], v[112:115]
    ds_read_b128 v[72:75], v17 offset:5184
    v_mfma_f32_16x16x32_bf16 v[116:119], v[80:83], v[52:55], v[116:119]
    ds_read_b128 v[76:79], v17 offset:7744
    v_mfma_f32_16x16x32_bf16 v[120:123], v[84:87], v[52:55], v[120:123]
    ds_read_b64_tr_b16 v[92:93], v18 offset:27648
    v_mfma_f32_16x16x32_bf16 v[124:127], v[88:91], v[52:55], v[124:127]
    ds_read_b64_tr_b16 v[94:95], v18 offset:28544
    v_mfma_f32_16x16x32_bf16 v[128:131], v[80:83], v[56:59], v[128:131]
    ds_read_b64_tr_b16 v[96:97], v18 offset:27680
    v_mfma_f32_16x16x32_bf16 v[132:135], v[84:87], v[56:59], v[132:135]
    ds_read_b64_tr_b16 v[98:99], v18 offset:28576
    v_mfma_f32_16x16x32_bf16 v[136:139], v[88:91], v[56:59], v[136:139]
    ds_read_b64_tr_b16 v[100:101], v18 offset:27712
    v_mfma_f32_16x16x32_bf16 v[140:143], v[80:83], v[60:63], v[140:143]
    ds_read_b64_tr_b16 v[102:103], v18 offset:28608
    v_mfma_f32_16x16x32_bf16 v[144:147], v[84:87], v[60:63], v[144:147]
    v_mfma_f32_16x16x32_bf16 v[148:151], v[88:91], v[60:63], v[148:151]
    s_waitcnt lgkmcnt(0)
    v_mfma_f32_16x16x32_bf16 v[104:107], v[92:95], v[64:67], v[104:107]
    s_waitcnt vmcnt(0)
    ds_write_b128 v10, v[20:23] offset:0
    v_mfma_f32_16x16x32_bf16 v[108:111], v[96:99], v[64:67], v[108:111]
    ds_write_b128 v10, v[24:27] offset:5120
    ds_write_b128 v10, v[28:31] offset:10240
    v_mfma_f32_16x16x32_bf16 v[112:115], v[100:103], v[64:67], v[112:115]
    ds_write_b128 v10, v[32:35] offset:15360
    ds_write_b128 v14, v[36:39] offset:20480
    v_mfma_f32_16x16x32_bf16 v[116:119], v[92:95], v[68:71], v[116:119]
    ds_write_b128 v15, v[40:43] offset:20480
    ds_write_b128 v16, v[44:47] offset:20480
    v_mfma_f32_16x16x32_bf16 v[120:123], v[96:99], v[68:71], v[120:123]
    v_add_u32 v10, 34816, v10
    v_add_u32 v14, 34816, v14
    v_mfma_f32_16x16x32_bf16 v[124:127], v[100:103], v[68:71], v[124:127]
    v_add_u32 v15, 34816, v15
    v_add_u32 v16, 34816, v16
    v_mfma_f32_16x16x32_bf16 v[128:131], v[92:95], v[72:75], v[128:131]
    buffer_load_dwordx4 v[20:23], v6, s[8:11], s34 offen
    buffer_load_dwordx4 v[24:27], v7, s[8:11], s34 offen
    v_mfma_f32_16x16x32_bf16 v[132:135], v[96:99], v[72:75], v[132:135]
    buffer_load_dwordx4 v[28:31], v8, s[8:11], s34 offen
    buffer_load_dwordx4 v[32:35], v9, s[8:11], s34 offen
    v_mfma_f32_16x16x32_bf16 v[136:139], v[100:103], v[72:75], v[136:139]
    buffer_load_dwordx4 v[36:39], v11, s[12:15], s35 offen
    buffer_load_dwordx4 v[40:43], v12, s[12:15], s35 offen
    v_mfma_f32_16x16x32_bf16 v[140:143], v[92:95], v[76:79], v[140:143]
    buffer_load_dwordx4 v[44:47], v13, s[12:15], s35 offen
    s_add_u32 s34, s34, 128
    v_mfma_f32_16x16x32_bf16 v[144:147], v[96:99], v[76:79], v[144:147]
    s_add_u32 s35, s35, 73728
    v_mfma_f32_16x16x32_bf16 v[148:151], v[100:103], v[76:79], v[148:151]
    v_add_u32 v17, 4294932480, v17
    v_add_u32 v18, 4294932480, v18
    s_waitcnt lgkmcnt(0)
    s_barrier
    ds_read_b128 v[48:51], v17 offset:0
    ds_read_b128 v[52:55], v17 offset:2560
    ds_read_b128 v[56:59], v17 offset:5120
    ds_read_b128 v[60:63], v17 offset:7680
    ds_read_b64_tr_b16 v[80:81], v18 offset:20480
    ds_read_b64_tr_b16 v[82:83], v18 offset:21376
    ds_read_b64_tr_b16 v[84:85], v18 offset:20512
    ds_read_b64_tr_b16 v[86:87], v18 offset:21408
    ds_read_b64_tr_b16 v[88:89], v18 offset:20544
    ds_read_b64_tr_b16 v[90:91], v18 offset:21440
    s_waitcnt lgkmcnt(0)
    v_mfma_f32_16x16x32_bf16 v[104:107], v[80:83], v[48:51], v[104:107]
    ds_read_b128 v[64:67], v17 offset:64
    v_mfma_f32_16x16x32_bf16 v[108:111], v[84:87], v[48:51], v[108:111]
    ds_read_b128 v[68:71], v17 offset:2624
    v_mfma_f32_16x16x32_bf16 v[112:115], v[88:91], v[48:51], v[112:115]
    ds_read_b128 v[72:75], v17 offset:5184
    v_mfma_f32_16x16x32_bf16 v[116:119], v[80:83], v[52:55], v[116:119]
    ds_read_b128 v[76:79], v17 offset:7744
    v_mfma_f32_16x16x32_bf16 v[120:123], v[84:87], v[52:55], v[120:123]
    ds_read_b64_tr_b16 v[92:93], v18 offset:27648
    v_mfma_f32_16x16x32_bf16 v[124:127], v[88:91], v[52:55], v[124:127]
    ds_read_b64_tr_b16 v[94:95], v18 offset:28544
    v_mfma_f32_16x16x32_bf16 v[128:131], v[80:83], v[56:59], v[128:131]
    ds_read_b64_tr_b16 v[96:97], v18 offset:27680
    v_mfma_f32_16x16x32_bf16 v[132:135], v[84:87], v[56:59], v[132:135]
    ds_read_b64_tr_b16 v[98:99], v18 offset:28576
    v_mfma_f32_16x16x32_bf16 v[136:139], v[88:91], v[56:59], v[136:139]
    ds_read_b64_tr_b16 v[100:101], v18 offset:27712
    v_mfma_f32_16x16x32_bf16 v[140:143], v[80:83], v[60:63], v[140:143]
    ds_read_b64_tr_b16 v[102:103], v18 offset:28608
    v_mfma_f32_16x16x32_bf16 v[144:147], v[84:87], v[60:63], v[144:147]
    v_mfma_f32_16x16x32_bf16 v[148:151], v[88:91], v[60:63], v[148:151]
    s_waitcnt lgkmcnt(0)
    v_mfma_f32_16x16x32_bf16 v[104:107], v[92:95], v[64:67], v[104:107]
    s_waitcnt vmcnt(0)
    ds_write_b128 v10, v[20:23] offset:0
    v_mfma_f32_16x16x32_bf16 v[108:111], v[96:99], v[64:67], v[108:111]
    ds_write_b128 v10, v[24:27] offset:5120
    ds_write_b128 v10, v[28:31] offset:10240
    v_mfma_f32_16x16x32_bf16 v[112:115], v[100:103], v[64:67], v[112:115]
    ds_write_b128 v10, v[32:35] offset:15360
    ds_write_b128 v14, v[36:39] offset:20480
    v_mfma_f32_16x16x32_bf16 v[116:119], v[92:95], v[68:71], v[116:119]
    ds_write_b128 v15, v[40:43] offset:20480
    ds_write_b128 v16, v[44:47] offset:20480
    v_mfma_f32_16x16x32_bf16 v[120:123], v[96:99], v[68:71], v[120:123]
    v_add_u32 v10, 4294932480, v10
    v_add_u32 v14, 4294932480, v14
    v_mfma_f32_16x16x32_bf16 v[124:127], v[100:103], v[68:71], v[124:127]
    v_add_u32 v15, 4294932480, v15
    v_add_u32 v16, 4294932480, v16
    v_mfma_f32_16x16x32_bf16 v[128:131], v[92:95], v[72:75], v[128:131]
    buffer_load_dwordx4 v[20:23], v6, s[8:11], s34 offen
    buffer_load_dwordx4 v[24:27], v7, s[8:11], s34 offen
    v_mfma_f32_16x16x32_bf16 v[132:135], v[96:99], v[72:75], v[132:135]
    buffer_load_dwordx4 v[28:31], v8, s[8:11], s34 offen
    buffer_load_dwordx4 v[32:35], v9, s[8:11], s34 offen
    v_mfma_f32_16x16x32_bf16 v[136:139], v[100:103], v[72:75], v[136:139]
    buffer_load_dwordx4 v[36:39], v11, s[12:15], s35 offen
    buffer_load_dwordx4 v[40:43], v12, s[12:15], s35 offen
    v_mfma_f32_16x16x32_bf16 v[140:143], v[92:95], v[76:79], v[140:143]
    buffer_load_dwordx4 v[44:47], v13, s[12:15], s35 offen
    s_add_u32 s34, s34, 128
    v_mfma_f32_16x16x32_bf16 v[144:147], v[96:99], v[76:79], v[144:147]
    s_add_u32 s35, s35, 73728
    v_mfma_f32_16x16x32_bf16 v[148:151], v[100:103], v[76:79], v[148:151]
    v_add_u32 v17, 34816, v17
    v_add_u32 v18, 34816, v18
    s_waitcnt lgkmcnt(0)
    s_barrier
    ds_read_b128 v[48:51], v17 offset:0
    ds_read_b128 v[52:55], v17 offset:2560
    ds_read_b128 v[56:59], v17 offset:5120
    ds_read_b128 v[60:63], v17 offset:7680
    ds_read_b64_tr_b16 v[80:81], v18 offset:20480
    ds_read_b64_tr_b16 v[82:83], v18 offset:21376
    ds_read_b64_tr_b16 v[84:85], v18 offset:20512
    ds_read_b64_tr_b16 v[86:87], v18 offset:21408
    ds_read_b64_tr_b16 v[88:89], v18 offset:20544
    ds_read_b64_tr_b16 v[90:91], v18 offset:21440
    s_waitcnt lgkmcnt(0)
    v_mfma_f32_16x16x32_bf16 v[104:107], v[80:83], v[48:51], v[104:107]
    ds_read_b128 v[64:67], v17 offset:64
    v_mfma_f32_16x16x32_bf16 v[108:111], v[84:87], v[48:51], v[108:111]
    ds_read_b128 v[68:71], v17 offset:2624
    v_mfma_f32_16x16x32_bf16 v[112:115], v[88:91], v[48:51], v[112:115]
    ds_read_b128 v[72:75], v17 offset:5184
    v_mfma_f32_16x16x32_bf16 v[116:119], v[80:83], v[52:55], v[116:119]
    ds_read_b128 v[76:79], v17 offset:7744
    v_mfma_f32_16x16x32_bf16 v[120:123], v[84:87], v[52:55], v[120:123]
    ds_read_b64_tr_b16 v[92:93], v18 offset:27648
    v_mfma_f32_16x16x32_bf16 v[124:127], v[88:91], v[52:55], v[124:127]
    ds_read_b64_tr_b16 v[94:95], v18 offset:28544
    v_mfma_f32_16x16x32_bf16 v[128:131], v[80:83], v[56:59], v[128:131]
    ds_read_b64_tr_b16 v[96:97], v18 offset:27680
    v_mfma_f32_16x16x32_bf16 v[132:135], v[84:87], v[56:59], v[132:135]
    ds_read_b64_tr_b16 v[98:99], v18 offset:28576
    v_mfma_f32_16x16x32_bf16 v[136:139], v[88:91], v[56:59], v[136:139]
    ds_read_b64_tr_b16 v[100:101], v18 offset:27712
    v_mfma_f32_16x16x32_bf16 v[140:143], v[80:83], v[60:63], v[140:143]
    ds_read_b64_tr_b16 v[102:103], v18 offset:28608
    v_mfma_f32_16x16x32_bf16 v[144:147], v[84:87], v[60:63], v[144:147]
    v_mfma_f32_16x16x32_bf16 v[148:151], v[88:91], v[60:63], v[148:151]
    s_waitcnt lgkmcnt(0)
    v_mfma_f32_16x16x32_bf16 v[104:107], v[92:95], v[64:67], v[104:107]
    s_waitcnt vmcnt(0)
    ds_write_b128 v10, v[20:23] offset:0
    v_mfma_f32_16x16x32_bf16 v[108:111], v[96:99], v[64:67], v[108:111]
    ds_write_b128 v10, v[24:27] offset:5120
    ds_write_b128 v10, v[28:31] offset:10240
    v_mfma_f32_16x16x32_bf16 v[112:115], v[100:103], v[64:67], v[112:115]
    ds_write_b128 v10, v[32:35] offset:15360
    ds_write_b128 v14, v[36:39] offset:20480
    v_mfma_f32_16x16x32_bf16 v[116:119], v[92:95], v[68:71], v[116:119]
    ds_write_b128 v15, v[40:43] offset:20480
    ds_write_b128 v16, v[44:47] offset:20480
    v_mfma_f32_16x16x32_bf16 v[120:123], v[96:99], v[68:71], v[120:123]
    v_add_u32 v10, 34816, v10
    v_add_u32 v14, 34816, v14
    v_mfma_f32_16x16x32_bf16 v[124:127], v[100:103], v[68:71], v[124:127]
    v_add_u32 v15, 34816, v15
    v_add_u32 v16, 34816, v16
    v_mfma_f32_16x16x32_bf16 v[128:131], v[92:95], v[72:75], v[128:131]
    buffer_load_dwordx4 v[20:23], v6, s[8:11], s34 offen
    buffer_load_dwordx4 v[24:27], v7, s[8:11], s34 offen
    v_mfma_f32_16x16x32_bf16 v[132:135], v[96:99], v[72:75], v[132:135]
    buffer_load_dwordx4 v[28:31], v8, s[8:11], s34 offen
    buffer_load_dwordx4 v[32:35], v9, s[8:11], s34 offen
    v_mfma_f32_16x16x32_bf16 v[136:139], v[100:103], v[72:75], v[136:139]
    buffer_load_dwordx4 v[36:39], v11, s[12:15], s35 offen
    buffer_load_dwordx4 v[40:43], v12, s[12:15], s35 offen
    v_mfma_f32_16x16x32_bf16 v[140:143], v[92:95], v[76:79], v[140:143]
    buffer_load_dwordx4 v[44:47], v13, s[12:15], s35 offen
    s_add_u32 s34, s34, 128
    v_mfma_f32_16x16x32_bf16 v[144:147], v[96:99], v[76:79], v[144:147]
    s_add_u32 s35, s35, 73728
    v_mfma_f32_16x16x32_bf16 v[148:151], v[100:103], v[76:79], v[148:151]
    v_add_u32 v17, 4294932480, v17
    v_add_u32 v18, 4294932480, v18
    s_waitcnt lgkmcnt(0)
    s_barrier
    ds_read_b128 v[48:51], v17 offset:0
    ds_read_b128 v[52:55], v17 offset:2560
    ds_read_b128 v[56:59], v17 offset:5120
    ds_read_b128 v[60:63], v17 offset:7680
    ds_read_b64_tr_b16 v[80:81], v18 offset:20480
    ds_read_b64_tr_b16 v[82:83], v18 offset:21376
    ds_read_b64_tr_b16 v[84:85], v18 offset:20512
    ds_read_b64_tr_b16 v[86:87], v18 offset:21408
    ds_read_b64_tr_b16 v[88:89], v18 offset:20544
    ds_read_b64_tr_b16 v[90:91], v18 offset:21440
    s_waitcnt lgkmcnt(0)
    v_mfma_f32_16x16x32_bf16 v[104:107], v[80:83], v[48:51], v[104:107]
    ds_read_b128 v[64:67], v17 offset:64
    v_mfma_f32_16x16x32_bf16 v[108:111], v[84:87], v[48:51], v[108:111]
    ds_read_b128 v[68:71], v17 offset:2624
    v_mfma_f32_16x16x32_bf16 v[112:115], v[88:91], v[48:51], v[112:115]
    ds_read_b128 v[72:75], v17 offset:5184
    v_mfma_f32_16x16x32_bf16 v[116:119], v[80:83], v[52:55], v[116:119]
    ds_read_b128 v[76:79], v17 offset:7744
    v_mfma_f32_16x16x32_bf16 v[120:123], v[84:87], v[52:55], v[120:123]
    ds_read_b64_tr_b16 v[92:93], v18 offset:27648
    v_mfma_f32_16x16x32_bf16 v[124:127], v[88:91], v[52:55], v[124:127]
    ds_read_b64_tr_b16 v[94:95], v18 offset:28544
    v_mfma_f32_16x16x32_bf16 v[128:131], v[80:83], v[56:59], v[128:131]
    ds_read_b64_tr_b16 v[96:97], v18 offset:27680
    v_mfma_f32_16x16x32_bf16 v[132:135], v[84:87], v[56:59], v[132:135]
    ds_read_b64_tr_b16 v[98:99], v18 offset:28576
    v_mfma_f32_16x16x32_bf16 v[136:139], v[88:91], v[56:59], v[136:139]
    ds_read_b64_tr_b16 v[100:101], v18 offset:27712
    v_mfma_f32_16x16x32_bf16 v[140:143], v[80:83], v[60:63], v[140:143]
    ds_read_b64_tr_b16 v[102:103], v18 offset:28608
    v_mfma_f32_16x16x32_bf16 v[144:147], v[84:87], v[60:63], v[144:147]
    v_mfma_f32_16x16x32_bf16 v[148:151], v[88:91], v[60:63], v[148:151]
    s_waitcnt lgkmcnt(0)
    v_mfma_f32_16x16x32_bf16 v[104:107], v[92:95], v[64:67], v[104:107]
    s_waitcnt vmcnt(0)
    ds_write_b128 v10, v[20:23] offset:0
    v_mfma_f32_16x16x32_bf16 v[108:111], v[96:99], v[64:67], v[108:111]
    ds_write_b128 v10, v[24:27] offset:5120
    ds_write_b128 v10, v[28:31] offset:10240
    v_mfma_f32_16x16x32_bf16 v[112:115], v[100:103], v[64:67], v[112:115]
    ds_write_b128 v10, v[32:35] offset:15360
    ds_write_b128 v14, v[36:39] offset:20480
    v_mfma_f32_16x16x32_bf16 v[116:119], v[92:95], v[68:71], v[116:119]
    ds_write_b128 v15, v[40:43] offset:20480
    ds_write_b128 v16, v[44:47] offset:20480
    v_mfma_f32_16x16x32_bf16 v[120:123], v[96:99], v[68:71], v[120:123]
    v_add_u32 v10, 4294932480, v10
    v_add_u32 v14, 4294932480, v14
    v_mfma_f32_16x16x32_bf16 v[124:127], v[100:103], v[68:71], v[124:127]
    v_add_u32 v15, 4294932480, v15
    v_add_u32 v16, 4294932480, v16
    v_mfma_f32_16x16x32_bf16 v[128:131], v[92:95], v[72:75], v[128:131]
    buffer_load_dwordx4 v[20:23], v6, s[8:11], s34 offen
    buffer_load_dwordx4 v[24:27], v7, s[8:11], s34 offen
    v_mfma_f32_16x16x32_bf16 v[132:135], v[96:99], v[72:75], v[132:135]
    buffer_load_dwordx4 v[28:31], v8, s[8:11], s34 offen
    buffer_load_dwordx4 v[32:35], v9, s[8:11], s34 offen
    v_mfma_f32_16x16x32_bf16 v[136:139], v[100:103], v[72:75], v[136:139]
    buffer_load_dwordx4 v[36:39], v11, s[12:15], s35 offen
    buffer_load_dwordx4 v[40:43], v12, s[12:15], s35 offen
    v_mfma_f32_16x16x32_bf16 v[140:143], v[92:95], v[76:79], v[140:143]
    buffer_load_dwordx4 v[44:47], v13, s[12:15], s35 offen
    s_add_u32 s34, s34, 128
    v_mfma_f32_16x16x32_bf16 v[144:147], v[96:99], v[76:79], v[144:147]
    s_add_u32 s35, s35, 73728
    v_mfma_f32_16x16x32_bf16 v[148:151], v[100:103], v[76:79], v[148:151]
    v_add_u32 v17, 34816, v17
    v_add_u32 v18, 34816, v18
    s_waitcnt lgkmcnt(0)
    s_barrier
    ds_read_b128 v[48:51], v17 offset:0
    ds_read_b128 v[52:55], v17 offset:2560
    ds_read_b128 v[56:59], v17 offset:5120
    ds_read_b128 v[60:63], v17 offset:7680
    ds_read_b64_tr_b16 v[80:81], v18 offset:20480
    ds_read_b64_tr_b16 v[82:83], v18 offset:21376
    ds_read_b64_tr_b16 v[84:85], v18 offset:20512
    ds_read_b64_tr_b16 v[86:87], v18 offset:21408
    ds_read_b64_tr_b16 v[88:89], v18 offset:20544
    ds_read_b64_tr_b16 v[90:91], v18 offset:21440
    s_waitcnt lgkmcnt(0)
    v_mfma_f32_16x16x32_bf16 v[104:107], v[80:83], v[48:51], v[104:107]
    ds_read_b128 v[64:67], v17 offset:64
    v_mfma_f32_16x16x32_bf16 v[108:111], v[84:87], v[48:51], v[108:111]
    ds_read_b128 v[68:71], v17 offset:2624
    v_mfma_f32_16x16x32_bf16 v[112:115], v[88:91], v[48:51], v[112:115]
    ds_read_b128 v[72:75], v17 offset:5184
    v_mfma_f32_16x16x32_bf16 v[116:119], v[80:83], v[52:55], v[116:119]
    ds_read_b128 v[76:79], v17 offset:7744
    v_mfma_f32_16x16x32_bf16 v[120:123], v[84:87], v[52:55], v[120:123]
    ds_read_b64_tr_b16 v[92:93], v18 offset:27648
    v_mfma_f32_16x16x32_bf16 v[124:127], v[88:91], v[52:55], v[124:127]
    ds_read_b64_tr_b16 v[94:95], v18 offset:28544
    v_mfma_f32_16x16x32_bf16 v[128:131], v[80:83], v[56:59], v[128:131]
    ds_read_b64_tr_b16 v[96:97], v18 offset:27680
    v_mfma_f32_16x16x32_bf16 v[132:135], v[84:87], v[56:59], v[132:135]
    ds_read_b64_tr_b16 v[98:99], v18 offset:28576
    v_mfma_f32_16x16x32_bf16 v[136:139], v[88:91], v[56:59], v[136:139]
    ds_read_b64_tr_b16 v[100:101], v18 offset:27712
    v_mfma_f32_16x16x32_bf16 v[140:143], v[80:83], v[60:63], v[140:143]
    ds_read_b64_tr_b16 v[102:103], v18 offset:28608
    v_mfma_f32_16x16x32_bf16 v[144:147], v[84:87], v[60:63], v[144:147]
    v_mfma_f32_16x16x32_bf16 v[148:151], v[88:91], v[60:63], v[148:151]
    s_waitcnt lgkmcnt(0)
    v_mfma_f32_16x16x32_bf16 v[104:107], v[92:95], v[64:67], v[104:107]
    s_waitcnt vmcnt(0)
    ds_write_b128 v10, v[20:23] offset:0
    v_mfma_f32_16x16x32_bf16 v[108:111], v[96:99], v[64:67], v[108:111]
    ds_write_b128 v10, v[24:27] offset:5120
    ds_write_b128 v10, v[28:31] offset:10240
    v_mfma_f32_16x16x32_bf16 v[112:115], v[100:103], v[64:67], v[112:115]
    ds_write_b128 v10, v[32:35] offset:15360
    ds_write_b128 v14, v[36:39] offset:20480
    v_mfma_f32_16x16x32_bf16 v[116:119], v[92:95], v[68:71], v[116:119]
    ds_write_b128 v15, v[40:43] offset:20480
    ds_write_b128 v16, v[44:47] offset:20480
    v_mfma_f32_16x16x32_bf16 v[120:123], v[96:99], v[68:71], v[120:123]
    v_add_u32 v10, 34816, v10
    v_add_u32 v14, 34816, v14
    v_mfma_f32_16x16x32_bf16 v[124:127], v[100:103], v[68:71], v[124:127]
    v_add_u32 v15, 34816, v15
    v_add_u32 v16, 34816, v16
    v_mfma_f32_16x16x32_bf16 v[128:131], v[92:95], v[72:75], v[128:131]
    buffer_load_dwordx4 v[20:23], v6, s[8:11], s34 offen
    buffer_load_dwordx4 v[24:27], v7, s[8:11], s34 offen
    v_mfma_f32_16x16x32_bf16 v[132:135], v[96:99], v[72:75], v[132:135]
    buffer_load_dwordx4 v[28:31], v8, s[8:11], s34 offen
    buffer_load_dwordx4 v[32:35], v9, s[8:11], s34 offen
    v_mfma_f32_16x16x32_bf16 v[136:139], v[100:103], v[72:75], v[136:139]
    buffer_load_dwordx4 v[36:39], v11, s[12:15], s35 offen
    buffer_load_dwordx4 v[40:43], v12, s[12:15], s35 offen
    v_mfma_f32_16x16x32_bf16 v[140:143], v[92:95], v[76:79], v[140:143]
    buffer_load_dwordx4 v[44:47], v13, s[12:15], s35 offen
    s_add_u32 s34, s34, 128
    v_mfma_f32_16x16x32_bf16 v[144:147], v[96:99], v[76:79], v[144:147]
    s_add_u32 s35, s35, 73728
    v_mfma_f32_16x16x32_bf16 v[148:151], v[100:103], v[76:79], v[148:151]
    v_add_u32 v17, 4294932480, v17
    v_add_u32 v18, 4294932480, v18
    s_waitcnt lgkmcnt(0)
    s_barrier
    ds_read_b128 v[48:51], v17 offset:0
    ds_read_b128 v[52:55], v17 offset:2560
    ds_read_b128 v[56:59], v17 offset:5120
    ds_read_b128 v[60:63], v17 offset:7680
    ds_read_b64_tr_b16 v[80:81], v18 offset:20480
    ds_read_b64_tr_b16 v[82:83], v18 offset:21376
    ds_read_b64_tr_b16 v[84:85], v18 offset:20512
    ds_read_b64_tr_b16 v[86:87], v18 offset:21408
    ds_read_b64_tr_b16 v[88:89], v18 offset:20544
    ds_read_b64_tr_b16 v[90:91], v18 offset:21440
    s_waitcnt lgkmcnt(0)
    v_mfma_f32_16x16x32_bf16 v[104:107], v[80:83], v[48:51], v[104:107]
    ds_read_b128 v[64:67], v17 offset:64
    v_mfma_f32_16x16x32_bf16 v[108:111], v[84:87], v[48:51], v[108:111]
    ds_read_b128 v[68:71], v17 offset:2624
    v_mfma_f32_16x16x32_bf16 v[112:115], v[88:91], v[48:51], v[112:115]
    ds_read_b128 v[72:75], v17 offset:5184
    v_mfma_f32_16x16x32_bf16 v[116:119], v[80:83], v[52:55], v[116:119]
    ds_read_b128 v[76:79], v17 offset:7744
    v_mfma_f32_16x16x32_bf16 v[120:123], v[84:87], v[52:55], v[120:123]
    ds_read_b64_tr_b16 v[92:93], v18 offset:27648
    v_mfma_f32_16x16x32_bf16 v[124:127], v[88:91], v[52:55], v[124:127]
    ds_read_b64_tr_b16 v[94:95], v18 offset:28544
    v_mfma_f32_16x16x32_bf16 v[128:131], v[80:83], v[56:59], v[128:131]
    ds_read_b64_tr_b16 v[96:97], v18 offset:27680
    v_mfma_f32_16x16x32_bf16 v[132:135], v[84:87], v[56:59], v[132:135]
    ds_read_b64_tr_b16 v[98:99], v18 offset:28576
    v_mfma_f32_16x16x32_bf16 v[136:139], v[88:91], v[56:59], v[136:139]
    ds_read_b64_tr_b16 v[100:101], v18 offset:27712
    v_mfma_f32_16x16x32_bf16 v[140:143], v[80:83], v[60:63], v[140:143]
    ds_read_b64_tr_b16 v[102:103], v18 offset:28608
    v_mfma_f32_16x16x32_bf16 v[144:147], v[84:87], v[60:63], v[144:147]
    v_mfma_f32_16x16x32_bf16 v[148:151], v[88:91], v[60:63], v[148:151]
    s_waitcnt lgkmcnt(0)
    v_mfma_f32_16x16x32_bf16 v[104:107], v[92:95], v[64:67], v[104:107]
    s_waitcnt vmcnt(0)
    ds_write_b128 v10, v[20:23] offset:0
    v_mfma_f32_16x16x32_bf16 v[108:111], v[96:99], v[64:67], v[108:111]
    ds_write_b128 v10, v[24:27] offset:5120
    ds_write_b128 v10, v[28:31] offset:10240
    v_mfma_f32_16x16x32_bf16 v[112:115], v[100:103], v[64:67], v[112:115]
    ds_write_b128 v10, v[32:35] offset:15360
    ds_write_b128 v14, v[36:39] offset:20480
    v_mfma_f32_16x16x32_bf16 v[116:119], v[92:95], v[68:71], v[116:119]
    ds_write_b128 v15, v[40:43] offset:20480
    ds_write_b128 v16, v[44:47] offset:20480
    v_mfma_f32_16x16x32_bf16 v[120:123], v[96:99], v[68:71], v[120:123]
    v_add_u32 v10, 4294932480, v10
    v_add_u32 v14, 4294932480, v14
    v_mfma_f32_16x16x32_bf16 v[124:127], v[100:103], v[68:71], v[124:127]
    v_add_u32 v15, 4294932480, v15
    v_add_u32 v16, 4294932480, v16
    v_mfma_f32_16x16x32_bf16 v[128:131], v[92:95], v[72:75], v[128:131]
    buffer_load_dwordx4 v[20:23], v6, s[8:11], s34 offen
    buffer_load_dwordx4 v[24:27], v7, s[8:11], s34 offen
    v_mfma_f32_16x16x32_bf16 v[132:135], v[96:99], v[72:75], v[132:135]
    buffer_load_dwordx4 v[28:31], v8, s[8:11], s34 offen
    buffer_load_dwordx4 v[32:35], v9, s[8:11], s34 offen
    v_mfma_f32_16x16x32_bf16 v[136:139], v[100:103], v[72:75], v[136:139]
    buffer_load_dwordx4 v[36:39], v11, s[12:15], s35 offen
    buffer_load_dwordx4 v[40:43], v12, s[12:15], s35 offen
    v_mfma_f32_16x16x32_bf16 v[140:143], v[92:95], v[76:79], v[140:143]
    buffer_load_dwordx4 v[44:47], v13, s[12:15], s35 offen
    s_add_u32 s34, s34, 128
    v_mfma_f32_16x16x32_bf16 v[144:147], v[96:99], v[76:79], v[144:147]
    s_add_u32 s35, s35, 73728
    v_mfma_f32_16x16x32_bf16 v[148:151], v[100:103], v[76:79], v[148:151]
    v_add_u32 v17, 34816, v17
    v_add_u32 v18, 34816, v18
    s_waitcnt lgkmcnt(0)
    s_barrier
    ds_read_b128 v[48:51], v17 offset:0
    ds_read_b128 v[52:55], v17 offset:2560
    ds_read_b128 v[56:59], v17 offset:5120
    ds_read_b128 v[60:63], v17 offset:7680
    ds_read_b64_tr_b16 v[80:81], v18 offset:20480
    ds_read_b64_tr_b16 v[82:83], v18 offset:21376
    ds_read_b64_tr_b16 v[84:85], v18 offset:20512
    ds_read_b64_tr_b16 v[86:87], v18 offset:21408
    ds_read_b64_tr_b16 v[88:89], v18 offset:20544
    ds_read_b64_tr_b16 v[90:91], v18 offset:21440
    s_waitcnt lgkmcnt(0)
    v_mfma_f32_16x16x32_bf16 v[104:107], v[80:83], v[48:51], v[104:107]
    ds_read_b128 v[64:67], v17 offset:64
    v_mfma_f32_16x16x32_bf16 v[108:111], v[84:87], v[48:51], v[108:111]
    ds_read_b128 v[68:71], v17 offset:2624
    v_mfma_f32_16x16x32_bf16 v[112:115], v[88:91], v[48:51], v[112:115]
    ds_read_b128 v[72:75], v17 offset:5184
    v_mfma_f32_16x16x32_bf16 v[116:119], v[80:83], v[52:55], v[116:119]
    ds_read_b128 v[76:79], v17 offset:7744
    v_mfma_f32_16x16x32_bf16 v[120:123], v[84:87], v[52:55], v[120:123]
    ds_read_b64_tr_b16 v[92:93], v18 offset:27648
    v_mfma_f32_16x16x32_bf16 v[124:127], v[88:91], v[52:55], v[124:127]
    ds_read_b64_tr_b16 v[94:95], v18 offset:28544
    v_mfma_f32_16x16x32_bf16 v[128:131], v[80:83], v[56:59], v[128:131]
    ds_read_b64_tr_b16 v[96:97], v18 offset:27680
    v_mfma_f32_16x16x32_bf16 v[132:135], v[84:87], v[56:59], v[132:135]
    ds_read_b64_tr_b16 v[98:99], v18 offset:28576
    v_mfma_f32_16x16x32_bf16 v[136:139], v[88:91], v[56:59], v[136:139]
    ds_read_b64_tr_b16 v[100:101], v18 offset:27712
    v_mfma_f32_16x16x32_bf16 v[140:143], v[80:83], v[60:63], v[140:143]
    ds_read_b64_tr_b16 v[102:103], v18 offset:28608
    v_mfma_f32_16x16x32_bf16 v[144:147], v[84:87], v[60:63], v[144:147]
    v_mfma_f32_16x16x32_bf16 v[148:151], v[88:91], v[60:63], v[148:151]
    s_waitcnt lgkmcnt(0)
    v_mfma_f32_16x16x32_bf16 v[104:107], v[92:95], v[64:67], v[104:107]
    s_waitcnt vmcnt(0)
    ds_write_b128 v10, v[20:23] offset:0
    v_mfma_f32_16x16x32_bf16 v[108:111], v[96:99], v[64:67], v[108:111]
    ds_write_b128 v10, v[24:27] offset:5120
    ds_write_b128 v10, v[28:31] offset:10240
    v_mfma_f32_16x16x32_bf16 v[112:115], v[100:103], v[64:67], v[112:115]
    ds_write_b128 v10, v[32:35] offset:15360
    ds_write_b128 v14, v[36:39] offset:20480
    v_mfma_f32_16x16x32_bf16 v[116:119], v[92:95], v[68:71], v[116:119]
    ds_write_b128 v15, v[40:43] offset:20480
    ds_write_b128 v16, v[44:47] offset:20480
    v_mfma_f32_16x16x32_bf16 v[120:123], v[96:99], v[68:71], v[120:123]
    v_add_u32 v10, 34816, v10
    v_add_u32 v14, 34816, v14
    v_mfma_f32_16x16x32_bf16 v[124:127], v[100:103], v[68:71], v[124:127]
    v_add_u32 v15, 34816, v15
    v_add_u32 v16, 34816, v16
    v_mfma_f32_16x16x32_bf16 v[128:131], v[92:95], v[72:75], v[128:131]
    buffer_load_dwordx4 v[20:23], v6, s[8:11], s34 offen
    buffer_load_dwordx4 v[24:27], v7, s[8:11], s34 offen
    v_mfma_f32_16x16x32_bf16 v[132:135], v[96:99], v[72:75], v[132:135]
    buffer_load_dwordx4 v[28:31], v8, s[8:11], s34 offen
    buffer_load_dwordx4 v[32:35], v9, s[8:11], s34 offen
    v_mfma_f32_16x16x32_bf16 v[136:139], v[100:103], v[72:75], v[136:139]
    buffer_load_dwordx4 v[36:39], v11, s[12:15], s35 offen
    buffer_load_dwordx4 v[40:43], v12, s[12:15], s35 offen
    v_mfma_f32_16x16x32_bf16 v[140:143], v[92:95], v[76:79], v[140:143]
    buffer_load_dwordx4 v[44:47], v13, s[12:15], s35 offen
    s_add_u32 s34, s34, 128
    v_mfma_f32_16x16x32_bf16 v[144:147], v[96:99], v[76:79], v[144:147]
    s_add_u32 s35, s35, 73728
    v_mfma_f32_16x16x32_bf16 v[148:151], v[100:103], v[76:79], v[148:151]
    v_add_u32 v17, 4294932480, v17
    v_add_u32 v18, 4294932480, v18
    s_waitcnt lgkmcnt(0)
    s_barrier
    ds_read_b128 v[48:51], v17 offset:0
    ds_read_b128 v[52:55], v17 offset:2560
    ds_read_b128 v[56:59], v17 offset:5120
    ds_read_b128 v[60:63], v17 offset:7680
    ds_read_b64_tr_b16 v[80:81], v18 offset:20480
    ds_read_b64_tr_b16 v[82:83], v18 offset:21376
    ds_read_b64_tr_b16 v[84:85], v18 offset:20512
    ds_read_b64_tr_b16 v[86:87], v18 offset:21408
    ds_read_b64_tr_b16 v[88:89], v18 offset:20544
    ds_read_b64_tr_b16 v[90:91], v18 offset:21440
    s_waitcnt lgkmcnt(0)
    v_mfma_f32_16x16x32_bf16 v[104:107], v[80:83], v[48:51], v[104:107]
    ds_read_b128 v[64:67], v17 offset:64
    v_mfma_f32_16x16x32_bf16 v[108:111], v[84:87], v[48:51], v[108:111]
    ds_read_b128 v[68:71], v17 offset:2624
    v_mfma_f32_16x16x32_bf16 v[112:115], v[88:91], v[48:51], v[112:115]
    ds_read_b128 v[72:75], v17 offset:5184
    v_mfma_f32_16x16x32_bf16 v[116:119], v[80:83], v[52:55], v[116:119]
    ds_read_b128 v[76:79], v17 offset:7744
    v_mfma_f32_16x16x32_bf16 v[120:123], v[84:87], v[52:55], v[120:123]
    ds_read_b64_tr_b16 v[92:93], v18 offset:27648
    v_mfma_f32_16x16x32_bf16 v[124:127], v[88:91], v[52:55], v[124:127]
    ds_read_b64_tr_b16 v[94:95], v18 offset:28544
    v_mfma_f32_16x16x32_bf16 v[128:131], v[80:83], v[56:59], v[128:131]
    ds_read_b64_tr_b16 v[96:97], v18 offset:27680
    v_mfma_f32_16x16x32_bf16 v[132:135], v[84:87], v[56:59], v[132:135]
    ds_read_b64_tr_b16 v[98:99], v18 offset:28576
    v_mfma_f32_16x16x32_bf16 v[136:139], v[88:91], v[56:59], v[136:139]
    ds_read_b64_tr_b16 v[100:101], v18 offset:27712
    v_mfma_f32_16x16x32_bf16 v[140:143], v[80:83], v[60:63], v[140:143]
    ds_read_b64_tr_b16 v[102:103], v18 offset:28608
    v_mfma_f32_16x16x32_bf16 v[144:147], v[84:87], v[60:63], v[144:147]
    v_mfma_f32_16x16x32_bf16 v[148:151], v[88:91], v[60:63], v[148:151]
    s_waitcnt lgkmcnt(0)
    v_mfma_f32_16x16x32_bf16 v[104:107], v[92:95], v[64:67], v[104:107]
    s_waitcnt vmcnt(0)
    ds_write_b128 v10, v[20:23] offset:0
    v_mfma_f32_16x16x32_bf16 v[108:111], v[96:99], v[64:67], v[108:111]
    ds_write_b128 v10, v[24:27] offset:5120
    ds_write_b128 v10, v[28:31] offset:10240
    v_mfma_f32_16x16x32_bf16 v[112:115], v[100:103], v[64:67], v[112:115]
    ds_write_b128 v10, v[32:35] offset:15360
    ds_write_b128 v14, v[36:39] offset:20480
    v_mfma_f32_16x16x32_bf16 v[116:119], v[92:95], v[68:71], v[116:119]
    ds_write_b128 v15, v[40:43] offset:20480
    ds_write_b128 v16, v[44:47] offset:20480
    v_mfma_f32_16x16x32_bf16 v[120:123], v[96:99], v[68:71], v[120:123]
    v_add_u32 v10, 4294932480, v10
    v_add_u32 v14, 4294932480, v14
    v_mfma_f32_16x16x32_bf16 v[124:127], v[100:103], v[68:71], v[124:127]
    v_add_u32 v15, 4294932480, v15
    v_add_u32 v16, 4294932480, v16
    v_mfma_f32_16x16x32_bf16 v[128:131], v[92:95], v[72:75], v[128:131]
    buffer_load_dwordx4 v[20:23], v6, s[8:11], s34 offen
    buffer_load_dwordx4 v[24:27], v7, s[8:11], s34 offen
    v_mfma_f32_16x16x32_bf16 v[132:135], v[96:99], v[72:75], v[132:135]
    buffer_load_dwordx4 v[28:31], v8, s[8:11], s34 offen
    buffer_load_dwordx4 v[32:35], v9, s[8:11], s34 offen
    v_mfma_f32_16x16x32_bf16 v[136:139], v[100:103], v[72:75], v[136:139]
    buffer_load_dwordx4 v[36:39], v11, s[12:15], s35 offen
    buffer_load_dwordx4 v[40:43], v12, s[12:15], s35 offen
    v_mfma_f32_16x16x32_bf16 v[140:143], v[92:95], v[76:79], v[140:143]
    buffer_load_dwordx4 v[44:47], v13, s[12:15], s35 offen
    s_add_u32 s34, s34, 128
    v_mfma_f32_16x16x32_bf16 v[144:147], v[96:99], v[76:79], v[144:147]
    s_add_u32 s35, s35, 73728
    v_mfma_f32_16x16x32_bf16 v[148:151], v[100:103], v[76:79], v[148:151]
    v_add_u32 v17, 34816, v17
    v_add_u32 v18, 34816, v18
    s_waitcnt lgkmcnt(0)
    s_barrier
    ds_read_b128 v[48:51], v17 offset:0
    ds_read_b128 v[52:55], v17 offset:2560
    ds_read_b128 v[56:59], v17 offset:5120
    ds_read_b128 v[60:63], v17 offset:7680
    ds_read_b64_tr_b16 v[80:81], v18 offset:20480
    ds_read_b64_tr_b16 v[82:83], v18 offset:21376
    ds_read_b64_tr_b16 v[84:85], v18 offset:20512
    ds_read_b64_tr_b16 v[86:87], v18 offset:21408
    ds_read_b64_tr_b16 v[88:89], v18 offset:20544
    ds_read_b64_tr_b16 v[90:91], v18 offset:21440
    s_waitcnt lgkmcnt(0)
    v_mfma_f32_16x16x32_bf16 v[104:107], v[80:83], v[48:51], v[104:107]
    ds_read_b128 v[64:67], v17 offset:64
    v_mfma_f32_16x16x32_bf16 v[108:111], v[84:87], v[48:51], v[108:111]
    ds_read_b128 v[68:71], v17 offset:2624
    v_mfma_f32_16x16x32_bf16 v[112:115], v[88:91], v[48:51], v[112:115]
    ds_read_b128 v[72:75], v17 offset:5184
    v_mfma_f32_16x16x32_bf16 v[116:119], v[80:83], v[52:55], v[116:119]
    ds_read_b128 v[76:79], v17 offset:7744
    v_mfma_f32_16x16x32_bf16 v[120:123], v[84:87], v[52:55], v[120:123]
    ds_read_b64_tr_b16 v[92:93], v18 offset:27648
    v_mfma_f32_16x16x32_bf16 v[124:127], v[88:91], v[52:55], v[124:127]
    ds_read_b64_tr_b16 v[94:95], v18 offset:28544
    v_mfma_f32_16x16x32_bf16 v[128:131], v[80:83], v[56:59], v[128:131]
    ds_read_b64_tr_b16 v[96:97], v18 offset:27680
    v_mfma_f32_16x16x32_bf16 v[132:135], v[84:87], v[56:59], v[132:135]
    ds_read_b64_tr_b16 v[98:99], v18 offset:28576
    v_mfma_f32_16x16x32_bf16 v[136:139], v[88:91], v[56:59], v[136:139]
    ds_read_b64_tr_b16 v[100:101], v18 offset:27712
    v_mfma_f32_16x16x32_bf16 v[140:143], v[80:83], v[60:63], v[140:143]
    ds_read_b64_tr_b16 v[102:103], v18 offset:28608
    v_mfma_f32_16x16x32_bf16 v[144:147], v[84:87], v[60:63], v[144:147]
    v_mfma_f32_16x16x32_bf16 v[148:151], v[88:91], v[60:63], v[148:151]
    s_waitcnt lgkmcnt(0)
    v_mfma_f32_16x16x32_bf16 v[104:107], v[92:95], v[64:67], v[104:107]
    s_waitcnt vmcnt(0)
    ds_write_b128 v10, v[20:23] offset:0
    v_mfma_f32_16x16x32_bf16 v[108:111], v[96:99], v[64:67], v[108:111]
    ds_write_b128 v10, v[24:27] offset:5120
    ds_write_b128 v10, v[28:31] offset:10240
    v_mfma_f32_16x16x32_bf16 v[112:115], v[100:103], v[64:67], v[112:115]
    ds_write_b128 v10, v[32:35] offset:15360
    ds_write_b128 v14, v[36:39] offset:20480
    v_mfma_f32_16x16x32_bf16 v[116:119], v[92:95], v[68:71], v[116:119]
    ds_write_b128 v15, v[40:43] offset:20480
    ds_write_b128 v16, v[44:47] offset:20480
    v_mfma_f32_16x16x32_bf16 v[120:123], v[96:99], v[68:71], v[120:123]
    v_add_u32 v10, 34816, v10
    v_add_u32 v14, 34816, v14
    v_mfma_f32_16x16x32_bf16 v[124:127], v[100:103], v[68:71], v[124:127]
    v_add_u32 v15, 34816, v15
    v_add_u32 v16, 34816, v16
    v_mfma_f32_16x16x32_bf16 v[128:131], v[92:95], v[72:75], v[128:131]
    buffer_load_dwordx4 v[20:23], v6, s[8:11], s34 offen
    buffer_load_dwordx4 v[24:27], v7, s[8:11], s34 offen
    v_mfma_f32_16x16x32_bf16 v[132:135], v[96:99], v[72:75], v[132:135]
    buffer_load_dwordx4 v[28:31], v8, s[8:11], s34 offen
    buffer_load_dwordx4 v[32:35], v9, s[8:11], s34 offen
    v_mfma_f32_16x16x32_bf16 v[136:139], v[100:103], v[72:75], v[136:139]
    buffer_load_dwordx4 v[36:39], v11, s[12:15], s35 offen
    buffer_load_dwordx4 v[40:43], v12, s[12:15], s35 offen
    v_mfma_f32_16x16x32_bf16 v[140:143], v[92:95], v[76:79], v[140:143]
    buffer_load_dwordx4 v[44:47], v13, s[12:15], s35 offen
    s_add_u32 s34, s34, 128
    v_mfma_f32_16x16x32_bf16 v[144:147], v[96:99], v[76:79], v[144:147]
    s_add_u32 s35, s35, 73728
    v_mfma_f32_16x16x32_bf16 v[148:151], v[100:103], v[76:79], v[148:151]
    v_add_u32 v17, 4294932480, v17
    v_add_u32 v18, 4294932480, v18
    s_waitcnt lgkmcnt(0)
    s_barrier
    ds_read_b128 v[48:51], v17 offset:0
    ds_read_b128 v[52:55], v17 offset:2560
    ds_read_b128 v[56:59], v17 offset:5120
    ds_read_b128 v[60:63], v17 offset:7680
    ds_read_b64_tr_b16 v[80:81], v18 offset:20480
    ds_read_b64_tr_b16 v[82:83], v18 offset:21376
    ds_read_b64_tr_b16 v[84:85], v18 offset:20512
    ds_read_b64_tr_b16 v[86:87], v18 offset:21408
    ds_read_b64_tr_b16 v[88:89], v18 offset:20544
    ds_read_b64_tr_b16 v[90:91], v18 offset:21440
    s_waitcnt lgkmcnt(0)
    v_mfma_f32_16x16x32_bf16 v[104:107], v[80:83], v[48:51], v[104:107]
    ds_read_b128 v[64:67], v17 offset:64
    v_mfma_f32_16x16x32_bf16 v[108:111], v[84:87], v[48:51], v[108:111]
    ds_read_b128 v[68:71], v17 offset:2624
    v_mfma_f32_16x16x32_bf16 v[112:115], v[88:91], v[48:51], v[112:115]
    ds_read_b128 v[72:75], v17 offset:5184
    v_mfma_f32_16x16x32_bf16 v[116:119], v[80:83], v[52:55], v[116:119]
    ds_read_b128 v[76:79], v17 offset:7744
    v_mfma_f32_16x16x32_bf16 v[120:123], v[84:87], v[52:55], v[120:123]
    ds_read_b64_tr_b16 v[92:93], v18 offset:27648
    v_mfma_f32_16x16x32_bf16 v[124:127], v[88:91], v[52:55], v[124:127]
    ds_read_b64_tr_b16 v[94:95], v18 offset:28544
    v_mfma_f32_16x16x32_bf16 v[128:131], v[80:83], v[56:59], v[128:131]
    ds_read_b64_tr_b16 v[96:97], v18 offset:27680
    v_mfma_f32_16x16x32_bf16 v[132:135], v[84:87], v[56:59], v[132:135]
    ds_read_b64_tr_b16 v[98:99], v18 offset:28576
    v_mfma_f32_16x16x32_bf16 v[136:139], v[88:91], v[56:59], v[136:139]
    ds_read_b64_tr_b16 v[100:101], v18 offset:27712
    v_mfma_f32_16x16x32_bf16 v[140:143], v[80:83], v[60:63], v[140:143]
    ds_read_b64_tr_b16 v[102:103], v18 offset:28608
    v_mfma_f32_16x16x32_bf16 v[144:147], v[84:87], v[60:63], v[144:147]
    v_mfma_f32_16x16x32_bf16 v[148:151], v[88:91], v[60:63], v[148:151]
    s_waitcnt lgkmcnt(0)
    v_mfma_f32_16x16x32_bf16 v[104:107], v[92:95], v[64:67], v[104:107]
    s_waitcnt vmcnt(0)
    ds_write_b128 v10, v[20:23] offset:0
    v_mfma_f32_16x16x32_bf16 v[108:111], v[96:99], v[64:67], v[108:111]
    ds_write_b128 v10, v[24:27] offset:5120
    ds_write_b128 v10, v[28:31] offset:10240
    v_mfma_f32_16x16x32_bf16 v[112:115], v[100:103], v[64:67], v[112:115]
    ds_write_b128 v10, v[32:35] offset:15360
    ds_write_b128 v14, v[36:39] offset:20480
    v_mfma_f32_16x16x32_bf16 v[116:119], v[92:95], v[68:71], v[116:119]
    ds_write_b128 v15, v[40:43] offset:20480
    ds_write_b128 v16, v[44:47] offset:20480
    v_mfma_f32_16x16x32_bf16 v[120:123], v[96:99], v[68:71], v[120:123]
    v_add_u32 v10, 4294932480, v10
    v_add_u32 v14, 4294932480, v14
    v_mfma_f32_16x16x32_bf16 v[124:127], v[100:103], v[68:71], v[124:127]
    v_add_u32 v15, 4294932480, v15
    v_add_u32 v16, 4294932480, v16
    v_mfma_f32_16x16x32_bf16 v[128:131], v[92:95], v[72:75], v[128:131]
    buffer_load_dwordx4 v[20:23], v6, s[8:11], s34 offen
    buffer_load_dwordx4 v[24:27], v7, s[8:11], s34 offen
    v_mfma_f32_16x16x32_bf16 v[132:135], v[96:99], v[72:75], v[132:135]
    buffer_load_dwordx4 v[28:31], v8, s[8:11], s34 offen
    buffer_load_dwordx4 v[32:35], v9, s[8:11], s34 offen
    v_mfma_f32_16x16x32_bf16 v[136:139], v[100:103], v[72:75], v[136:139]
    buffer_load_dwordx4 v[36:39], v11, s[12:15], s35 offen
    buffer_load_dwordx4 v[40:43], v12, s[12:15], s35 offen
    v_mfma_f32_16x16x32_bf16 v[140:143], v[92:95], v[76:79], v[140:143]
    buffer_load_dwordx4 v[44:47], v13, s[12:15], s35 offen
    s_add_u32 s34, s34, 128
    v_mfma_f32_16x16x32_bf16 v[144:147], v[96:99], v[76:79], v[144:147]
    s_add_u32 s35, s35, 73728
    v_mfma_f32_16x16x32_bf16 v[148:151], v[100:103], v[76:79], v[148:151]
    v_add_u32 v17, 34816, v17
    v_add_u32 v18, 34816, v18
    s_waitcnt lgkmcnt(0)
    s_barrier
    ds_read_b128 v[48:51], v17 offset:0
    ds_read_b128 v[52:55], v17 offset:2560
    ds_read_b128 v[56:59], v17 offset:5120
    ds_read_b128 v[60:63], v17 offset:7680
    ds_read_b64_tr_b16 v[80:81], v18 offset:20480
    ds_read_b64_tr_b16 v[82:83], v18 offset:21376
    ds_read_b64_tr_b16 v[84:85], v18 offset:20512
    ds_read_b64_tr_b16 v[86:87], v18 offset:21408
    ds_read_b64_tr_b16 v[88:89], v18 offset:20544
    ds_read_b64_tr_b16 v[90:91], v18 offset:21440
    s_waitcnt lgkmcnt(0)
    v_mfma_f32_16x16x32_bf16 v[104:107], v[80:83], v[48:51], v[104:107]
    ds_read_b128 v[64:67], v17 offset:64
    v_mfma_f32_16x16x32_bf16 v[108:111], v[84:87], v[48:51], v[108:111]
    ds_read_b128 v[68:71], v17 offset:2624
    v_mfma_f32_16x16x32_bf16 v[112:115], v[88:91], v[48:51], v[112:115]
    ds_read_b128 v[72:75], v17 offset:5184
    v_mfma_f32_16x16x32_bf16 v[116:119], v[80:83], v[52:55], v[116:119]
    ds_read_b128 v[76:79], v17 offset:7744
    v_mfma_f32_16x16x32_bf16 v[120:123], v[84:87], v[52:55], v[120:123]
    ds_read_b64_tr_b16 v[92:93], v18 offset:27648
    v_mfma_f32_16x16x32_bf16 v[124:127], v[88:91], v[52:55], v[124:127]
    ds_read_b64_tr_b16 v[94:95], v18 offset:28544
    v_mfma_f32_16x16x32_bf16 v[128:131], v[80:83], v[56:59], v[128:131]
    ds_read_b64_tr_b16 v[96:97], v18 offset:27680
    v_mfma_f32_16x16x32_bf16 v[132:135], v[84:87], v[56:59], v[132:135]
    ds_read_b64_tr_b16 v[98:99], v18 offset:28576
    v_mfma_f32_16x16x32_bf16 v[136:139], v[88:91], v[56:59], v[136:139]
    ds_read_b64_tr_b16 v[100:101], v18 offset:27712
    v_mfma_f32_16x16x32_bf16 v[140:143], v[80:83], v[60:63], v[140:143]
    ds_read_b64_tr_b16 v[102:103], v18 offset:28608
    v_mfma_f32_16x16x32_bf16 v[144:147], v[84:87], v[60:63], v[144:147]
    v_mfma_f32_16x16x32_bf16 v[148:151], v[88:91], v[60:63], v[148:151]
    s_waitcnt lgkmcnt(0)
    v_mfma_f32_16x16x32_bf16 v[104:107], v[92:95], v[64:67], v[104:107]
    s_waitcnt vmcnt(0)
    ds_write_b128 v10, v[20:23] offset:0
    v_mfma_f32_16x16x32_bf16 v[108:111], v[96:99], v[64:67], v[108:111]
    ds_write_b128 v10, v[24:27] offset:5120
    ds_write_b128 v10, v[28:31] offset:10240
    v_mfma_f32_16x16x32_bf16 v[112:115], v[100:103], v[64:67], v[112:115]
    ds_write_b128 v10, v[32:35] offset:15360
    ds_write_b128 v14, v[36:39] offset:20480
    v_mfma_f32_16x16x32_bf16 v[116:119], v[92:95], v[68:71], v[116:119]
    ds_write_b128 v15, v[40:43] offset:20480
    ds_write_b128 v16, v[44:47] offset:20480
    v_mfma_f32_16x16x32_bf16 v[120:123], v[96:99], v[68:71], v[120:123]
    v_add_u32 v10, 34816, v10
    v_add_u32 v14, 34816, v14
    v_mfma_f32_16x16x32_bf16 v[124:127], v[100:103], v[68:71], v[124:127]
    v_add_u32 v15, 34816, v15
    v_add_u32 v16, 34816, v16
    v_mfma_f32_16x16x32_bf16 v[128:131], v[92:95], v[72:75], v[128:131]
    buffer_load_dwordx4 v[20:23], v6, s[8:11], s34 offen
    buffer_load_dwordx4 v[24:27], v7, s[8:11], s34 offen
    v_mfma_f32_16x16x32_bf16 v[132:135], v[96:99], v[72:75], v[132:135]
    buffer_load_dwordx4 v[28:31], v8, s[8:11], s34 offen
    buffer_load_dwordx4 v[32:35], v9, s[8:11], s34 offen
    v_mfma_f32_16x16x32_bf16 v[136:139], v[100:103], v[72:75], v[136:139]
    buffer_load_dwordx4 v[36:39], v11, s[12:15], s35 offen
    buffer_load_dwordx4 v[40:43], v12, s[12:15], s35 offen
    v_mfma_f32_16x16x32_bf16 v[140:143], v[92:95], v[76:79], v[140:143]
    buffer_load_dwordx4 v[44:47], v13, s[12:15], s35 offen
    s_add_u32 s34, s34, 128
    v_mfma_f32_16x16x32_bf16 v[144:147], v[96:99], v[76:79], v[144:147]
    s_add_u32 s35, s35, 73728
    v_mfma_f32_16x16x32_bf16 v[148:151], v[100:103], v[76:79], v[148:151]
    v_add_u32 v17, 4294932480, v17
    v_add_u32 v18, 4294932480, v18
    s_waitcnt lgkmcnt(0)
    s_barrier
    ds_read_b128 v[48:51], v17 offset:0
    ds_read_b128 v[52:55], v17 offset:2560
    ds_read_b128 v[56:59], v17 offset:5120
    ds_read_b128 v[60:63], v17 offset:7680
    ds_read_b64_tr_b16 v[80:81], v18 offset:20480
    ds_read_b64_tr_b16 v[82:83], v18 offset:21376
    ds_read_b64_tr_b16 v[84:85], v18 offset:20512
    ds_read_b64_tr_b16 v[86:87], v18 offset:21408
    ds_read_b64_tr_b16 v[88:89], v18 offset:20544
    ds_read_b64_tr_b16 v[90:91], v18 offset:21440
    s_waitcnt lgkmcnt(0)
    v_mfma_f32_16x16x32_bf16 v[104:107], v[80:83], v[48:51], v[104:107]
    ds_read_b128 v[64:67], v17 offset:64
    v_mfma_f32_16x16x32_bf16 v[108:111], v[84:87], v[48:51], v[108:111]
    ds_read_b128 v[68:71], v17 offset:2624
    v_mfma_f32_16x16x32_bf16 v[112:115], v[88:91], v[48:51], v[112:115]
    ds_read_b128 v[72:75], v17 offset:5184
    v_mfma_f32_16x16x32_bf16 v[116:119], v[80:83], v[52:55], v[116:119]
    ds_read_b128 v[76:79], v17 offset:7744
    v_mfma_f32_16x16x32_bf16 v[120:123], v[84:87], v[52:55], v[120:123]
    ds_read_b64_tr_b16 v[92:93], v18 offset:27648
    v_mfma_f32_16x16x32_bf16 v[124:127], v[88:91], v[52:55], v[124:127]
    ds_read_b64_tr_b16 v[94:95], v18 offset:28544
    v_mfma_f32_16x16x32_bf16 v[128:131], v[80:83], v[56:59], v[128:131]
    ds_read_b64_tr_b16 v[96:97], v18 offset:27680
    v_mfma_f32_16x16x32_bf16 v[132:135], v[84:87], v[56:59], v[132:135]
    ds_read_b64_tr_b16 v[98:99], v18 offset:28576
    v_mfma_f32_16x16x32_bf16 v[136:139], v[88:91], v[56:59], v[136:139]
    ds_read_b64_tr_b16 v[100:101], v18 offset:27712
    v_mfma_f32_16x16x32_bf16 v[140:143], v[80:83], v[60:63], v[140:143]
    ds_read_b64_tr_b16 v[102:103], v18 offset:28608
    v_mfma_f32_16x16x32_bf16 v[144:147], v[84:87], v[60:63], v[144:147]
    v_mfma_f32_16x16x32_bf16 v[148:151], v[88:91], v[60:63], v[148:151]
    s_waitcnt lgkmcnt(0)
    v_mfma_f32_16x16x32_bf16 v[104:107], v[92:95], v[64:67], v[104:107]
    s_waitcnt vmcnt(0)
    v_mfma_f32_16x16x32_bf16 v[108:111], v[96:99], v[64:67], v[108:111]
    ds_write_b128 v10, v[20:23] offset:0
    v_mfma_f32_16x16x32_bf16 v[112:115], v[100:103], v[64:67], v[112:115]
    ds_write_b128 v10, v[24:27] offset:5120
    v_mfma_f32_16x16x32_bf16 v[116:119], v[92:95], v[68:71], v[116:119]
    ds_write_b128 v10, v[28:31] offset:10240
    v_mfma_f32_16x16x32_bf16 v[120:123], v[96:99], v[68:71], v[120:123]
    ds_write_b128 v10, v[32:35] offset:15360
    v_mfma_f32_16x16x32_bf16 v[124:127], v[100:103], v[68:71], v[124:127]
    ds_write_b128 v14, v[36:39] offset:20480
    v_mfma_f32_16x16x32_bf16 v[128:131], v[92:95], v[72:75], v[128:131]
    ds_write_b128 v15, v[40:43] offset:20480
    v_mfma_f32_16x16x32_bf16 v[132:135], v[96:99], v[72:75], v[132:135]
    ds_write_b128 v16, v[44:47] offset:20480
    v_mfma_f32_16x16x32_bf16 v[136:139], v[100:103], v[72:75], v[136:139]
    v_add_u32 v10, 4294932480, v10
    v_mfma_f32_16x16x32_bf16 v[140:143], v[92:95], v[76:79], v[140:143]
    v_add_u32 v14, 4294932480, v14
    v_mfma_f32_16x16x32_bf16 v[144:147], v[96:99], v[76:79], v[144:147]
    v_add_u32 v15, 4294932480, v15
    v_mfma_f32_16x16x32_bf16 v[148:151], v[100:103], v[76:79], v[148:151]
    v_add_u32 v16, 4294932480, v16
    v_add_u32 v17, 34816, v17
    v_add_u32 v18, 34816, v18
    s_waitcnt lgkmcnt(0)
    s_barrier
    ds_read_b128 v[48:51], v17 offset:0
    ds_read_b128 v[52:55], v17 offset:2560
    ds_read_b128 v[56:59], v17 offset:5120
    ds_read_b128 v[60:63], v17 offset:7680
    ds_read_b64_tr_b16 v[80:81], v18 offset:20480
    ds_read_b64_tr_b16 v[82:83], v18 offset:21376
    ds_read_b64_tr_b16 v[84:85], v18 offset:20512
    ds_read_b64_tr_b16 v[86:87], v18 offset:21408
    ds_read_b64_tr_b16 v[88:89], v18 offset:20544
    ds_read_b64_tr_b16 v[90:91], v18 offset:21440
    s_waitcnt lgkmcnt(0)
    v_mfma_f32_16x16x32_bf16 v[104:107], v[80:83], v[48:51], v[104:107]
    ds_read_b128 v[64:67], v17 offset:64
    v_mfma_f32_16x16x32_bf16 v[108:111], v[84:87], v[48:51], v[108:111]
    ds_read_b128 v[68:71], v17 offset:2624
    v_mfma_f32_16x16x32_bf16 v[112:115], v[88:91], v[48:51], v[112:115]
    ds_read_b128 v[72:75], v17 offset:5184
    v_mfma_f32_16x16x32_bf16 v[116:119], v[80:83], v[52:55], v[116:119]
    ds_read_b128 v[76:79], v17 offset:7744
    v_mfma_f32_16x16x32_bf16 v[120:123], v[84:87], v[52:55], v[120:123]
    ds_read_b64_tr_b16 v[92:93], v18 offset:27648
    v_mfma_f32_16x16x32_bf16 v[124:127], v[88:91], v[52:55], v[124:127]
    ds_read_b64_tr_b16 v[94:95], v18 offset:28544
    v_mfma_f32_16x16x32_bf16 v[128:131], v[80:83], v[56:59], v[128:131]
    ds_read_b64_tr_b16 v[96:97], v18 offset:27680
    v_mfma_f32_16x16x32_bf16 v[132:135], v[84:87], v[56:59], v[132:135]
    ds_read_b64_tr_b16 v[98:99], v18 offset:28576
    v_mfma_f32_16x16x32_bf16 v[136:139], v[88:91], v[56:59], v[136:139]
    ds_read_b64_tr_b16 v[100:101], v18 offset:27712
    v_mfma_f32_16x16x32_bf16 v[140:143], v[80:83], v[60:63], v[140:143]
    ds_read_b64_tr_b16 v[102:103], v18 offset:28608
    v_mfma_f32_16x16x32_bf16 v[144:147], v[84:87], v[60:63], v[144:147]
    v_mfma_f32_16x16x32_bf16 v[148:151], v[88:91], v[60:63], v[148:151]
    s_waitcnt lgkmcnt(0)
    v_mfma_f32_16x16x32_bf16 v[104:107], v[92:95], v[64:67], v[104:107]
    v_mfma_f32_16x16x32_bf16 v[108:111], v[96:99], v[64:67], v[108:111]
    v_mfma_f32_16x16x32_bf16 v[112:115], v[100:103], v[64:67], v[112:115]
    v_mfma_f32_16x16x32_bf16 v[116:119], v[92:95], v[68:71], v[116:119]
    v_mfma_f32_16x16x32_bf16 v[120:123], v[96:99], v[68:71], v[120:123]
    v_mfma_f32_16x16x32_bf16 v[124:127], v[100:103], v[68:71], v[124:127]
    v_mfma_f32_16x16x32_bf16 v[128:131], v[92:95], v[72:75], v[128:131]
    v_mfma_f32_16x16x32_bf16 v[132:135], v[96:99], v[72:75], v[132:135]
    v_mfma_f32_16x16x32_bf16 v[136:139], v[100:103], v[72:75], v[136:139]
    v_mfma_f32_16x16x32_bf16 v[140:143], v[92:95], v[76:79], v[140:143]
    v_mfma_f32_16x16x32_bf16 v[144:147], v[96:99], v[76:79], v[144:147]
    v_mfma_f32_16x16x32_bf16 v[148:151], v[100:103], v[76:79], v[148:151]
    s_nop 7
    s_nop 7
    buffer_store_dwordx4 v[104:107], v19, s[16:19], 0 offen offset:0
    buffer_store_dwordx4 v[108:111], v19, s[16:19], 0 offen offset:64
    buffer_store_dwordx4 v[112:115], v19, s[16:19], 0 offen offset:128
    v_add_u32 v19, 36864, v19
    buffer_store_dwordx4 v[116:119], v19, s[16:19], 0 offen offset:0
    buffer_store_dwordx4 v[120:123], v19, s[16:19], 0 offen offset:64
    buffer_store_dwordx4 v[124:127], v19, s[16:19], 0 offen offset:128
    v_add_u32 v19, 36864, v19
    buffer_store_dwordx4 v[128:131], v19, s[16:19], 0 offen offset:0
    buffer_store_dwordx4 v[132:135], v19, s[16:19], 0 offen offset:64
    buffer_store_dwordx4 v[136:139], v19, s[16:19], 0 offen offset:128
    v_add_u32 v19, 36864, v19
    buffer_store_dwordx4 v[140:143], v19, s[16:19], 0 offen offset:0
    buffer_store_dwordx4 v[144:147], v19, s[16:19], 0 offen offset:64
    buffer_store_dwordx4 v[148:151], v19, s[16:19], 0 offen offset:128
    s_waitcnt vmcnt(0)
k_w4_kernel_end:
    s_endpgm
.section .rodata,"a"
.p2align 6
.amdhsa_kernel k_w4_kernel
  .amdhsa_next_free_vgpr 152
  .amdhsa_next_free_sgpr 80
  .amdhsa_accum_offset 152
  .amdhsa_group_segment_fixed_size 0
  .amdhsa_kernarg_size 88
  .amdhsa_user_sgpr_count 2
  .amdhsa_user_sgpr_kernarg_segment_ptr 1
  .amdhsa_system_sgpr_workgroup_id_x 1
.end_amdhsa_kernel
.text
.globl sequential_preLN__mha_block__mixer_s_mlp__prompt_kernel
.p2align 8
.type sequential_preLN__mha_block__mixer_s_mlp__prompt_kernel,@function
sequential_preLN__mha_block__mixer_s_mlp__prompt_kernel:
    s_cmp_ge_u32 s2, 576
    s_cbranch_scc1 sequential_preLN__mha_block__mixer_s_mlp__prompt_kernel_end
    s_load_dwordx2 s[4:5], s[0:1], 80
    s_load_dwordx2 s[6:7], s[0:1], 64
    s_waitcnt lgkmcnt(0)
    s_add_u32 s8, s4, 37748736
    s_addc_u32 s9, s5, 0
    s_mov_b32 s10, 18874368
    s_mov_b32 s11, 0x00020000
    s_add_u32 s12, s4, 9437184
    s_addc_u32 s13, s5, 0
    s_mov_b32 s14, 2359296
    s_mov_b32 s15, 0x00020000
    s_add_u32 s16, s4, 16515072
    s_addc_u32 s17, s5, 0
    s_mov_b32 s18, 2359296
    s_mov_b32 s19, 0x00020000
    s_mov_b32 s20, s6
    s_mov_b32 s21, s7
    s_mov_b32 s22, 2359296
    s_mov_b32 s23, 0x00020000
    s_lshl_b32 s24, s2, 8
    v_add_u32 v1, s24, v0
    v_lshlrev_b32 v2, 4, v1
    v_lshlrev_b32 v3, 5, v1
    v_add_u32 v4, 0, v3
    buffer_load_dwordx4 v[8:11], v4, s[8:11], 0 offen
    buffer_load_dwordx4 v[12:15], v4, s[8:11], 0 offen offset:16
    v_add_u32 v4, 4718592, v3
    buffer_load_dwordx4 v[16:19], v4, s[8:11], 0 offen
    buffer_load_dwordx4 v[20:23], v4, s[8:11], 0 offen offset:16
    v_add_u32 v4, 9437184, v3
    buffer_load_dwordx4 v[24:27], v4, s[8:11], 0 offen
    buffer_load_dwordx4 v[28:31], v4, s[8:11], 0 offen offset:16
    v_add_u32 v4, 14155776, v3
    buffer_load_dwordx4 v[32:35], v4, s[8:11], 0 offen
    buffer_load_dwordx4 v[36:39], v4, s[8:11], 0 offen offset:16
    buffer_load_dwordx4 v[40:43], v2, s[12:15], 0 offen
    buffer_load_dwordx4 v[44:47], v2, s[16:19], 0 offen
    s_waitcnt vmcnt(0)
    v_add_f32 v8, v8, v16
    v_add_f32 v8, v8, v24
    v_add_f32 v8, v8, v32
    v_add_f32 v9, v9, v17
    v_add_f32 v9, v9, v25
    v_add_f32 v9, v9, v33
    v_add_f32 v10, v10, v18
    v_add_f32 v10, v10, v26
    v_add_f32 v10, v10, v34
    v_add_f32 v11, v11, v19
    v_add_f32 v11, v11, v27
    v_add_f32 v11, v11, v35
    v_add_f32 v12, v12, v20
    v_add_f32 v12, v12, v28
    v_add_f32 v12, v12, v36
    v_add_f32 v13, v13, v21
    v_add_f32 v13, v13, v29
    v_add_f32 v13, v13, v37
    v_add_f32 v14, v14, v22
    v_add_f32 v14, v14, v30
    v_add_f32 v14, v14, v38
    v_add_f32 v15, v15, v23
    v_add_f32 v15, v15, v31
    v_add_f32 v15, v15, v39
    v_cvt_pk_bf16_f32 v48, v8, v9
    v_lshlrev_b32 v49, 16, v48
    v_and_b32 v50, 0xffff0000, v48
    v_lshlrev_b32 v51, 16, v44
    v_and_b32 v52, 0xffff0000, v44
    v_add_f32 v49, v49, v51
    v_add_f32 v50, v50, v52
    v_cvt_pk_bf16_f32 v48, v49, v50
    v_lshlrev_b32 v49, 16, v48
    v_and_b32 v50, 0xffff0000, v48
    v_lshlrev_b32 v51, 16, v40
    v_and_b32 v52, 0xffff0000, v40
    v_add_f32 v49, v49, v51
    v_add_f32 v50, v50, v52
    v_cvt_pk_bf16_f32 v56, v49, v50
    v_cvt_pk_bf16_f32 v48, v10, v11
    v_lshlrev_b32 v49, 16, v48
    v_and_b32 v50, 0xffff0000, v48
    v_lshlrev_b32 v51, 16, v45
    v_and_b32 v52, 0xffff0000, v45
    v_add_f32 v49, v49, v51
    v_add_f32 v50, v50, v52
    v_cvt_pk_bf16_f32 v48, v49, v50
    v_lshlrev_b32 v49, 16, v48
    v_and_b32 v50, 0xffff0000, v48
    v_lshlrev_b32 v51, 16, v41
    v_and_b32 v52, 0xffff0000, v41
    v_add_f32 v49, v49, v51
    v_add_f32 v50, v50, v52
    v_cvt_pk_bf16_f32 v57, v49, v50
    v_cvt_pk_bf16_f32 v48, v12, v13
    v_lshlrev_b32 v49, 16, v48
    v_and_b32 v50, 0xffff0000, v48
    v_lshlrev_b32 v51, 16, v46
    v_and_b32 v52, 0xffff0000, v46
    v_add_f32 v49, v49, v51
    v_add_f32 v50, v50, v52
    v_cvt_pk_bf16_f32 v48, v49, v50
    v_lshlrev_b32 v49, 16, v48
    v_and_b32 v50, 0xffff0000, v48
    v_lshlrev_b32 v51, 16, v42
    v_and_b32 v52, 0xffff0000, v42
    v_add_f32 v49, v49, v51
    v_add_f32 v50, v50, v52
    v_cvt_pk_bf16_f32 v58, v49, v50
    v_cvt_pk_bf16_f32 v48, v14, v15
    v_lshlrev_b32 v49, 16, v48
    v_and_b32 v50, 0xffff0000, v48
    v_lshlrev_b32 v51, 16, v47
    v_and_b32 v52, 0xffff0000, v47
    v_add_f32 v49, v49, v51
    v_add_f32 v50, v50, v52
    v_cvt_pk_bf16_f32 v48, v49, v50
    v_lshlrev_b32 v49, 16, v48
    v_and_b32 v50, 0xffff0000, v48
    v_lshlrev_b32 v51, 16, v43
    v_and_b32 v52, 0xffff0000, v43
    v_add_f32 v49, v49, v51
    v_add_f32 v50, v50, v52
    v_cvt_pk_bf16_f32 v59, v49, v50
    buffer_store_dwordx4 v[56:59], v2, s[20:23], 0 offen
    s_waitcnt vmcnt(0)
sequential_preLN__mha_block__mixer_s_mlp__prompt_kernel_end:
    s_endpgm
.section .rodata,"a"
.p2align 6
.amdhsa_kernel sequential_preLN__mha_block__mixer_s_mlp__prompt_kernel
  .amdhsa_next_free_vgpr 64
  .amdhsa_next_free_sgpr 32
  .amdhsa_accum_offset 64
  .amdhsa_group_segment_fixed_size 0
  .amdhsa_kernarg_size 88
  .amdhsa_user_sgpr_count 2
  .amdhsa_user_sgpr_kernarg_segment_ptr 1
  .amdhsa_system_sgpr_workgroup_id_x 1
.end_amdhsa_kernel
.text
```
